```python
import torch

def _softmax(x, axis=-1):
    return torch.softmax(x, dim=axis)

def _gelu(x):
    return torch.nn.functional.gelu(x, approximate='tanh')

def _silu(x):
    return torch.nn.functional.silu(x)

def _sigmoid(x):
    return torch.sigmoid(x)

def _layernorm(x, axis=-1, eps=1e-05):
    m = x.mean(dim=axis, keepdim=True)
    v = x.var(dim=axis, keepdim=True, unbiased=False)
    return (x - m) / torch.sqrt(v + eps)

def _scatter_add(tgt, idx, src, axis=0):
    return tgt.clone().index_add_(axis, idx, src)

def _segment_sum(src, seg, n):
    out = torch.zeros((n,) + src.shape[1:], dtype=src.dtype)
    return out.index_add_(0, seg, src)

def _pad(x, pw):
    flat = tuple((v for pair in reversed(pw) for v in pair))
    return torch.nn.functional.pad(x, flat)
kernel_name = 'adaLN_cond__ssm_conv_h3__geglu_ffn__prompt'

def setup_inputs():

    _w = lambda a: (lambda t: t.to(torch.bfloat16) if t.is_floating_point() else t)(torch.as_tensor(a))

    def _A_setup():
        B, S, D = (1, 2048, 576)
        ks = 4
        return {'q': _w((lambda *s: torch.randn(*s, dtype=torch.bfloat16) * 0.05)(B, S, D)), 'k': _w((lambda *s: torch.randn(*s, dtype=torch.bfloat16) * 0.8)(B, S, D)), 'v': _w((lambda *s: torch.randn(*s, dtype=torch.bfloat16) * 0.8)(B, S, D)), 'shift_k': _w((lambda *s: torch.randn(*s, dtype=torch.bfloat16) * 0.8)(D, ks) * 0.5), 'ssm_k': _w((lambda *s: torch.randn(*s, dtype=torch.bfloat16) * 0.8)(D, S) * (1.0 / S ** 0.5)), 'ssm_D': _w((lambda *s: torch.randn(*s, dtype=torch.bfloat16) * 0.8)(D))}
    _A_in = _A_setup()

    def _B_setup():
        B, S, D, F = (1, 2048, 576, 4608)
        return {'x': _w((lambda *s: torch.randn(*s, dtype=torch.bfloat16) * 0.05)(B, S, D)), 'w_gate': _w((lambda *s: torch.randn(*s, dtype=torch.bfloat16) * 0.05)(D, F)), 'w_up': _w((lambda *s: torch.randn(*s, dtype=torch.bfloat16) * 0.05)(D, F)), 'w_down': _w((lambda *s: torch.randn(*s, dtype=torch.bfloat16) * 0.05)(F, D))}
    _B_in = _B_setup()
    return {'A_q': _A_in['q'], 'A_k': _A_in['k'], 'A_v': _A_in['v'], 'A_shift_k': _A_in['shift_k'], 'A_ssm_k': _A_in['ssm_k'], 'A_ssm_D': _A_in['ssm_D'], 'B_x': _B_in['x'], 'B_w_gate': _B_in['w_gate'], 'B_w_up': _B_in['w_up'], 'B_w_down': _B_in['w_down'], 'c': _w((lambda *s: torch.randn(*s, dtype=torch.bfloat16) * 0.1)(1, 576) * 8.0), 'w_mod': _w((lambda *s: torch.randn(*s, dtype=torch.bfloat16) * 0.1)(576, 6 * 576) * 576 ** (-0.5) * 8.0)}

def reference(A_q, A_k, A_v, A_shift_k, A_ssm_k, A_ssm_D, B_x, B_w_gate, B_w_up, B_w_down, c, w_mod):

    def _A_ref(q, k, v, shift_k, ssm_k, ssm_D):
        B, S, D = q.shape
        ks = shift_k.shape[-1]
        k_pad = _pad(k, ((0, 0), (ks - 1, 0), (0, 0)))
        k_shift = torch.zeros_like(k)
        for t in range(ks):
            k_shift = k_shift + k_pad[:, t:t + S, :] * shift_k[:, ks - 1 - t][None, None, :]
        kv = k_shift * v
        L = 2 * S
        kv_pad = _pad(kv, ((0, 0), (0, S), (0, 0)))
        kf_pad = _pad(ssm_k, ((0, 0), (0, S)))
        kv_f = (lambda x, axes=(-2, -1): torch.fft.rfft2(x.float(), dim=axes))(kv_pad[:, None, :, :], axes=(1, 2))
        kf_f = (lambda x, axes=(-2, -1): torch.fft.rfft2(x.float(), dim=axes))(kf_pad[:, None, :], axes=(1, 2))
        kf_f = (lambda x, *d: x.permute(*d))(kf_f, 1, 2, 0)
        y_f = kv_f * kf_f[None, :, :, :]
        y = (lambda x, s, axes=(-2, -1): torch.fft.irfft2(x, s=s, dim=axes).to(torch.bfloat16))(y_f, (1, L), axes=(1, 2))[:, 0, :S, :]
        y = y + kv * ssm_D[None, None, :]
        return q * y

    def _B_ref(x, w_gate, w_up, w_down):
        return _gelu(x @ w_gate) * (x @ w_up) @ w_down
    x = A_q
    mod = (_silu(c) @ w_mod).reshape(c.shape[0], 6, 1, -1)
    sa, ca, ga, sb, cb, gb = (mod[:, 0].clone(), mod[:, 1].clone(), mod[:, 2].clone(), mod[:, 3].clone(), mod[:, 4].clone(), mod[:, 5].clone())
    h = _layernorm(x, axis=-1) * (1 + ca) + sa
    x = x + ga * _A_ref(h, A_k, A_v, A_shift_k, A_ssm_k, A_ssm_D)
    h = _layernorm(x, axis=-1) * (1 + cb) + sb
    x = x + gb * _B_ref(h, B_w_gate, B_w_up, B_w_down)
    return x
```

```asm
; @launch grid=(256,1,1) block=(512,1,1) lds=163840
.amdgcn_target "amdgcn-amd-amdhsa--gfx950"
.text
.globl adaLN_cond__ssm_conv_h3__geglu_ffn__prompt_kernel
.p2align 8
.type adaLN_cond__ssm_conv_h3__geglu_ffn__prompt_kernel,@function
adaLN_cond__ssm_conv_h3__geglu_ffn__prompt_kernel:
    s_cmp_ge_u32 s2, 256
    s_cbranch_scc1 L_done
    s_load_dwordx16 s[4:19], s[0:1], 0
    s_load_dwordx8 s[20:27], s[0:1], 64
    s_load_dwordx2 s[28:29], s[0:1], 96
    s_load_dwordx2 s[30:31], s[0:1], 112
    v_and_b32 v1, 63, v0
    v_lshrrev_b32 v2, 6, v0
    s_mov_b32 s92, 0xffff0000
    s_mov_b32 s93, 20000
    v_readfirstlane_b32 s90, v2
    v_mov_b32 v8, 0
    v_mov_b32 v9, 0
    s_and_b32 s39, s2, 7
    s_lshr_b32 s40, s2, 3
    s_and_b32 s52, s40, 3
    s_lshl_b32 s39, s39, 2
    s_add_u32 s39, s39, s52
    s_lshr_b32 s40, s40, 2
    s_and_b32 s52, s90, 3
    s_mul_i32 s52, s52, 73728
    s_lshr_b32 s53, s39, 1
    s_mul_i32 s53, s53, 576
    s_add_u32 s53, s53, s52
    s_and_b32 s54, s39, 1
    s_lshl_b32 s55, s54, 8
    s_add_u32 s55, s55, s53
    s_lshl_b32 s54, s54, 5
    s_add_u32 s54, s54, 512
    s_add_u32 s54, s54, s53
    s_sub_u32 s54, s54, 256
    v_mul_u32_u24 v5, 3641, v1
    v_lshrrev_b32 v5, 16, v5
    v_mul_u32_u24 v6, 18, v5
    v_sub_u32 v6, v1, v6
    v_mul_u32_u24 v5, 9216, v5
    v_mov_b32 v7, s55
    v_mov_b32 v13, s54
    v_cmp_lt_u32 vcc, 15, v6
    v_lshlrev_b32 v6, 4, v6
    s_nop 0
    v_cndmask_b32 v7, v7, v13, vcc
    v_add3_u32 v10, v5, v6, v7
    v_add_u32 v4, 64, v1
    v_mul_u32_u24 v5, 3641, v4
    v_lshrrev_b32 v5, 16, v5
    v_mul_u32_u24 v6, 18, v5
    v_sub_u32 v6, v4, v6
    v_mul_u32_u24 v5, 9216, v5
    v_mov_b32 v7, s55
    v_mov_b32 v13, s54
    v_cmp_lt_u32 vcc, 15, v6
    v_lshlrev_b32 v6, 4, v6
    s_nop 0
    v_cndmask_b32 v7, v7, v13, vcc
    v_add3_u32 v11, v5, v6, v7
    v_subrev_u32 v11, 1024, v11
    v_add_u32 v4, 128, v1
    v_mul_u32_u24 v5, 3641, v4
    v_lshrrev_b32 v5, 16, v5
    v_mul_u32_u24 v6, 18, v5
    v_sub_u32 v6, v4, v6
    v_mul_u32_u24 v5, 9216, v5
    v_mov_b32 v7, s55
    v_mov_b32 v13, s54
    v_cmp_lt_u32 vcc, 15, v6
    v_lshlrev_b32 v6, 4, v6
    s_nop 0
    v_cndmask_b32 v7, v7, v13, vcc
    v_add3_u32 v12, v5, v6, v7
    v_subrev_u32 v12, 2048, v12
    s_lshr_b32 s38, s90, 2
    s_mul_i32 s38, s38, 9216
    s_and_b32 s52, s90, 3
    s_mul_i32 s52, s52, 2304
    s_add_u32 s38, s38, s52
    s_mov_b32 s36, 0
    s_mov_b32 s37, 0
    s_mov_b32 s94, s39
    s_mov_b32 s95, s40
    s_mul_i32 s52, s2, 3
    s_add_u32 s52, s52, s90
    s_lshl_b32 s53, s2, 1
    s_add_u32 s53, s53, 64
    s_add_u32 s53, s53, s90
    s_cmp_lt_u32 s2, 64
    s_cselect_b32 s41, s52, s53
    s_cselect_b32 s52, 3, 2
    s_cmp_lt_u32 s90, s52
    s_cselect_b32 s41, s41, -1
    s_and_b32 s52, s2, 7
    s_lshr_b32 s53, s2, 3
    s_lshl_b32 s52, s52, 5
    s_add_u32 s3, s52, s53
    s_waitcnt lgkmcnt(0)
    s_add_u32 s52, s30, 9961472
    s_addc_u32 s53, s31, 0
    s_load_dword s91, s[52:53], 0
    s_mov_b32 s96, s52
    s_mov_b32 s97, s53
    s_mov_b32 s98, 270336
    s_mov_b32 s99, 0x20000
    v_mov_b32 v2, 139008
    v_mov_b32 v3, 0
    v_mov_b32 v4, 0
    v_mov_b32 v5, 0
    v_mov_b32 v6, 0
    s_mov_b64 exec, 1
    ds_write_b64 v2, v[4:5]
    ds_write_b64 v2, v[4:5] offset:8
    v_mov_b32 v3, 163776
    ds_write_b64 v3, v[4:5]
    ds_write_b64 v3, v[4:5] offset:8
    s_mov_b64 exec, -1
    s_waitcnt lgkmcnt(0)
    s_barrier
    s_cmp_ge_u32 s90, 5
    s_cbranch_scc1 Lp1i_1
    v_mul_u32_u24 v2, 7282, v0
    v_lshrrev_b32 v2, 16, v2
    v_mul_u32_u24 v3, 9, v2
    v_sub_u32 v3, v0, v3
    s_and_b32 s52, s2, 31
    s_lshr_b32 s53, s2, 5
    s_lshl_b32 s52, s52, 6
    s_mul_i32 s53, s53, 144
    v_lshlrev_b32 v4, 1, v2
    v_add_u32 v4, s52, v4
    v_lshlrev_b32 v5, 4, v3
    v_add_u32 v5, s53, v5
    v_mul_u32_u24 v6, 1152, v4
    v_add_u32 v6, v6, v5
    v_lshlrev_b32 v7, 2, v5
    v_subrev_u32 v100, 3456, v6
    v_subrev_u32 v101, 2304, v6
    v_subrev_u32 v102, 1152, v6
    v_sub_u32 v8, 31, v2
    v_and_b32 v9, 7, v3
    v_lshlrev_b32 v9, 2, v9
    v_xor_b32 v8, v8, v9
    v_lshlrev_b32 v8, 2, v8
    v_mul_u32_u24 v9, 1152, v3
    v_add3_u32 v8, v8, v9, 0
    v_add_u32 v8, 139520, v8
    v_cmp_gt_u32 vcc, 288, v0
    s_mov_b64 exec, vcc
    s_mov_b32 s44, s6
    s_mov_b32 s45, s7
    s_mov_b32 s46, 2359296
    s_mov_b32 s47, 0x20000
    s_mov_b32 s48, s8
    s_mov_b32 s49, s9
    s_mov_b32 s50, 2359296
    s_mov_b32 s51, 0x20000
    s_mov_b32 s52, s10
    s_mov_b32 s53, s11
    s_mov_b32 s54, 4608
    s_mov_b32 s55, 0x20000
    buffer_load_dwordx4 v[64:67], v100, s[44:47], 0 offen
    buffer_load_dwordx4 v[68:71], v101, s[44:47], 0 offen
    buffer_load_dwordx4 v[72:75], v102, s[44:47], 0 offen
    buffer_load_dwordx4 v[76:79], v6, s[44:47], 0 offen offset:0
    buffer_load_dwordx4 v[80:83], v6, s[44:47], 0 offen offset:1152
    buffer_load_dwordx4 v[92:95], v7, s[52:55], 0 offen offset:0
    buffer_load_dwordx4 v[96:99], v7, s[52:55], 0 offen offset:16
    buffer_load_dwordx4 v[100:103], v7, s[52:55], 0 offen offset:32
    buffer_load_dwordx4 v[104:107], v7, s[52:55], 0 offen offset:48
    buffer_load_dwordx4 v[84:87], v6, s[48:51], 0 offen offset:0
    buffer_load_dwordx4 v[88:91], v6, s[48:51], 0 offen offset:1152
    s_mov_b64 exec, -1
Lp1i_1:
    s_cmp_lt_u32 s90, 5
    s_cbranch_scc1 Lq5_2
    v_and_b32 v2, 7, v0
    v_lshrrev_b32 v5, 3, v0
    s_lshl_b32 s52, s3, 3
    v_add_u32 v6, s52, v2
    v_mul_u32_u24 v7, 1152, v6
    v_lshlrev_b32 v5, 4, v5
    v_add_u32 v7, v7, v5
    s_mov_b32 s44, s4
    s_mov_b32 s45, s5
    s_mov_b32 s46, 2359296
    s_mov_b32 s47, 0x20000
    buffer_load_dwordx4 v[252:255], v7, s[44:47], 0 offen
    s_cmp_eq_u32 s90, 0
    s_cbranch_scc0 LB_3
    buffer_load_dwordx4 v[196:199], v7, s[44:47], 0 offen offset:1024
LB_3:
Lq5_2:
    s_cmp_lt_u32 s90, 4
    s_cselect_b32 s32, s18, s20
    s_cselect_b32 s33, s19, s21
    s_mov_b32 s34, 5308416
    s_mov_b32 s35, 0x20000
    s_waitcnt lgkmcnt(0)
    s_add_u32 s91, s91, 1
    s_cmp_ge_u32 s90, 5
    s_cbranch_scc1 Lp1c_4
    s_waitcnt vmcnt(2)
    v_and_b32 v2, 7, v0
    v_lshrrev_b32 v5, 3, v0
    s_lshl_b32 s52, s3, 3
    v_add_u32 v6, s52, v2
    v_mul_u32_u24 v7, 1152, v6
    v_lshlrev_b32 v5, 4, v5
    v_add_u32 v7, v7, v5
    s_mov_b32 s44, s4
    s_mov_b32 s45, s5
    s_mov_b32 s46, 2359296
    s_mov_b32 s47, 0x20000
    buffer_load_dwordx4 v[252:255], v7, s[44:47], 0 offen
    s_cmp_eq_u32 s90, 0
    s_cbranch_scc0 LB_5
    buffer_load_dwordx4 v[196:199], v7, s[44:47], 0 offen offset:1024
LB_5:
    s_cmp_eq_u32 s41, -1
    s_cbranch_scc1 Lnoh_6
    s_mov_b32 s44, s12
    s_mov_b32 s45, s13
    s_mov_b32 s46, 2359296
    s_mov_b32 s47, 0x20000
    s_lshl_b32 s52, s41, 12
    v_lshlrev_b32 v2, 4, v1
    buffer_load_dwordx4 v[200:203], v2, s[44:47], s52 offen offset:0
    buffer_load_dwordx4 v[204:207], v2, s[44:47], s52 offen offset:4
    buffer_load_dwordx4 v[208:211], v2, s[44:47], s52 offen offset:8
    buffer_load_dwordx4 v[212:215], v2, s[44:47], s52 offen offset:1024
    buffer_load_dwordx4 v[216:219], v2, s[44:47], s52 offen offset:1028
    buffer_load_dwordx4 v[220:223], v2, s[44:47], s52 offen offset:1032
    buffer_load_dwordx4 v[224:227], v2, s[44:47], s52 offen offset:2048
    buffer_load_dwordx4 v[228:231], v2, s[44:47], s52 offen offset:2052
    buffer_load_dwordx4 v[232:235], v2, s[44:47], s52 offen offset:2056
    buffer_load_dwordx4 v[236:239], v2, s[44:47], s52 offen offset:3072
    buffer_load_dwordx4 v[240:243], v2, s[44:47], s52 offen offset:3076
    buffer_load_dwordx4 v[244:247], v2, s[44:47], s52 offen offset:3080
    v_lshrrev_b32 v4, 3, v1
    v_and_b32 v5, 7, v1
    v_lshlrev_b32 v5, 1, v5
    v_add_u32 v6, v4, v5
    v_subrev_u32 v6, 16, v6
    v_lshlrev_b32 v7, 1, v6
    v_mov_b32 v248, 0
    v_mov_b32 v249, 0
    v_cmp_gt_u32 vcc, 32, v1
    s_mov_b64 s[54:55], vcc
    v_cmp_le_i32 vcc, 0, v6
    s_and_b64 s[56:57], vcc, s[54:55]
    v_cmp_le_i32 vcc, -1, v6
    s_and_b64 s[58:59], vcc, s[54:55]
    s_mov_b64 exec, s[56:57]
    buffer_load_short_d16 v248, v7, s[44:47], s52 offen
    s_mov_b64 exec, s[58:59]
    v_add_u32 v7, 2, v7
    buffer_load_short_d16_hi v249, v7, s[44:47], s52 offen
    s_mov_b64 exec, -1
    s_lshr_b32 s52, s41, 1
    s_lshl_b32 s52, s52, 2
    s_add_u32 s54, s14, s52
    s_addc_u32 s55, s15, 0
    s_load_dword s42, s[54:55], 0
Lnoh_6:
    v_lshlrev_b32 v164, 16, v92
    v_lshlrev_b32 v165, 16, v94
    v_and_b32 v166, s92, v92
    v_and_b32 v167, s92, v94
    v_lshlrev_b32 v168, 16, v93
    v_lshlrev_b32 v169, 16, v95
    v_and_b32 v170, s92, v93
    v_and_b32 v171, s92, v95
    v_lshlrev_b32 v172, 16, v96
    v_lshlrev_b32 v173, 16, v98
    v_and_b32 v174, s92, v96
    v_and_b32 v175, s92, v98
    v_lshlrev_b32 v176, 16, v97
    v_lshlrev_b32 v177, 16, v99
    v_and_b32 v178, s92, v97
    v_and_b32 v179, s92, v99
    v_lshlrev_b32 v180, 16, v100
    v_lshlrev_b32 v181, 16, v102
    v_and_b32 v182, s92, v100
    v_and_b32 v183, s92, v102
    v_lshlrev_b32 v184, 16, v101
    v_lshlrev_b32 v185, 16, v103
    v_and_b32 v186, s92, v101
    v_and_b32 v187, s92, v103
    v_lshlrev_b32 v188, 16, v104
    v_lshlrev_b32 v189, 16, v106
    v_and_b32 v190, s92, v104
    v_and_b32 v191, s92, v106
    v_lshlrev_b32 v192, 16, v105
    v_lshlrev_b32 v193, 16, v107
    v_and_b32 v194, s92, v105
    v_and_b32 v195, s92, v107
    v_lshlrev_b32 v108, 16, v64
    v_and_b32 v109, s92, v64
    v_lshlrev_b32 v110, 16, v65
    v_and_b32 v111, s92, v65
    v_lshlrev_b32 v112, 16, v66
    v_and_b32 v113, s92, v66
    v_lshlrev_b32 v114, 16, v67
    v_and_b32 v115, s92, v67
    v_lshlrev_b32 v116, 16, v68
    v_and_b32 v117, s92, v68
    v_lshlrev_b32 v118, 16, v69
    v_and_b32 v119, s92, v69
    v_lshlrev_b32 v120, 16, v70
    v_and_b32 v121, s92, v70
    v_lshlrev_b32 v122, 16, v71
    v_and_b32 v123, s92, v71
    v_lshlrev_b32 v124, 16, v72
    v_and_b32 v125, s92, v72
    v_lshlrev_b32 v126, 16, v73
    v_and_b32 v127, s92, v73
    v_lshlrev_b32 v128, 16, v74
    v_and_b32 v129, s92, v74
    v_lshlrev_b32 v130, 16, v75
    v_and_b32 v131, s92, v75
    v_lshlrev_b32 v132, 16, v76
    v_and_b32 v133, s92, v76
    v_lshlrev_b32 v134, 16, v77
    v_and_b32 v135, s92, v77
    v_lshlrev_b32 v136, 16, v78
    v_and_b32 v137, s92, v78
    v_lshlrev_b32 v138, 16, v79
    v_and_b32 v139, s92, v79
    v_lshlrev_b32 v140, 16, v80
    v_and_b32 v141, s92, v80
    v_lshlrev_b32 v142, 16, v81
    v_and_b32 v143, s92, v81
    v_lshlrev_b32 v144, 16, v82
    v_and_b32 v145, s92, v82
    v_lshlrev_b32 v146, 16, v83
    v_and_b32 v147, s92, v83
    v_pk_mul_f32 v[16:17], v[108:109], v[170:171]
    v_pk_mul_f32 v[18:19], v[110:111], v[178:179]
    v_pk_mul_f32 v[20:21], v[112:113], v[186:187]
    v_pk_mul_f32 v[22:23], v[114:115], v[194:195]
    v_pk_mul_f32 v[24:25], v[116:117], v[170:171]
    v_pk_mul_f32 v[26:27], v[118:119], v[178:179]
    v_pk_mul_f32 v[28:29], v[120:121], v[186:187]
    v_pk_mul_f32 v[30:31], v[122:123], v[194:195]
    v_pk_fma_f32 v[16:17], v[116:117], v[168:169], v[16:17]
    v_pk_fma_f32 v[18:19], v[118:119], v[176:177], v[18:19]
    v_pk_fma_f32 v[20:21], v[120:121], v[184:185], v[20:21]
    v_pk_fma_f32 v[22:23], v[122:123], v[192:193], v[22:23]
    v_pk_fma_f32 v[24:25], v[124:125], v[168:169], v[24:25]
    v_pk_fma_f32 v[26:27], v[126:127], v[176:177], v[26:27]
    v_pk_fma_f32 v[28:29], v[128:129], v[184:185], v[28:29]
    v_pk_fma_f32 v[30:31], v[130:131], v[192:193], v[30:31]
    v_pk_fma_f32 v[16:17], v[124:125], v[166:167], v[16:17]
    v_pk_fma_f32 v[18:19], v[126:127], v[174:175], v[18:19]
    v_pk_fma_f32 v[20:21], v[128:129], v[182:183], v[20:21]
    v_pk_fma_f32 v[22:23], v[130:131], v[190:191], v[22:23]
    v_pk_fma_f32 v[24:25], v[132:133], v[166:167], v[24:25]
    v_pk_fma_f32 v[26:27], v[134:135], v[174:175], v[26:27]
    v_pk_fma_f32 v[28:29], v[136:137], v[182:183], v[28:29]
    v_pk_fma_f32 v[30:31], v[138:139], v[190:191], v[30:31]
    v_pk_fma_f32 v[16:17], v[132:133], v[164:165], v[16:17]
    v_pk_fma_f32 v[18:19], v[134:135], v[172:173], v[18:19]
    v_pk_fma_f32 v[20:21], v[136:137], v[180:181], v[20:21]
    v_pk_fma_f32 v[22:23], v[138:139], v[188:189], v[22:23]
    v_pk_fma_f32 v[24:25], v[140:141], v[164:165], v[24:25]
    v_pk_fma_f32 v[26:27], v[142:143], v[172:173], v[26:27]
    v_pk_fma_f32 v[28:29], v[144:145], v[180:181], v[28:29]
    v_pk_fma_f32 v[30:31], v[146:147], v[188:189], v[30:31]
    s_cmp_eq_u32 s41, -1
    s_cbranch_scc1 Lw2_8
    s_cmp_eq_u32 s90, 0
    s_cbranch_scc0 Lw1_7
    s_waitcnt vmcnt(16)
    s_branch Lwe_10
Lw1_7:
    s_waitcnt vmcnt(15)
    s_branch Lwe_10
Lw2_8:
    s_waitcnt vmcnt(1)
Lwe_10:
    v_lshlrev_b32 v148, 16, v84
    v_and_b32 v149, s92, v84
    v_lshlrev_b32 v150, 16, v85
    v_and_b32 v151, s92, v85
    v_lshlrev_b32 v152, 16, v86
    v_and_b32 v153, s92, v86
    v_lshlrev_b32 v154, 16, v87
    v_and_b32 v155, s92, v87
    v_lshlrev_b32 v156, 16, v88
    v_and_b32 v157, s92, v88
    v_lshlrev_b32 v158, 16, v89
    v_and_b32 v159, s92, v89
    v_lshlrev_b32 v160, 16, v90
    v_and_b32 v161, s92, v90
    v_lshlrev_b32 v162, 16, v91
    v_and_b32 v163, s92, v91
    v_pk_mul_f32 v[16:17], v[16:17], v[148:149]
    v_pk_mul_f32 v[18:19], v[18:19], v[150:151]
    v_pk_mul_f32 v[20:21], v[20:21], v[152:153]
    v_pk_mul_f32 v[22:23], v[22:23], v[154:155]
    v_pk_mul_f32 v[24:25], v[24:25], v[156:157]
    v_pk_mul_f32 v[26:27], v[26:27], v[158:159]
    v_pk_mul_f32 v[28:29], v[28:29], v[160:161]
    v_pk_mul_f32 v[30:31], v[30:31], v[162:163]
    v_cvt_pk_bf16_f32 v32, v24, v16
    v_cvt_pk_bf16_f32 v33, v25, v17
    v_cvt_pk_bf16_f32 v34, v26, v18
    v_cvt_pk_bf16_f32 v35, v27, v19
    v_cvt_pk_bf16_f32 v36, v28, v20
    v_cvt_pk_bf16_f32 v37, v29, v21
    v_cvt_pk_bf16_f32 v38, v30, v22
    v_cvt_pk_bf16_f32 v39, v31, v23
    s_mov_b32 s44, s30
    s_mov_b32 s45, s31
    s_mov_b32 s46, 2433024
    s_mov_b32 s47, 0x20000
    s_lshr_b32 s58, s2, 5
    s_mul_i32 s58, s58, 304128
    s_and_b32 s59, s2, 31
    s_lshl_b32 s59, s59, 7
    s_sub_u32 s58, s58, s59
    s_add_u32 s58, s58, 3968
    s_mov_b32 s59, 139520
    v_cmp_gt_u32 vcc, 288, v0
    s_mov_b64 exec, vcc
    ds_write_b32 v8, v32 offset:0
    ds_write_b32 v8, v33 offset:144
    ds_write_b32 v8, v34 offset:288
    ds_write_b32 v8, v35 offset:432
    ds_write_b32 v8, v36 offset:576
    ds_write_b32 v8, v37 offset:720
    ds_write_b32 v8, v38 offset:864
    ds_write_b32 v8, v39 offset:1008
    s_mov_b64 exec, -1
    s_waitcnt lgkmcnt(0)
    v_mov_b32 v2, 139012
    v_mov_b32 v3, 1
    s_mov_b64 exec, 1
    ds_add_u32 v2, v3
    s_mov_b64 exec, -1
    v_mov_b32 v2, 139012
    s_mov_b32 s61, 0
Lsp_11:
    ds_read_b32 v3, v2
    s_waitcnt lgkmcnt(0)
    v_readfirstlane_b32 s60, v3
    s_nop 0
    s_cmp_ge_u32 s60, 5
    s_cbranch_scc1 Lspd_12
    s_add_u32 s61, s61, 1
    s_cmp_lt_u32 s61, 0x40000
    s_cbranch_scc1 Lsp_11
Lspd_12:
    v_lshrrev_b32 v2, 3, v0
    v_and_b32 v3, 7, v0
    v_bfe_u32 v7, v2, 3, 3
    v_xor_b32 v7, v7, v3
    v_lshlrev_b32 v7, 4, v7
    v_mul_u32_u24 v4, 144, v2
    v_add3_u32 v4, v4, v7, s59
    ds_read_b128 v[64:67], v4
    v_mul_u32_u24 v5, 4224, v2
    v_lshlrev_b32 v7, 4, v3
    v_add3_u32 v5, v5, v7, s58
    v_add_u32 v2, 36, v2
    v_bfe_u32 v7, v2, 3, 3
    v_xor_b32 v7, v7, v3
    v_lshlrev_b32 v7, 4, v7
    v_mul_u32_u24 v4, 144, v2
    v_add3_u32 v4, v4, v7, s59
    ds_read_b128 v[68:71], v4
    v_mul_u32_u24 v6, 4224, v2
    v_lshlrev_b32 v7, 4, v3
    v_add3_u32 v6, v6, v7, s58
    v_cmp_gt_u32 vcc, 288, v0
    s_mov_b64 exec, vcc
    s_waitcnt lgkmcnt(0)
    buffer_store_dwordx4 v[64:67], v5, s[44:47], 0 offen sc1
    buffer_store_dwordx4 v[68:71], v6, s[44:47], 0 offen sc1
    s_mov_b64 exec, -1
    s_waitcnt vmcnt(0)
    v_mov_b32 v2, 139016
    v_mov_b32 v3, 1
    s_mov_b64 exec, 1
    ds_add_rtn_u32 v3, v2, v3
    s_waitcnt lgkmcnt(0)
    v_readfirstlane_b32 s58, v3
    s_nop 0
    s_mov_b64 exec, -1
    s_cmp_eq_u32 s58, 4
    s_cbranch_scc0 Lpub_13
    s_lshl_b32 s60, s2, 4
    s_add_u32 s60, s60, 33792
    v_mul_u32_u24 v2, 4224, v1
    v_add_u32 v2, s60, v2
    v_mov_b32 v3, s91
    s_mov_b64 exec, 0xff
    buffer_store_dword v3, v2, s[96:99], 0 offen sc1
    s_mov_b64 exec, -1
Lpub_13:
Lp1c_4:
    s_cmp_eq_u32 s90, 7
    s_cbranch_scc0 L7_14
    v_mov_b32 v2, 139012
    s_mov_b32 s61, 0
Lsp_15:
    ds_read_b32 v3, v2
    s_waitcnt lgkmcnt(0)
    v_readfirstlane_b32 s60, v3
    s_nop 0
    s_cmp_ge_u32 s60, 1
    s_cbranch_scc1 Lspd_16
    s_add_u32 s61, s61, 1
    s_cmp_lt_u32 s61, 0x40000
    s_cbranch_scc1 Lsp_15
Lspd_16:
L7_14:
    s_cmp_eq_u32 s90, 7
    s_cbranch_scc0 Lw7_17
    v_and_b32 v2, 7, v1
    v_lshrrev_b32 v5, 3, v1
    s_lshl_b32 s52, s3, 3
    v_add_u32 v6, s52, v2
    v_mul_u32_u24 v7, 1152, v6
    v_lshlrev_b32 v5, 4, v5
    v_add_u32 v7, v7, v5
    s_mov_b32 s44, s4
    s_mov_b32 s45, s5
    s_mov_b32 s46, 2359296
    s_mov_b32 s47, 0x20000
    buffer_load_dwordx4 v[40:43], v7, s[44:47], 0 offen offset:0
    buffer_load_dwordx4 v[44:47], v7, s[44:47], 0 offen offset:128
    buffer_load_dwordx4 v[48:51], v7, s[44:47], 0 offen offset:256
    buffer_load_dwordx4 v[52:55], v7, s[44:47], 0 offen offset:384
    buffer_load_dwordx4 v[56:59], v7, s[44:47], 0 offen offset:512
    buffer_load_dwordx4 v[60:63], v7, s[44:47], 0 offen offset:640
    buffer_load_dwordx4 v[64:67], v7, s[44:47], 0 offen offset:768
    buffer_load_dwordx4 v[68:71], v7, s[44:47], 0 offen offset:896
    buffer_load_dwordx4 v[72:75], v7, s[44:47], 0 offen offset:1024
Lw7_17:
    s_cmp_eq_u32 s90, 5
    s_cbranch_scc0 Lcp_18
    s_cmp_lt_u32 s2, 128
    s_cbranch_scc1 Lcp_18
    v_mov_b32 v2, 139012
    s_mov_b32 s61, 0
Lsp_19:
    ds_read_b32 v3, v2
    s_waitcnt lgkmcnt(0)
    v_readfirstlane_b32 s60, v3
    s_nop 0
    s_cmp_ge_u32 s60, 1
    s_cbranch_scc1 Lspd_20
    s_add_u32 s61, s61, 1
    s_cmp_lt_u32 s61, 0x40000
    s_cbranch_scc1 Lsp_19
Lspd_20:
    s_getpc_b64 s[52:53]
L_pc:
    s_sub_u32 s52, s52, (L_pc - adaLN_cond__ssm_conv_h3__geglu_ffn__prompt_kernel)
    s_subb_u32 s53, s53, 0
    v_lshlrev_b32 v2, 7, v1
    global_load_dword v16, v2, s[52:53]
    v_add_u32 v2, 8192, v2
    global_load_dword v17, v2, s[52:53]
    v_add_u32 v2, 8192, v2
    global_load_dword v18, v2, s[52:53]
    v_add_u32 v2, 8192, v2
    global_load_dword v19, v2, s[52:53]
    v_add_u32 v2, 8192, v2
    global_load_dword v20, v2, s[52:53]
    v_add_u32 v2, 8192, v2
Lcp_18:
    s_sub_u32 s52, s90, 5
    s_cmp_lt_u32 s52, 2
    s_cbranch_scc0 Lmod_21
    s_cmp_ge_u32 s2, 108
    s_cbranch_scc1 Lmod_21
    s_sub_u32 s52, s90, 5
    s_mul_i32 s54, s2, 2428
    s_lshr_b32 s54, s54, 16
    s_mul_i32 s55, s54, 27
    s_sub_u32 s55, s2, s55
    s_mul_i32 s53, s54, 144
    s_mul_i32 s52, s52, 72
    s_add_u32 s53, s53, s52
    v_lshrrev_b32 v4, 4, v1
    v_add_u32 v4, s53, v4
    v_and_b32 v3, 15, v1
    s_lshl_b32 s52, s55, 8
    v_mul_u32_u24 v5, 6912, v4
    v_lshlrev_b32 v6, 4, v3
    v_add3_u32 v5, v5, v6, s52
    v_lshlrev_b32 v6, 1, v4
    s_mov_b32 s44, s24
    s_mov_b32 s45, s25
    s_mov_b32 s46, 1152
    s_mov_b32 s47, 0x20000
    s_mov_b32 s48, s26
    s_mov_b32 s49, s27
    s_mov_b32 s50, 3981312
    s_mov_b32 s51, 0x20000
    v_mov_b32 v124, 0
    v_mov_b32 v125, 0
    v_mov_b32 v126, 0
    v_mov_b32 v127, 0
    v_mov_b32 v128, 0
    v_mov_b32 v129, 0
    v_mov_b32 v130, 0
    v_mov_b32 v131, 0
    v_mov_b32 v132, 0
    v_mov_b32 v133, 0
    v_mov_b32 v134, 0
    v_mov_b32 v135, 0
    v_mov_b32 v136, 0
    v_mov_b32 v137, 0
    v_mov_b32 v138, 0
    v_mov_b32 v139, 0
    v_mov_b32 v140, 0
    v_mov_b32 v141, 0
    buffer_load_short_d16_hi v124, v6, s[44:47], 0 offen offset:0
    buffer_load_short_d16_hi v125, v6, s[44:47], 0 offen offset:8
    buffer_load_short_d16_hi v126, v6, s[44:47], 0 offen offset:16
    buffer_load_short_d16_hi v127, v6, s[44:47], 0 offen offset:24
    buffer_load_short_d16_hi v128, v6, s[44:47], 0 offen offset:32
    buffer_load_short_d16_hi v129, v6, s[44:47], 0 offen offset:40
    buffer_load_short_d16_hi v130, v6, s[44:47], 0 offen offset:48
    buffer_load_short_d16_hi v131, v6, s[44:47], 0 offen offset:56
    buffer_load_short_d16_hi v132, v6, s[44:47], 0 offen offset:64
    buffer_load_short_d16_hi v133, v6, s[44:47], 0 offen offset:72
    buffer_load_short_d16_hi v134, v6, s[44:47], 0 offen offset:80
    buffer_load_short_d16_hi v135, v6, s[44:47], 0 offen offset:88
    buffer_load_short_d16_hi v136, v6, s[44:47], 0 offen offset:96
    buffer_load_short_d16_hi v137, v6, s[44:47], 0 offen offset:104
    buffer_load_short_d16_hi v138, v6, s[44:47], 0 offen offset:112
    buffer_load_short_d16_hi v139, v6, s[44:47], 0 offen offset:120
    buffer_load_short_d16_hi v140, v6, s[44:47], 0 offen offset:128
    buffer_load_short_d16_hi v141, v6, s[44:47], 0 offen offset:136
    s_mov_b32 s53, 0
    buffer_load_dwordx4 v[40:43], v5, s[48:51], s53 offen
    s_mov_b32 s53, 27648
    buffer_load_dwordx4 v[44:47], v5, s[48:51], s53 offen
    s_mov_b32 s53, 55296
    buffer_load_dwordx4 v[48:51], v5, s[48:51], s53 offen
    s_mov_b32 s53, 82944
    buffer_load_dwordx4 v[52:55], v5, s[48:51], s53 offen
    s_mov_b32 s53, 110592
    buffer_load_dwordx4 v[56:59], v5, s[48:51], s53 offen
    s_mov_b32 s53, 138240
    buffer_load_dwordx4 v[60:63], v5, s[48:51], s53 offen
    s_mov_b32 s53, 165888
    buffer_load_dwordx4 v[64:67], v5, s[48:51], s53 offen
    s_mov_b32 s53, 193536
    buffer_load_dwordx4 v[68:71], v5, s[48:51], s53 offen
    s_mov_b32 s53, 221184
    buffer_load_dwordx4 v[72:75], v5, s[48:51], s53 offen
    s_mov_b32 s53, 248832
    buffer_load_dwordx4 v[76:79], v5, s[48:51], s53 offen
    s_mov_b32 s53, 276480
    buffer_load_dwordx4 v[80:83], v5, s[48:51], s53 offen
    s_mov_b32 s53, 304128
    buffer_load_dwordx4 v[84:87], v5, s[48:51], s53 offen
    s_mov_b32 s53, 331776
    buffer_load_dwordx4 v[88:91], v5, s[48:51], s53 offen
    s_mov_b32 s53, 359424
    buffer_load_dwordx4 v[92:95], v5, s[48:51], s53 offen
    s_mov_b32 s53, 387072
    buffer_load_dwordx4 v[96:99], v5, s[48:51], s53 offen
    s_mov_b32 s53, 414720
    buffer_load_dwordx4 v[100:103], v5, s[48:51], s53 offen
    s_mov_b32 s53, 442368
    buffer_load_dwordx4 v[104:107], v5, s[48:51], s53 offen
    s_mov_b32 s53, 470016
    buffer_load_dwordx4 v[108:111], v5, s[48:51], s53 offen
    s_waitcnt vmcnt(18)
    v_mul_f32 v160, 0xbfb8aa3b, v124
    v_mul_f32 v161, 0xbfb8aa3b, v125
    v_mul_f32 v162, 0xbfb8aa3b, v126
    v_mul_f32 v163, 0xbfb8aa3b, v127
    v_mul_f32 v164, 0xbfb8aa3b, v128
    v_mul_f32 v165, 0xbfb8aa3b, v129
    v_exp_f32 v160, v160
    v_exp_f32 v161, v161
    v_exp_f32 v162, v162
    v_exp_f32 v163, v163
    v_exp_f32 v164, v164
    v_exp_f32 v165, v165
    s_nop 0
    v_add_f32 v160, 1.0, v160
    v_add_f32 v161, 1.0, v161
    v_add_f32 v162, 1.0, v162
    v_add_f32 v163, 1.0, v163
    v_add_f32 v164, 1.0, v164
    v_add_f32 v165, 1.0, v165
    v_rcp_f32 v160, v160
    v_rcp_f32 v161, v161
    v_rcp_f32 v162, v162
    v_rcp_f32 v163, v163
    v_rcp_f32 v164, v164
    v_rcp_f32 v165, v165
    s_nop 0
    v_mul_f32 v124, v160, v124
    v_mul_f32 v125, v161, v125
    v_mul_f32 v126, v162, v126
    v_mul_f32 v127, v163, v127
    v_mul_f32 v128, v164, v128
    v_mul_f32 v129, v165, v129
    v_cvt_pk_bf16_f32 v124, v124, v124
    v_and_b32 v124, s92, v124
    v_cvt_pk_bf16_f32 v125, v125, v125
    v_and_b32 v125, s92, v125
    v_cvt_pk_bf16_f32 v126, v126, v126
    v_and_b32 v126, s92, v126
    v_cvt_pk_bf16_f32 v127, v127, v127
    v_and_b32 v127, s92, v127
    v_cvt_pk_bf16_f32 v128, v128, v128
    v_and_b32 v128, s92, v128
    v_cvt_pk_bf16_f32 v129, v129, v129
    v_and_b32 v129, s92, v129
    v_mul_f32 v160, 0xbfb8aa3b, v130
    v_mul_f32 v161, 0xbfb8aa3b, v131
    v_mul_f32 v162, 0xbfb8aa3b, v132
    v_mul_f32 v163, 0xbfb8aa3b, v133
    v_mul_f32 v164, 0xbfb8aa3b, v134
    v_mul_f32 v165, 0xbfb8aa3b, v135
    v_exp_f32 v160, v160
    v_exp_f32 v161, v161
    v_exp_f32 v162, v162
    v_exp_f32 v163, v163
    v_exp_f32 v164, v164
    v_exp_f32 v165, v165
    s_nop 0
    v_add_f32 v160, 1.0, v160
    v_add_f32 v161, 1.0, v161
    v_add_f32 v162, 1.0, v162
    v_add_f32 v163, 1.0, v163
    v_add_f32 v164, 1.0, v164
    v_add_f32 v165, 1.0, v165
    v_rcp_f32 v160, v160
    v_rcp_f32 v161, v161
    v_rcp_f32 v162, v162
    v_rcp_f32 v163, v163
    v_rcp_f32 v164, v164
    v_rcp_f32 v165, v165
    s_nop 0
    v_mul_f32 v130, v160, v130
    v_mul_f32 v131, v161, v131
    v_mul_f32 v132, v162, v132
    v_mul_f32 v133, v163, v133
    v_mul_f32 v134, v164, v134
    v_mul_f32 v135, v165, v135
    v_cvt_pk_bf16_f32 v130, v130, v130
    v_and_b32 v130, s92, v130
    v_cvt_pk_bf16_f32 v131, v131, v131
    v_and_b32 v131, s92, v131
    v_cvt_pk_bf16_f32 v132, v132, v132
    v_and_b32 v132, s92, v132
    v_cvt_pk_bf16_f32 v133, v133, v133
    v_and_b32 v133, s92, v133
    v_cvt_pk_bf16_f32 v134, v134, v134
    v_and_b32 v134, s92, v134
    v_cvt_pk_bf16_f32 v135, v135, v135
    v_and_b32 v135, s92, v135
    v_mul_f32 v160, 0xbfb8aa3b, v136
    v_mul_f32 v161, 0xbfb8aa3b, v137
    v_mul_f32 v162, 0xbfb8aa3b, v138
    v_mul_f32 v163, 0xbfb8aa3b, v139
    v_mul_f32 v164, 0xbfb8aa3b, v140
    v_mul_f32 v165, 0xbfb8aa3b, v141
    v_exp_f32 v160, v160
    v_exp_f32 v161, v161
    v_exp_f32 v162, v162
    v_exp_f32 v163, v163
    v_exp_f32 v164, v164
    v_exp_f32 v165, v165
    s_nop 0
    v_add_f32 v160, 1.0, v160
    v_add_f32 v161, 1.0, v161
    v_add_f32 v162, 1.0, v162
    v_add_f32 v163, 1.0, v163
    v_add_f32 v164, 1.0, v164
    v_add_f32 v165, 1.0, v165
    v_rcp_f32 v160, v160
    v_rcp_f32 v161, v161
    v_rcp_f32 v162, v162
    v_rcp_f32 v163, v163
    v_rcp_f32 v164, v164
    v_rcp_f32 v165, v165
    s_nop 0
    v_mul_f32 v136, v160, v136
    v_mul_f32 v137, v161, v137
    v_mul_f32 v138, v162, v138
    v_mul_f32 v139, v163, v139
    v_mul_f32 v140, v164, v140
    v_mul_f32 v141, v165, v141
    v_cvt_pk_bf16_f32 v136, v136, v136
    v_and_b32 v136, s92, v136
    v_cvt_pk_bf16_f32 v137, v137, v137
    v_and_b32 v137, s92, v137
    v_cvt_pk_bf16_f32 v138, v138, v138
    v_and_b32 v138, s92, v138
    v_cvt_pk_bf16_f32 v139, v139, v139
    v_and_b32 v139, s92, v139
    v_cvt_pk_bf16_f32 v140, v140, v140
    v_and_b32 v140, s92, v140
    v_cvt_pk_bf16_f32 v141, v141, v141
    v_and_b32 v141, s92, v141
    s_waitcnt vmcnt(17)
    v_lshlrev_b32 v120, 16, v40
    v_and_b32 v121, s92, v40
    v_mul_f32 v112, v120, v124
    v_mul_f32 v113, v121, v124
    v_lshlrev_b32 v120, 16, v41
    v_and_b32 v121, s92, v41
    v_mul_f32 v114, v120, v124
    v_mul_f32 v115, v121, v124
    v_lshlrev_b32 v120, 16, v42
    v_and_b32 v121, s92, v42
    v_mul_f32 v116, v120, v124
    v_mul_f32 v117, v121, v124
    v_lshlrev_b32 v120, 16, v43
    v_and_b32 v121, s92, v43
    v_mul_f32 v118, v120, v124
    v_mul_f32 v119, v121, v124
    s_waitcnt vmcnt(16)
    v_lshlrev_b32 v120, 16, v44
    v_and_b32 v121, s92, v44
    v_fmac_f32 v112, v120, v125
    v_fmac_f32 v113, v121, v125
    v_lshlrev_b32 v120, 16, v45
    v_and_b32 v121, s92, v45
    v_fmac_f32 v114, v120, v125
    v_fmac_f32 v115, v121, v125
    v_lshlrev_b32 v120, 16, v46
    v_and_b32 v121, s92, v46
    v_fmac_f32 v116, v120, v125
    v_fmac_f32 v117, v121, v125
    v_lshlrev_b32 v120, 16, v47
    v_and_b32 v121, s92, v47
    v_fmac_f32 v118, v120, v125
    v_fmac_f32 v119, v121, v125
    s_waitcnt vmcnt(15)
    v_lshlrev_b32 v120, 16, v48
    v_and_b32 v121, s92, v48
    v_fmac_f32 v112, v120, v126
    v_fmac_f32 v113, v121, v126
    v_lshlrev_b32 v120, 16, v49
    v_and_b32 v121, s92, v49
    v_fmac_f32 v114, v120, v126
    v_fmac_f32 v115, v121, v126
    v_lshlrev_b32 v120, 16, v50
    v_and_b32 v121, s92, v50
    v_fmac_f32 v116, v120, v126
    v_fmac_f32 v117, v121, v126
    v_lshlrev_b32 v120, 16, v51
    v_and_b32 v121, s92, v51
    v_fmac_f32 v118, v120, v126
    v_fmac_f32 v119, v121, v126
    s_waitcnt vmcnt(14)
    v_lshlrev_b32 v120, 16, v52
    v_and_b32 v121, s92, v52
    v_fmac_f32 v112, v120, v127
    v_fmac_f32 v113, v121, v127
    v_lshlrev_b32 v120, 16, v53
    v_and_b32 v121, s92, v53
    v_fmac_f32 v114, v120, v127
    v_fmac_f32 v115, v121, v127
    v_lshlrev_b32 v120, 16, v54
    v_and_b32 v121, s92, v54
    v_fmac_f32 v116, v120, v127
    v_fmac_f32 v117, v121, v127
    v_lshlrev_b32 v120, 16, v55
    v_and_b32 v121, s92, v55
    v_fmac_f32 v118, v120, v127
    v_fmac_f32 v119, v121, v127
    s_waitcnt vmcnt(13)
    v_lshlrev_b32 v120, 16, v56
    v_and_b32 v121, s92, v56
    v_fmac_f32 v112, v120, v128
    v_fmac_f32 v113, v121, v128
    v_lshlrev_b32 v120, 16, v57
    v_and_b32 v121, s92, v57
    v_fmac_f32 v114, v120, v128
    v_fmac_f32 v115, v121, v128
    v_lshlrev_b32 v120, 16, v58
    v_and_b32 v121, s92, v58
    v_fmac_f32 v116, v120, v128
    v_fmac_f32 v117, v121, v128
    v_lshlrev_b32 v120, 16, v59
    v_and_b32 v121, s92, v59
    v_fmac_f32 v118, v120, v128
    v_fmac_f32 v119, v121, v128
    s_waitcnt vmcnt(12)
    v_lshlrev_b32 v120, 16, v60
    v_and_b32 v121, s92, v60
    v_fmac_f32 v112, v120, v129
    v_fmac_f32 v113, v121, v129
    v_lshlrev_b32 v120, 16, v61
    v_and_b32 v121, s92, v61
    v_fmac_f32 v114, v120, v129
    v_fmac_f32 v115, v121, v129
    v_lshlrev_b32 v120, 16, v62
    v_and_b32 v121, s92, v62
    v_fmac_f32 v116, v120, v129
    v_fmac_f32 v117, v121, v129
    v_lshlrev_b32 v120, 16, v63
    v_and_b32 v121, s92, v63
    v_fmac_f32 v118, v120, v129
    v_fmac_f32 v119, v121, v129
    s_waitcnt vmcnt(11)
    v_lshlrev_b32 v120, 16, v64
    v_and_b32 v121, s92, v64
    v_fmac_f32 v112, v120, v130
    v_fmac_f32 v113, v121, v130
    v_lshlrev_b32 v120, 16, v65
    v_and_b32 v121, s92, v65
    v_fmac_f32 v114, v120, v130
    v_fmac_f32 v115, v121, v130
    v_lshlrev_b32 v120, 16, v66
    v_and_b32 v121, s92, v66
    v_fmac_f32 v116, v120, v130
    v_fmac_f32 v117, v121, v130
    v_lshlrev_b32 v120, 16, v67
    v_and_b32 v121, s92, v67
    v_fmac_f32 v118, v120, v130
    v_fmac_f32 v119, v121, v130
    s_waitcnt vmcnt(10)
    v_lshlrev_b32 v120, 16, v68
    v_and_b32 v121, s92, v68
    v_fmac_f32 v112, v120, v131
    v_fmac_f32 v113, v121, v131
    v_lshlrev_b32 v120, 16, v69
    v_and_b32 v121, s92, v69
    v_fmac_f32 v114, v120, v131
    v_fmac_f32 v115, v121, v131
    v_lshlrev_b32 v120, 16, v70
    v_and_b32 v121, s92, v70
    v_fmac_f32 v116, v120, v131
    v_fmac_f32 v117, v121, v131
    v_lshlrev_b32 v120, 16, v71
    v_and_b32 v121, s92, v71
    v_fmac_f32 v118, v120, v131
    v_fmac_f32 v119, v121, v131
    s_waitcnt vmcnt(9)
    v_lshlrev_b32 v120, 16, v72
    v_and_b32 v121, s92, v72
    v_fmac_f32 v112, v120, v132
    v_fmac_f32 v113, v121, v132
    v_lshlrev_b32 v120, 16, v73
    v_and_b32 v121, s92, v73
    v_fmac_f32 v114, v120, v132
    v_fmac_f32 v115, v121, v132
    v_lshlrev_b32 v120, 16, v74
    v_and_b32 v121, s92, v74
    v_fmac_f32 v116, v120, v132
    v_fmac_f32 v117, v121, v132
    v_lshlrev_b32 v120, 16, v75
    v_and_b32 v121, s92, v75
    v_fmac_f32 v118, v120, v132
    v_fmac_f32 v119, v121, v132
    s_waitcnt vmcnt(8)
    v_lshlrev_b32 v120, 16, v76
    v_and_b32 v121, s92, v76
    v_fmac_f32 v112, v120, v133
    v_fmac_f32 v113, v121, v133
    v_lshlrev_b32 v120, 16, v77
    v_and_b32 v121, s92, v77
    v_fmac_f32 v114, v120, v133
    v_fmac_f32 v115, v121, v133
    v_lshlrev_b32 v120, 16, v78
    v_and_b32 v121, s92, v78
    v_fmac_f32 v116, v120, v133
    v_fmac_f32 v117, v121, v133
    v_lshlrev_b32 v120, 16, v79
    v_and_b32 v121, s92, v79
    v_fmac_f32 v118, v120, v133
    v_fmac_f32 v119, v121, v133
    s_waitcnt vmcnt(7)
    v_lshlrev_b32 v120, 16, v80
    v_and_b32 v121, s92, v80
    v_fmac_f32 v112, v120, v134
    v_fmac_f32 v113, v121, v134
    v_lshlrev_b32 v120, 16, v81
    v_and_b32 v121, s92, v81
    v_fmac_f32 v114, v120, v134
    v_fmac_f32 v115, v121, v134
    v_lshlrev_b32 v120, 16, v82
    v_and_b32 v121, s92, v82
    v_fmac_f32 v116, v120, v134
    v_fmac_f32 v117, v121, v134
    v_lshlrev_b32 v120, 16, v83
    v_and_b32 v121, s92, v83
    v_fmac_f32 v118, v120, v134
    v_fmac_f32 v119, v121, v134
    s_waitcnt vmcnt(6)
    v_lshlrev_b32 v120, 16, v84
    v_and_b32 v121, s92, v84
    v_fmac_f32 v112, v120, v135
    v_fmac_f32 v113, v121, v135
    v_lshlrev_b32 v120, 16, v85
    v_and_b32 v121, s92, v85
    v_fmac_f32 v114, v120, v135
    v_fmac_f32 v115, v121, v135
    v_lshlrev_b32 v120, 16, v86
    v_and_b32 v121, s92, v86
    v_fmac_f32 v116, v120, v135
    v_fmac_f32 v117, v121, v135
    v_lshlrev_b32 v120, 16, v87
    v_and_b32 v121, s92, v87
    v_fmac_f32 v118, v120, v135
    v_fmac_f32 v119, v121, v135
    s_waitcnt vmcnt(5)
    v_lshlrev_b32 v120, 16, v88
    v_and_b32 v121, s92, v88
    v_fmac_f32 v112, v120, v136
    v_fmac_f32 v113, v121, v136
    v_lshlrev_b32 v120, 16, v89
    v_and_b32 v121, s92, v89
    v_fmac_f32 v114, v120, v136
    v_fmac_f32 v115, v121, v136
    v_lshlrev_b32 v120, 16, v90
    v_and_b32 v121, s92, v90
    v_fmac_f32 v116, v120, v136
    v_fmac_f32 v117, v121, v136
    v_lshlrev_b32 v120, 16, v91
    v_and_b32 v121, s92, v91
    v_fmac_f32 v118, v120, v136
    v_fmac_f32 v119, v121, v136
    s_waitcnt vmcnt(4)
    v_lshlrev_b32 v120, 16, v92
    v_and_b32 v121, s92, v92
    v_fmac_f32 v112, v120, v137
    v_fmac_f32 v113, v121, v137
    v_lshlrev_b32 v120, 16, v93
    v_and_b32 v121, s92, v93
    v_fmac_f32 v114, v120, v137
    v_fmac_f32 v115, v121, v137
    v_lshlrev_b32 v120, 16, v94
    v_and_b32 v121, s92, v94
    v_fmac_f32 v116, v120, v137
    v_fmac_f32 v117, v121, v137
    v_lshlrev_b32 v120, 16, v95
    v_and_b32 v121, s92, v95
    v_fmac_f32 v118, v120, v137
    v_fmac_f32 v119, v121, v137
    s_waitcnt vmcnt(3)
    v_lshlrev_b32 v120, 16, v96
    v_and_b32 v121, s92, v96
    v_fmac_f32 v112, v120, v138
    v_fmac_f32 v113, v121, v138
    v_lshlrev_b32 v120, 16, v97
    v_and_b32 v121, s92, v97
    v_fmac_f32 v114, v120, v138
    v_fmac_f32 v115, v121, v138
    v_lshlrev_b32 v120, 16, v98
    v_and_b32 v121, s92, v98
    v_fmac_f32 v116, v120, v138
    v_fmac_f32 v117, v121, v138
    v_lshlrev_b32 v120, 16, v99
    v_and_b32 v121, s92, v99
    v_fmac_f32 v118, v120, v138
    v_fmac_f32 v119, v121, v138
    s_waitcnt vmcnt(2)
    v_lshlrev_b32 v120, 16, v100
    v_and_b32 v121, s92, v100
    v_fmac_f32 v112, v120, v139
    v_fmac_f32 v113, v121, v139
    v_lshlrev_b32 v120, 16, v101
    v_and_b32 v121, s92, v101
    v_fmac_f32 v114, v120, v139
    v_fmac_f32 v115, v121, v139
    v_lshlrev_b32 v120, 16, v102
    v_and_b32 v121, s92, v102
    v_fmac_f32 v116, v120, v139
    v_fmac_f32 v117, v121, v139
    v_lshlrev_b32 v120, 16, v103
    v_and_b32 v121, s92, v103
    v_fmac_f32 v118, v120, v139
    v_fmac_f32 v119, v121, v139
    s_waitcnt vmcnt(1)
    v_lshlrev_b32 v120, 16, v104
    v_and_b32 v121, s92, v104
    v_fmac_f32 v112, v120, v140
    v_fmac_f32 v113, v121, v140
    v_lshlrev_b32 v120, 16, v105
    v_and_b32 v121, s92, v105
    v_fmac_f32 v114, v120, v140
    v_fmac_f32 v115, v121, v140
    v_lshlrev_b32 v120, 16, v106
    v_and_b32 v121, s92, v106
    v_fmac_f32 v116, v120, v140
    v_fmac_f32 v117, v121, v140
    v_lshlrev_b32 v120, 16, v107
    v_and_b32 v121, s92, v107
    v_fmac_f32 v118, v120, v140
    v_fmac_f32 v119, v121, v140
    s_waitcnt vmcnt(0)
    v_lshlrev_b32 v120, 16, v108
    v_and_b32 v121, s92, v108
    v_fmac_f32 v112, v120, v141
    v_fmac_f32 v113, v121, v141
    v_lshlrev_b32 v120, 16, v109
    v_and_b32 v121, s92, v109
    v_fmac_f32 v114, v120, v141
    v_fmac_f32 v115, v121, v141
    v_lshlrev_b32 v120, 16, v110
    v_and_b32 v121, s92, v110
    v_fmac_f32 v116, v120, v141
    v_fmac_f32 v117, v121, v141
    v_lshlrev_b32 v120, 16, v111
    v_and_b32 v121, s92, v111
    v_fmac_f32 v118, v120, v141
    v_fmac_f32 v119, v121, v141
    v_mov_b32 v160, v112
    v_mov_b32 v161, v113
    v_mov_b32 v162, v114
    v_mov_b32 v163, v115
    v_mov_b32 v164, v116
    v_mov_b32 v165, v117
    v_mov_b32 v166, v118
    v_mov_b32 v167, v119
    s_nop 1
    v_permlane16_swap_b32 v160, v112
    v_permlane16_swap_b32 v161, v113
    v_permlane16_swap_b32 v162, v114
    v_permlane16_swap_b32 v163, v115
    v_permlane16_swap_b32 v164, v116
    v_permlane16_swap_b32 v165, v117
    v_permlane16_swap_b32 v166, v118
    v_permlane16_swap_b32 v167, v119
    s_nop 1
    v_add_f32 v112, v112, v160
    v_add_f32 v113, v113, v161
    v_add_f32 v114, v114, v162
    v_add_f32 v115, v115, v163
    v_add_f32 v116, v116, v164
    v_add_f32 v117, v117, v165
    v_add_f32 v118, v118, v166
    v_add_f32 v119, v119, v167
    v_mov_b32 v160, v112
    v_mov_b32 v161, v113
    v_mov_b32 v162, v114
    v_mov_b32 v163, v115
    v_mov_b32 v164, v116
    v_mov_b32 v165, v117
    v_mov_b32 v166, v118
    v_mov_b32 v167, v119
    s_nop 1
    v_permlane32_swap_b32 v160, v112
    v_permlane32_swap_b32 v161, v113
    v_permlane32_swap_b32 v162, v114
    v_permlane32_swap_b32 v163, v115
    v_permlane32_swap_b32 v164, v116
    v_permlane32_swap_b32 v165, v117
    v_permlane32_swap_b32 v166, v118
    v_permlane32_swap_b32 v167, v119
    s_nop 1
    v_add_f32 v112, v112, v160
    v_add_f32 v113, v113, v161
    v_add_f32 v114, v114, v162
    v_add_f32 v115, v115, v163
    v_add_f32 v116, v116, v164
    v_add_f32 v117, v117, v165
    v_add_f32 v118, v118, v166
    v_add_f32 v119, v119, v167
    v_lshlrev_b32 v6, 5, v3
    v_add_u32 v7, 137472, v6
    s_cmp_eq_u32 s90, 6
    s_cbranch_scc0 Lm6_22
    s_mov_b64 exec, 0xffff
    ds_write_b128 v7, v[112:115]
    ds_write_b128 v7, v[116:119] offset:16
    s_mov_b64 exec, -1
    s_waitcnt lgkmcnt(0)
    v_mov_b32 v2, 139008
    v_mov_b32 v3, 1
    s_mov_b64 exec, 1
    ds_add_u32 v2, v3
    s_mov_b64 exec, -1
    s_branch Lmod_21
Lm6_22:
    v_mov_b32 v2, 139008
    s_mov_b32 s61, 0
Lsp_23:
    ds_read_b32 v3, v2
    s_waitcnt lgkmcnt(0)
    v_readfirstlane_b32 s60, v3
    s_nop 0
    s_cmp_ge_u32 s60, 1
    s_cbranch_scc1 Lspd_24
    s_add_u32 s61, s61, 1
    s_cmp_lt_u32 s61, 0x40000
    s_cbranch_scc1 Lsp_23
Lspd_24:
    ds_read_b128 v[160:163], v7
    ds_read_b128 v[164:167], v7 offset:16
    s_add_u32 s44, s30, 9764864
    s_addc_u32 s45, s31, 0
    s_mov_b32 s46, 55296
    s_mov_b32 s47, 0x20000
    s_waitcnt lgkmcnt(0)
    v_add_f32 v112, v112, v160
    v_add_f32 v113, v113, v161
    v_add_f32 v114, v114, v162
    v_add_f32 v115, v115, v163
    v_add_f32 v116, v116, v164
    v_add_f32 v117, v117, v165
    v_add_f32 v118, v118, v166
    v_add_f32 v119, v119, v167
    s_mul_i32 s53, s54, 13824
    s_lshl_b32 s52, s55, 9
    s_add_u32 s52, s52, s53
    v_add_u32 v6, s52, v6
    s_mov_b64 exec, 0xffff
    buffer_store_dwordx4 v[112:115], v6, s[44:47], 0 offen sc1
    buffer_store_dwordx4 v[116:119], v6, s[44:47], 0 offen offset:16 sc1
    s_waitcnt vmcnt(0)
    s_mov_b64 exec, -1
    s_lshl_b32 s60, s2, 4
    s_add_u32 s60, s60, 202752
    v_mul_u32_u24 v2, 4224, v1
    v_add_u32 v2, s60, v2
    v_mov_b32 v3, s91
    s_mov_b64 exec, 0xff
    buffer_store_dword v3, v2, s[96:99], 0 offen sc1
    s_mov_b64 exec, -1
Lmod_21:
    s_cmp_eq_u32 s90, 7
    s_cbranch_scc0 Lw7_25
    s_waitcnt vmcnt(0)
    v_lshlrev_b32 v20, 16, v40
    v_and_b32 v21, s92, v40
    v_mov_b32 v16, v20
    v_mov_b32 v17, v21
    v_pk_mul_f32 v[18:19], v[20:21], v[20:21]
    v_lshlrev_b32 v20, 16, v41
    v_and_b32 v21, s92, v41
    v_pk_add_f32 v[16:17], v[16:17], v[20:21]
    v_pk_fma_f32 v[18:19], v[20:21], v[20:21], v[18:19]
    v_lshlrev_b32 v20, 16, v42
    v_and_b32 v21, s92, v42
    v_pk_add_f32 v[16:17], v[16:17], v[20:21]
    v_pk_fma_f32 v[18:19], v[20:21], v[20:21], v[18:19]
    v_lshlrev_b32 v20, 16, v43
    v_and_b32 v21, s92, v43
    v_pk_add_f32 v[16:17], v[16:17], v[20:21]
    v_pk_fma_f32 v[18:19], v[20:21], v[20:21], v[18:19]
    v_lshlrev_b32 v20, 16, v44
    v_and_b32 v21, s92, v44
    v_pk_add_f32 v[16:17], v[16:17], v[20:21]
    v_pk_fma_f32 v[18:19], v[20:21], v[20:21], v[18:19]
    v_lshlrev_b32 v20, 16, v45
    v_and_b32 v21, s92, v45
    v_pk_add_f32 v[16:17], v[16:17], v[20:21]
    v_pk_fma_f32 v[18:19], v[20:21], v[20:21], v[18:19]
    v_lshlrev_b32 v20, 16, v46
    v_and_b32 v21, s92, v46
    v_pk_add_f32 v[16:17], v[16:17], v[20:21]
    v_pk_fma_f32 v[18:19], v[20:21], v[20:21], v[18:19]
    v_lshlrev_b32 v20, 16, v47
    v_and_b32 v21, s92, v47
    v_pk_add_f32 v[16:17], v[16:17], v[20:21]
    v_pk_fma_f32 v[18:19], v[20:21], v[20:21], v[18:19]
    v_lshlrev_b32 v20, 16, v48
    v_and_b32 v21, s92, v48
    v_pk_add_f32 v[16:17], v[16:17], v[20:21]
    v_pk_fma_f32 v[18:19], v[20:21], v[20:21], v[18:19]
    v_lshlrev_b32 v20, 16, v49
    v_and_b32 v21, s92, v49
    v_pk_add_f32 v[16:17], v[16:17], v[20:21]
    v_pk_fma_f32 v[18:19], v[20:21], v[20:21], v[18:19]
    v_lshlrev_b32 v20, 16, v50
    v_and_b32 v21, s92, v50
    v_pk_add_f32 v[16:17], v[16:17], v[20:21]
    v_pk_fma_f32 v[18:19], v[20:21], v[20:21], v[18:19]
    v_lshlrev_b32 v20, 16, v51
    v_and_b32 v21, s92, v51
    v_pk_add_f32 v[16:17], v[16:17], v[20:21]
    v_pk_fma_f32 v[18:19], v[20:21], v[20:21], v[18:19]
    v_lshlrev_b32 v20, 16, v52
    v_and_b32 v21, s92, v52
    v_pk_add_f32 v[16:17], v[16:17], v[20:21]
    v_pk_fma_f32 v[18:19], v[20:21], v[20:21], v[18:19]
    v_lshlrev_b32 v20, 16, v53
    v_and_b32 v21, s92, v53
    v_pk_add_f32 v[16:17], v[16:17], v[20:21]
    v_pk_fma_f32 v[18:19], v[20:21], v[20:21], v[18:19]
    v_lshlrev_b32 v20, 16, v54
    v_and_b32 v21, s92, v54
    v_pk_add_f32 v[16:17], v[16:17], v[20:21]
    v_pk_fma_f32 v[18:19], v[20:21], v[20:21], v[18:19]
    v_lshlrev_b32 v20, 16, v55
    v_and_b32 v21, s92, v55
    v_pk_add_f32 v[16:17], v[16:17], v[20:21]
    v_pk_fma_f32 v[18:19], v[20:21], v[20:21], v[18:19]
    v_lshlrev_b32 v20, 16, v56
    v_and_b32 v21, s92, v56
    v_pk_add_f32 v[16:17], v[16:17], v[20:21]
    v_pk_fma_f32 v[18:19], v[20:21], v[20:21], v[18:19]
    v_lshlrev_b32 v20, 16, v57
    v_and_b32 v21, s92, v57
    v_pk_add_f32 v[16:17], v[16:17], v[20:21]
    v_pk_fma_f32 v[18:19], v[20:21], v[20:21], v[18:19]
    v_lshlrev_b32 v20, 16, v58
    v_and_b32 v21, s92, v58
    v_pk_add_f32 v[16:17], v[16:17], v[20:21]
    v_pk_fma_f32 v[18:19], v[20:21], v[20:21], v[18:19]
    v_lshlrev_b32 v20, 16, v59
    v_and_b32 v21, s92, v59
    v_pk_add_f32 v[16:17], v[16:17], v[20:21]
    v_pk_fma_f32 v[18:19], v[20:21], v[20:21], v[18:19]
    v_lshlrev_b32 v20, 16, v60
    v_and_b32 v21, s92, v60
    v_pk_add_f32 v[16:17], v[16:17], v[20:21]
    v_pk_fma_f32 v[18:19], v[20:21], v[20:21], v[18:19]
    v_lshlrev_b32 v20, 16, v61
    v_and_b32 v21, s92, v61
    v_pk_add_f32 v[16:17], v[16:17], v[20:21]
    v_pk_fma_f32 v[18:19], v[20:21], v[20:21], v[18:19]
    v_lshlrev_b32 v20, 16, v62
    v_and_b32 v21, s92, v62
    v_pk_add_f32 v[16:17], v[16:17], v[20:21]
    v_pk_fma_f32 v[18:19], v[20:21], v[20:21], v[18:19]
    v_lshlrev_b32 v20, 16, v63
    v_and_b32 v21, s92, v63
    v_pk_add_f32 v[16:17], v[16:17], v[20:21]
    v_pk_fma_f32 v[18:19], v[20:21], v[20:21], v[18:19]
    v_lshlrev_b32 v20, 16, v64
    v_and_b32 v21, s92, v64
    v_pk_add_f32 v[16:17], v[16:17], v[20:21]
    v_pk_fma_f32 v[18:19], v[20:21], v[20:21], v[18:19]
    v_lshlrev_b32 v20, 16, v65
    v_and_b32 v21, s92, v65
    v_pk_add_f32 v[16:17], v[16:17], v[20:21]
    v_pk_fma_f32 v[18:19], v[20:21], v[20:21], v[18:19]
    v_lshlrev_b32 v20, 16, v66
    v_and_b32 v21, s92, v66
    v_pk_add_f32 v[16:17], v[16:17], v[20:21]
    v_pk_fma_f32 v[18:19], v[20:21], v[20:21], v[18:19]
    v_lshlrev_b32 v20, 16, v67
    v_and_b32 v21, s92, v67
    v_pk_add_f32 v[16:17], v[16:17], v[20:21]
    v_pk_fma_f32 v[18:19], v[20:21], v[20:21], v[18:19]
    v_lshlrev_b32 v20, 16, v68
    v_and_b32 v21, s92, v68
    v_pk_add_f32 v[16:17], v[16:17], v[20:21]
    v_pk_fma_f32 v[18:19], v[20:21], v[20:21], v[18:19]
    v_lshlrev_b32 v20, 16, v69
    v_and_b32 v21, s92, v69
    v_pk_add_f32 v[16:17], v[16:17], v[20:21]
    v_pk_fma_f32 v[18:19], v[20:21], v[20:21], v[18:19]
    v_lshlrev_b32 v20, 16, v70
    v_and_b32 v21, s92, v70
    v_pk_add_f32 v[16:17], v[16:17], v[20:21]
    v_pk_fma_f32 v[18:19], v[20:21], v[20:21], v[18:19]
    v_lshlrev_b32 v20, 16, v71
    v_and_b32 v21, s92, v71
    v_pk_add_f32 v[16:17], v[16:17], v[20:21]
    v_pk_fma_f32 v[18:19], v[20:21], v[20:21], v[18:19]
    v_lshlrev_b32 v20, 16, v72
    v_and_b32 v21, s92, v72
    v_pk_add_f32 v[16:17], v[16:17], v[20:21]
    v_pk_fma_f32 v[18:19], v[20:21], v[20:21], v[18:19]
    v_lshlrev_b32 v20, 16, v73
    v_and_b32 v21, s92, v73
    v_pk_add_f32 v[16:17], v[16:17], v[20:21]
    v_pk_fma_f32 v[18:19], v[20:21], v[20:21], v[18:19]
    v_lshlrev_b32 v20, 16, v74
    v_and_b32 v21, s92, v74
    v_pk_add_f32 v[16:17], v[16:17], v[20:21]
    v_pk_fma_f32 v[18:19], v[20:21], v[20:21], v[18:19]
    v_lshlrev_b32 v20, 16, v75
    v_and_b32 v21, s92, v75
    v_pk_add_f32 v[16:17], v[16:17], v[20:21]
    v_pk_fma_f32 v[18:19], v[20:21], v[20:21], v[18:19]
    v_add_f32 v22, v16, v17
    v_add_f32 v23, v18, v19
    s_nop 1
    v_add_f32_dpp v24, v22, v22 row_ror:8 row_mask:0xf bank_mask:0xf
    v_add_f32_dpp v25, v23, v23 row_ror:8 row_mask:0xf bank_mask:0xf
    v_mov_b32 v22, v24
    v_mov_b32 v23, v25
    s_nop 1
    v_permlane16_swap_b32 v22, v24
    v_permlane16_swap_b32 v23, v25
    s_nop 1
    v_pk_add_f32 v[24:25], v[22:23], v[24:25]
    v_mov_b32 v22, v24
    v_mov_b32 v23, v25
    s_nop 1
    v_permlane32_swap_b32 v22, v24
    v_permlane32_swap_b32 v23, v25
    s_nop 1
    v_pk_add_f32 v[24:25], v[22:23], v[24:25]
    v_mul_f32 v22, 0x3ae38e39, v24
    v_mul_f32 v25, 0x3ae38e39, v25
    v_fma_f32 v25, -v22, v22, v25
    v_max_f32 v25, 0, v25
    v_add_f32 v25, 0x3727c5ac, v25
    v_rsq_f32 v23, v25
    v_lshlrev_b32 v2, 3, v1
    v_add_u32 v2, 138496, v2
    s_mov_b64 exec, 0xff
    ds_write_b64 v2, v[22:23]
    s_mov_b64 exec, -1
    s_and_b32 s88, s2, 7
    s_mul_i32 s88, s88, 4224
    s_add_u32 s88, s88, 202752
    v_lshlrev_b32 v4, 4, v1
    s_mov_b32 s61, 0
Lpoll_26:
    s_add_u32 s60, s88, 0
    buffer_load_dword v5, v4, s[96:99], s60 offen sc1
    s_mov_b32 exec_hi, 0xfff
    s_add_u32 s60, s88, 1024
    buffer_load_dword v6, v4, s[96:99], s60 offen sc1
    s_mov_b64 exec, -1
    s_waitcnt vmcnt(0)
    v_cmp_ne_u32 vcc, s91, v5
    s_mov_b32 exec_hi, 0xfff
    v_cmp_ne_u32 s[86:87], s91, v6
    s_or_b64 vcc, vcc, s[86:87]
    s_mov_b64 exec, -1
    s_cmp_eq_u64 vcc, 0
    s_cbranch_scc1 Lpd_27
    s_add_u32 s61, s61, 1
    s_cmp_lt_u32 s61, s93
    s_cbranch_scc1 Lpoll_26
Lpd_27:
    v_mov_b32 v4, 139016
    s_mov_b32 s61, 0
Lsp_28:
    ds_read_b32 v5, v4
    s_waitcnt lgkmcnt(0)
    v_readfirstlane_b32 s60, v5
    s_nop 0
    s_cmp_ge_u32 s60, 5
    s_cbranch_scc1 Lspd_29
    s_add_u32 s61, s61, 1
    s_cmp_lt_u32 s61, 0x40000
    s_cbranch_scc1 Lsp_28
Lspd_29:
    s_add_u32 s44, s30, 9764864
    s_addc_u32 s45, s31, 0
    s_mov_b32 s46, 55296
    s_mov_b32 s47, 0x20000
    v_lshlrev_b32 v2, 4, v1
    s_mov_b32 s60, 0
    buffer_load_dwordx4 v[40:43], v2, s[44:47], s60 offen sc1
    s_mov_b32 s60, 1024
    buffer_load_dwordx4 v[44:47], v2, s[44:47], s60 offen sc1
    s_mov_b32 s60, 2048
    buffer_load_dwordx4 v[48:51], v2, s[44:47], s60 offen sc1
    s_mov_b32 s60, 3072
    buffer_load_dwordx4 v[52:55], v2, s[44:47], s60 offen sc1
    s_mov_b32 s60, 4096
    buffer_load_dwordx4 v[56:59], v2, s[44:47], s60 offen sc1
    s_mov_b32 s60, 5120
    buffer_load_dwordx4 v[60:63], v2, s[44:47], s60 offen sc1
    s_mov_b32 s60, 6144
    buffer_load_dwordx4 v[64:67], v2, s[44:47], s60 offen sc1
    s_mov_b32 s60, 7168
    buffer_load_dwordx4 v[68:71], v2, s[44:47], s60 offen sc1
    s_mov_b32 s60, 8192
    buffer_load_dwordx4 v[72:75], v2, s[44:47], s60 offen sc1
    s_mov_b32 s60, 9216
    buffer_load_dwordx4 v[76:79], v2, s[44:47], s60 offen sc1
    s_mov_b32 s60, 10240
    buffer_load_dwordx4 v[80:83], v2, s[44:47], s60 offen sc1
    s_mov_b32 s60, 11264
    buffer_load_dwordx4 v[84:87], v2, s[44:47], s60 offen sc1
    s_mov_b32 s60, 13824
    buffer_load_dwordx4 v[88:91], v2, s[44:47], s60 offen sc1
    s_mov_b32 s60, 14848
    buffer_load_dwordx4 v[92:95], v2, s[44:47], s60 offen sc1
    s_mov_b32 s60, 15872
    buffer_load_dwordx4 v[96:99], v2, s[44:47], s60 offen sc1
    s_mov_b32 s60, 16896
    buffer_load_dwordx4 v[100:103], v2, s[44:47], s60 offen sc1
    s_mov_b32 s60, 17920
    buffer_load_dwordx4 v[104:107], v2, s[44:47], s60 offen sc1
    s_mov_b32 s60, 18944
    buffer_load_dwordx4 v[108:111], v2, s[44:47], s60 offen sc1
    s_mov_b32 s60, 19968
    buffer_load_dwordx4 v[112:115], v2, s[44:47], s60 offen sc1
    s_mov_b32 s60, 20992
    buffer_load_dwordx4 v[116:119], v2, s[44:47], s60 offen sc1
    s_mov_b32 s60, 22016
    buffer_load_dwordx4 v[120:123], v2, s[44:47], s60 offen sc1
    s_mov_b32 s60, 23040
    buffer_load_dwordx4 v[124:127], v2, s[44:47], s60 offen sc1
    s_mov_b32 s60, 24064
    buffer_load_dwordx4 v[128:131], v2, s[44:47], s60 offen sc1
    s_mov_b32 s60, 25088
    buffer_load_dwordx4 v[132:135], v2, s[44:47], s60 offen sc1
    s_mov_b32 s60, 27648
    buffer_load_dwordx4 v[136:139], v2, s[44:47], s60 offen sc1
    s_mov_b32 s60, 28672
    buffer_load_dwordx4 v[140:143], v2, s[44:47], s60 offen sc1
    s_mov_b32 s60, 29696
    buffer_load_dwordx4 v[144:147], v2, s[44:47], s60 offen sc1
    s_mov_b32 s60, 30720
    buffer_load_dwordx4 v[148:151], v2, s[44:47], s60 offen sc1
    s_mov_b32 s60, 31744
    buffer_load_dwordx4 v[152:155], v2, s[44:47], s60 offen sc1
    s_mov_b32 s60, 32768
    buffer_load_dwordx4 v[156:159], v2, s[44:47], s60 offen sc1
    s_mov_b32 s60, 33792
    buffer_load_dwordx4 v[160:163], v2, s[44:47], s60 offen sc1
    s_mov_b32 s60, 34816
    buffer_load_dwordx4 v[164:167], v2, s[44:47], s60 offen sc1
    s_mov_b32 s60, 35840
    buffer_load_dwordx4 v[168:171], v2, s[44:47], s60 offen sc1
    s_mov_b32 s60, 36864
    buffer_load_dwordx4 v[172:175], v2, s[44:47], s60 offen sc1
    s_mov_b32 s60, 37888
    buffer_load_dwordx4 v[176:179], v2, s[44:47], s60 offen sc1
    s_mov_b32 s60, 38912
    buffer_load_dwordx4 v[180:183], v2, s[44:47], s60 offen sc1
    s_mov_b32 s60, 41472
    buffer_load_dwordx4 v[184:187], v2, s[44:47], s60 offen sc1
    s_mov_b32 s60, 42496
    buffer_load_dwordx4 v[188:191], v2, s[44:47], s60 offen sc1
    s_mov_b32 s60, 43520
    buffer_load_dwordx4 v[192:195], v2, s[44:47], s60 offen sc1
    s_mov_b32 s60, 44544
    buffer_load_dwordx4 v[196:199], v2, s[44:47], s60 offen sc1
    s_mov_b32 s60, 45568
    buffer_load_dwordx4 v[200:203], v2, s[44:47], s60 offen sc1
    s_mov_b32 s60, 46592
    buffer_load_dwordx4 v[204:207], v2, s[44:47], s60 offen sc1
    s_mov_b32 s60, 47616
    buffer_load_dwordx4 v[208:211], v2, s[44:47], s60 offen sc1
    s_mov_b32 s60, 48640
    buffer_load_dwordx4 v[212:215], v2, s[44:47], s60 offen sc1
    s_mov_b32 s60, 49664
    buffer_load_dwordx4 v[216:219], v2, s[44:47], s60 offen sc1
    s_mov_b32 s60, 50688
    buffer_load_dwordx4 v[220:223], v2, s[44:47], s60 offen sc1
    s_mov_b32 s60, 51712
    buffer_load_dwordx4 v[224:227], v2, s[44:47], s60 offen sc1
    s_mov_b32 s60, 52736
    buffer_load_dwordx4 v[228:231], v2, s[44:47], s60 offen sc1
    s_waitcnt vmcnt(24)
    v_pk_add_f32 v[40:41], v[40:41], v[88:89]
    v_pk_add_f32 v[42:43], v[42:43], v[90:91]
    v_pk_add_f32 v[44:45], v[44:45], v[92:93]
    v_pk_add_f32 v[46:47], v[46:47], v[94:95]
    v_pk_add_f32 v[48:49], v[48:49], v[96:97]
    v_pk_add_f32 v[50:51], v[50:51], v[98:99]
    v_pk_add_f32 v[52:53], v[52:53], v[100:101]
    v_pk_add_f32 v[54:55], v[54:55], v[102:103]
    v_pk_add_f32 v[56:57], v[56:57], v[104:105]
    v_pk_add_f32 v[58:59], v[58:59], v[106:107]
    v_pk_add_f32 v[60:61], v[60:61], v[108:109]
    v_pk_add_f32 v[62:63], v[62:63], v[110:111]
    v_pk_add_f32 v[64:65], v[64:65], v[112:113]
    v_pk_add_f32 v[66:67], v[66:67], v[114:115]
    v_pk_add_f32 v[68:69], v[68:69], v[116:117]
    v_pk_add_f32 v[70:71], v[70:71], v[118:119]
    v_pk_add_f32 v[72:73], v[72:73], v[120:121]
    v_pk_add_f32 v[74:75], v[74:75], v[122:123]
    v_pk_add_f32 v[76:77], v[76:77], v[124:125]
    v_pk_add_f32 v[78:79], v[78:79], v[126:127]
    v_pk_add_f32 v[80:81], v[80:81], v[128:129]
    v_pk_add_f32 v[82:83], v[82:83], v[130:131]
    v_pk_add_f32 v[84:85], v[84:85], v[132:133]
    v_pk_add_f32 v[86:87], v[86:87], v[134:135]
    s_waitcnt vmcnt(0)
    v_pk_add_f32 v[136:137], v[136:137], v[184:185]
    v_pk_add_f32 v[138:139], v[138:139], v[186:187]
    v_pk_add_f32 v[140:141], v[140:141], v[188:189]
    v_pk_add_f32 v[142:143], v[142:143], v[190:191]
    v_pk_add_f32 v[144:145], v[144:145], v[192:193]
    v_pk_add_f32 v[146:147], v[146:147], v[194:195]
    v_pk_add_f32 v[148:149], v[148:149], v[196:197]
    v_pk_add_f32 v[150:151], v[150:151], v[198:199]
    v_pk_add_f32 v[152:153], v[152:153], v[200:201]
    v_pk_add_f32 v[154:155], v[154:155], v[202:203]
    v_pk_add_f32 v[156:157], v[156:157], v[204:205]
    v_pk_add_f32 v[158:159], v[158:159], v[206:207]
    v_pk_add_f32 v[160:161], v[160:161], v[208:209]
    v_pk_add_f32 v[162:163], v[162:163], v[210:211]
    v_pk_add_f32 v[164:165], v[164:165], v[212:213]
    v_pk_add_f32 v[166:167], v[166:167], v[214:215]
    v_pk_add_f32 v[168:169], v[168:169], v[216:217]
    v_pk_add_f32 v[170:171], v[170:171], v[218:219]
    v_pk_add_f32 v[172:173], v[172:173], v[220:221]
    v_pk_add_f32 v[174:175], v[174:175], v[222:223]
    v_pk_add_f32 v[176:177], v[176:177], v[224:225]
    v_pk_add_f32 v[178:179], v[178:179], v[226:227]
    v_pk_add_f32 v[180:181], v[180:181], v[228:229]
    v_pk_add_f32 v[182:183], v[182:183], v[230:231]
    v_pk_add_f32 v[40:41], v[40:41], v[136:137]
    v_pk_add_f32 v[42:43], v[42:43], v[138:139]
    v_pk_add_f32 v[44:45], v[44:45], v[140:141]
    v_pk_add_f32 v[46:47], v[46:47], v[142:143]
    v_pk_add_f32 v[48:49], v[48:49], v[144:145]
    v_pk_add_f32 v[50:51], v[50:51], v[146:147]
    v_pk_add_f32 v[52:53], v[52:53], v[148:149]
    v_pk_add_f32 v[54:55], v[54:55], v[150:151]
    v_pk_add_f32 v[56:57], v[56:57], v[152:153]
    v_pk_add_f32 v[58:59], v[58:59], v[154:155]
    v_pk_add_f32 v[60:61], v[60:61], v[156:157]
    v_pk_add_f32 v[62:63], v[62:63], v[158:159]
    v_pk_add_f32 v[64:65], v[64:65], v[160:161]
    v_pk_add_f32 v[66:67], v[66:67], v[162:163]
    v_pk_add_f32 v[68:69], v[68:69], v[164:165]
    v_pk_add_f32 v[70:71], v[70:71], v[166:167]
    v_pk_add_f32 v[72:73], v[72:73], v[168:169]
    v_pk_add_f32 v[74:75], v[74:75], v[170:171]
    v_pk_add_f32 v[76:77], v[76:77], v[172:173]
    v_pk_add_f32 v[78:79], v[78:79], v[174:175]
    v_pk_add_f32 v[80:81], v[80:81], v[176:177]
    v_pk_add_f32 v[82:83], v[82:83], v[178:179]
    v_pk_add_f32 v[84:85], v[84:85], v[180:181]
    v_pk_add_f32 v[86:87], v[86:87], v[182:183]
    v_cvt_pk_bf16_f32 v88, v40, v41
    v_lshlrev_b32 v40, 16, v88
    v_and_b32 v41, s92, v88
    v_cvt_pk_bf16_f32 v88, v42, v43
    v_lshlrev_b32 v42, 16, v88
    v_and_b32 v43, s92, v88
    v_cvt_pk_bf16_f32 v88, v44, v45
    v_lshlrev_b32 v44, 16, v88
    v_and_b32 v45, s92, v88
    v_cvt_pk_bf16_f32 v88, v46, v47
    v_lshlrev_b32 v46, 16, v88
    v_and_b32 v47, s92, v88
    v_cvt_pk_bf16_f32 v88, v48, v49
    v_lshlrev_b32 v48, 16, v88
    v_and_b32 v49, s92, v88
    v_cvt_pk_bf16_f32 v88, v50, v51
    v_lshlrev_b32 v50, 16, v88
    v_and_b32 v51, s92, v88
    v_cvt_pk_bf16_f32 v88, v52, v53
    v_lshlrev_b32 v52, 16, v88
    v_and_b32 v53, s92, v88
    v_cvt_pk_bf16_f32 v88, v54, v55
    v_lshlrev_b32 v54, 16, v88
    v_and_b32 v55, s92, v88
    v_cvt_pk_bf16_f32 v88, v56, v57
    v_lshlrev_b32 v56, 16, v88
    v_and_b32 v57, s92, v88
    v_cvt_pk_bf16_f32 v88, v58, v59
    v_lshlrev_b32 v58, 16, v88
    v_and_b32 v59, s92, v88
    v_cvt_pk_bf16_f32 v88, v60, v61
    v_lshlrev_b32 v60, 16, v88
    v_and_b32 v61, s92, v88
    v_cvt_pk_bf16_f32 v88, v62, v63
    v_lshlrev_b32 v62, 16, v88
    v_and_b32 v63, s92, v88
    v_cvt_pk_bf16_f32 v88, v64, v65
    v_lshlrev_b32 v64, 16, v88
    v_and_b32 v65, s92, v88
    v_cvt_pk_bf16_f32 v88, v66, v67
    v_lshlrev_b32 v66, 16, v88
    v_and_b32 v67, s92, v88
    v_cvt_pk_bf16_f32 v88, v68, v69
    v_lshlrev_b32 v68, 16, v88
    v_and_b32 v69, s92, v88
    v_cvt_pk_bf16_f32 v88, v70, v71
    v_lshlrev_b32 v70, 16, v88
    v_and_b32 v71, s92, v88
    v_cvt_pk_bf16_f32 v88, v72, v73
    v_lshlrev_b32 v72, 16, v88
    v_and_b32 v73, s92, v88
    v_cvt_pk_bf16_f32 v88, v74, v75
    v_lshlrev_b32 v74, 16, v88
    v_and_b32 v75, s92, v88
    v_cvt_pk_bf16_f32 v88, v76, v77
    v_lshlrev_b32 v76, 16, v88
    v_and_b32 v77, s92, v88
    v_cvt_pk_bf16_f32 v88, v78, v79
    v_lshlrev_b32 v78, 16, v88
    v_and_b32 v79, s92, v88
    v_cvt_pk_bf16_f32 v88, v80, v81
    v_lshlrev_b32 v80, 16, v88
    v_and_b32 v81, s92, v88
    v_cvt_pk_bf16_f32 v88, v82, v83
    v_lshlrev_b32 v82, 16, v88
    v_and_b32 v83, s92, v88
    v_cvt_pk_bf16_f32 v88, v84, v85
    v_lshlrev_b32 v84, 16, v88
    v_and_b32 v85, s92, v88
    v_cvt_pk_bf16_f32 v88, v86, v87
    v_lshlrev_b32 v86, 16, v88
    v_and_b32 v87, s92, v88
    v_add_u32 v3, 148736, v2
    ds_write_b128 v3, v[40:43] offset:0
    ds_write_b128 v3, v[44:47] offset:1024
    ds_write_b128 v3, v[48:51] offset:2048
    ds_write_b128 v3, v[52:55] offset:3072
    ds_write_b128 v3, v[56:59] offset:4096
    ds_write_b128 v3, v[60:63] offset:5120
    ds_write_b128 v3, v[64:67] offset:6144
    ds_write_b128 v3, v[68:71] offset:7168
    ds_write_b128 v3, v[72:75] offset:8192
    ds_write_b128 v3, v[76:79] offset:9216
    ds_write_b128 v3, v[80:83] offset:10240
    s_mov_b64 exec, 0xffff
    ds_write_b128 v3, v[84:87] offset:11264
    s_mov_b64 exec, -1
    s_cmp_eq_u32 s2, 0
    s_cbranch_scc0 Lw7_25
    s_mov_b32 s60, 11520
    buffer_load_dwordx4 v[40:43], v2, s[44:47], s60 offen sc1
    s_mov_b32 s60, 12544
    buffer_load_dwordx4 v[44:47], v2, s[44:47], s60 offen sc1
    s_mov_b32 s60, 13568
    buffer_load_dwordx4 v[48:51], v2, s[44:47], s60 offen sc1
    s_mov_b32 s60, 25344
    buffer_load_dwordx4 v[52:55], v2, s[44:47], s60 offen sc1
    s_mov_b32 s60, 26368
    buffer_load_dwordx4 v[56:59], v2, s[44:47], s60 offen sc1
    s_mov_b32 s60, 27392
    buffer_load_dwordx4 v[60:63], v2, s[44:47], s60 offen sc1
    s_mov_b32 s60, 39168
    buffer_load_dwordx4 v[64:67], v2, s[44:47], s60 offen sc1
    s_mov_b32 s60, 40192
    buffer_load_dwordx4 v[68:71], v2, s[44:47], s60 offen sc1
    s_mov_b32 s60, 41216
    buffer_load_dwordx4 v[72:75], v2, s[44:47], s60 offen sc1
    s_mov_b32 s60, 52992
    buffer_load_dwordx4 v[76:79], v2, s[44:47], s60 offen sc1
    s_mov_b32 s60, 54016
    buffer_load_dwordx4 v[80:83], v2, s[44:47], s60 offen sc1
    s_mov_b32 s60, 55040
    buffer_load_dwordx4 v[84:87], v2, s[44:47], s60 offen sc1
    s_waitcnt vmcnt(0)
    v_pk_add_f32 v[40:41], v[40:41], v[52:53]
    v_pk_add_f32 v[64:65], v[64:65], v[76:77]
    v_pk_add_f32 v[42:43], v[42:43], v[54:55]
    v_pk_add_f32 v[66:67], v[66:67], v[78:79]
    v_pk_add_f32 v[44:45], v[44:45], v[56:57]
    v_pk_add_f32 v[68:69], v[68:69], v[80:81]
    v_pk_add_f32 v[46:47], v[46:47], v[58:59]
    v_pk_add_f32 v[70:71], v[70:71], v[82:83]
    v_pk_add_f32 v[48:49], v[48:49], v[60:61]
    v_pk_add_f32 v[72:73], v[72:73], v[84:85]
    v_pk_add_f32 v[50:51], v[50:51], v[62:63]
    v_pk_add_f32 v[74:75], v[74:75], v[86:87]
    v_pk_add_f32 v[40:41], v[40:41], v[64:65]
    v_cvt_pk_bf16_f32 v88, v40, v41
    v_lshlrev_b32 v40, 16, v88
    v_and_b32 v41, s92, v88
    v_pk_add_f32 v[42:43], v[42:43], v[66:67]
    v_cvt_pk_bf16_f32 v88, v42, v43
    v_lshlrev_b32 v42, 16, v88
    v_and_b32 v43, s92, v88
    v_pk_add_f32 v[44:45], v[44:45], v[68:69]
    v_cvt_pk_bf16_f32 v88, v44, v45
    v_lshlrev_b32 v44, 16, v88
    v_and_b32 v45, s92, v88
    v_pk_add_f32 v[46:47], v[46:47], v[70:71]
    v_cvt_pk_bf16_f32 v88, v46, v47
    v_lshlrev_b32 v46, 16, v88
    v_and_b32 v47, s92, v88
    v_pk_add_f32 v[48:49], v[48:49], v[72:73]
    v_cvt_pk_bf16_f32 v88, v48, v49
    v_lshlrev_b32 v48, 16, v88
    v_and_b32 v49, s92, v88
    v_pk_add_f32 v[50:51], v[50:51], v[74:75]
    v_cvt_pk_bf16_f32 v88, v50, v51
    v_lshlrev_b32 v50, 16, v88
    v_and_b32 v51, s92, v88
    s_add_u32 s44, s30, 9699328
    s_addc_u32 s45, s31, 0
    s_mov_b32 s46, 13824
    s_mov_b32 s47, 0x20000
    s_mov_b32 s60, 11520
    buffer_store_dwordx4 v[40:43], v2, s[44:47], s60 offen sc1
    s_mov_b32 s60, 12544
    buffer_store_dwordx4 v[44:47], v2, s[44:47], s60 offen sc1
    s_mov_b32 s60, 13568
    buffer_store_dwordx4 v[48:51], v2, s[44:47], s60 offen sc1
Lw7_25:
    s_cmp_lt_u32 s90, 3
    s_cbranch_scc1 Lwp_30
    v_mov_b32 v2, 139020
    s_mov_b32 s61, 0
Lsp_31:
    ds_read_b32 v3, v2
    s_waitcnt lgkmcnt(0)
    v_readfirstlane_b32 s60, v3
    s_nop 0
    s_cmp_ge_u32 s60, 2
    s_cbranch_scc1 Lspd_32
    s_add_u32 s61, s61, 1
    s_cmp_lt_u32 s61, 0x40000
    s_cbranch_scc1 Lsp_31
Lspd_32:
    s_add_u32 m0, s37, s38
    s_nop 0
    buffer_load_dwordx4 v10, s[32:35], s36 offen lds
    buffer_load_dwordx4 v11, s[32:35], s36 offen offset:1024 lds
    s_mov_b64 exec, 0xffff
    buffer_load_dwordx4 v12, s[32:35], s36 offen offset:2048 lds
    s_mov_b64 exec, -1
    s_add_u32 s37, s37, 18432
    s_add_u32 s36, s36, 294912
    s_cmp_ge_u32 s37, 110592
    s_cselect_b32 s37, 0, s37
    s_add_u32 m0, s37, s38
    s_nop 0
    buffer_load_dwordx4 v10, s[32:35], s36 offen lds
    buffer_load_dwordx4 v11, s[32:35], s36 offen offset:1024 lds
    s_mov_b64 exec, 0xffff
    buffer_load_dwordx4 v12, s[32:35], s36 offen offset:2048 lds
    s_mov_b64 exec, -1
    s_add_u32 s37, s37, 18432
    s_add_u32 s36, s36, 294912
    s_cmp_ge_u32 s37, 110592
    s_cselect_b32 s37, 0, s37
    s_add_u32 m0, s37, s38
    s_nop 0
    buffer_load_dwordx4 v10, s[32:35], s36 offen lds
    buffer_load_dwordx4 v11, s[32:35], s36 offen offset:1024 lds
    s_mov_b64 exec, 0xffff
    buffer_load_dwordx4 v12, s[32:35], s36 offen offset:2048 lds
    s_mov_b64 exec, -1
    s_add_u32 s37, s37, 18432
    s_add_u32 s36, s36, 294912
    s_cmp_ge_u32 s37, 110592
    s_cselect_b32 s37, 0, s37
    s_add_u32 m0, s37, s38
    s_nop 0
    buffer_load_dwordx4 v10, s[32:35], s36 offen lds
    buffer_load_dwordx4 v11, s[32:35], s36 offen offset:1024 lds
    s_mov_b64 exec, 0xffff
    buffer_load_dwordx4 v12, s[32:35], s36 offen offset:2048 lds
    s_mov_b64 exec, -1
    s_add_u32 s37, s37, 18432
    s_add_u32 s36, s36, 294912
    s_cmp_ge_u32 s37, 110592
    s_cselect_b32 s37, 0, s37
Lwp_30:
    s_cmp_eq_u32 s41, -1
    s_cbranch_scc1 Lp2end_33
    s_mul_i32 s43, s90, 21248
    s_add_u32 s43, s43, 73728
    v_lshlrev_b32 v3, 4, v1
    v_add_u32 v14, s43, v3
    v_alignbit_b32 v64, v204, v200, 16
    v_alignbit_b32 v65, v205, v201, 16
    v_alignbit_b32 v66, v206, v202, 16
    v_alignbit_b32 v67, v207, v203, 16
    v_alignbit_b32 v68, v208, v204, 16
    v_alignbit_b32 v69, v209, v205, 16
    v_alignbit_b32 v70, v210, v206, 16
    v_alignbit_b32 v71, v211, v207, 16
    ds_write_b128 v14, v[200:203] offset:32
    ds_write_b128 v14, v[64:67] offset:4192
    ds_write_b128 v14, v[204:207] offset:8352
    ds_write_b128 v14, v[68:71] offset:12512
    v_alignbit_b32 v72, v216, v212, 16
    v_alignbit_b32 v73, v217, v213, 16
    v_alignbit_b32 v74, v218, v214, 16
    v_alignbit_b32 v75, v219, v215, 16
    v_alignbit_b32 v76, v220, v216, 16
    v_alignbit_b32 v77, v221, v217, 16
    v_alignbit_b32 v78, v222, v218, 16
    v_alignbit_b32 v79, v223, v219, 16
    ds_write_b128 v14, v[212:215] offset:1056
    ds_write_b128 v14, v[72:75] offset:5216
    ds_write_b128 v14, v[216:219] offset:9376
    ds_write_b128 v14, v[76:79] offset:13536
    v_alignbit_b32 v64, v228, v224, 16
    v_alignbit_b32 v65, v229, v225, 16
    v_alignbit_b32 v66, v230, v226, 16
    v_alignbit_b32 v67, v231, v227, 16
    v_alignbit_b32 v68, v232, v228, 16
    v_alignbit_b32 v69, v233, v229, 16
    v_alignbit_b32 v70, v234, v230, 16
    v_alignbit_b32 v71, v235, v231, 16
    ds_write_b128 v14, v[224:227] offset:2080
    ds_write_b128 v14, v[64:67] offset:6240
    ds_write_b128 v14, v[228:231] offset:10400
    ds_write_b128 v14, v[68:71] offset:14560
    v_alignbit_b32 v72, v240, v236, 16
    v_alignbit_b32 v73, v241, v237, 16
    v_alignbit_b32 v74, v242, v238, 16
    v_alignbit_b32 v75, v243, v239, 16
    v_alignbit_b32 v76, v244, v240, 16
    v_alignbit_b32 v77, v245, v241, 16
    v_alignbit_b32 v78, v246, v242, 16
    v_alignbit_b32 v79, v247, v243, 16
    ds_write_b128 v14, v[236:239] offset:3104
    ds_write_b128 v14, v[72:75] offset:7264
    ds_write_b128 v14, v[240:243] offset:11424
    ds_write_b128 v14, v[76:79] offset:15584
    v_or_b32 v248, v248, v249
    v_lshrrev_b32 v4, 3, v1
    v_mul_u32_u24 v5, 4160, v4
    v_and_b32 v6, 7, v1
    v_lshlrev_b32 v6, 2, v6
    v_add3_u32 v5, v5, v6, s43
    v_mov_b32 v80, 0
    v_mov_b32 v81, 0
    v_mov_b32 v82, 0
    v_mov_b32 v83, 0
    s_mov_b32 exec_lo, -1
    s_mov_b32 exec_hi, 0
    ds_write_b32 v5, v248
    ds_write_b128 v14, v[80:83] offset:20736
    s_mov_b64 exec, -1
    v_and_b32 v4, 15, v1
    v_lshrrev_b32 v5, 4, v1
    v_add_u32 v6, 1, v4
    v_and_b32 v7, 3, v6
    v_lshrrev_b32 v6, 2, v6
    v_mul_u32_u24 v7, 4160, v7
    v_lshlrev_b32 v6, 3, v6
    v_lshlrev_b32 v8, 4, v5
    v_add3_u32 v7, v7, v6, v8
    v_add_u32 v7, s43, v7
    v_lshlrev_b32 v9, 5, v4
    v_sub_u32 v8, v8, v9
    v_add_u32 v8, 17120, v8
    v_add_u32 v8, s43, v8
    v_lshlrev_b32 v6, 3, v5
    v_add_u32 v13, v6, v9
    v_sub_u32 v13, 17144, v13
    v_add_u32 v13, s43, v13
    v_lshrrev_b32 v15, 1, v4
    v_mul_u32_u24 v15, 36864, v15
    v_and_b32 v9, 1, v4
    v_lshlrev_b32 v9, 5, v9
    v_add3_u32 v15, v15, v9, v6
    s_lshl_b32 s52, s41, 6
    v_add_u32 v15, s52, v15
    v_mov_b32 v16, 0
    v_mov_b32 v17, 0
    v_mov_b32 v18, 0
    v_mov_b32 v19, 0
    v_mov_b32 v20, 0
    v_mov_b32 v21, 0
    v_mov_b32 v22, 0
    v_mov_b32 v23, 0
    v_mov_b32 v24, 0
    v_mov_b32 v25, 0
    v_mov_b32 v26, 0
    v_mov_b32 v27, 0
    v_mov_b32 v28, 0
    v_mov_b32 v29, 0
    v_mov_b32 v30, 0
    v_mov_b32 v31, 0
    v_mov_b32 v32, 0
    v_mov_b32 v33, 0
    v_mov_b32 v34, 0
    v_mov_b32 v35, 0
    v_mov_b32 v36, 0
    v_mov_b32 v37, 0
    v_mov_b32 v38, 0
    v_mov_b32 v39, 0
    v_mov_b32 v40, 0
    v_mov_b32 v41, 0
    v_mov_b32 v42, 0
    v_mov_b32 v43, 0
    v_mov_b32 v44, 0
    v_mov_b32 v45, 0
    v_mov_b32 v46, 0
    v_mov_b32 v47, 0
    s_mul_i32 s52, s41, 911
    s_lshr_b32 s52, s52, 16
    s_lshl_b32 s52, s52, 5
    s_and_b32 s88, s2, 7
    s_mul_i32 s88, s88, 4224
    s_add_u32 s88, s88, 33792
    s_lshl_b32 s60, s52, 4
    s_add_u32 s60, s60, s88
    v_lshlrev_b32 v64, 4, v1
    v_add_u32 v64, s60, v64
    v_cmp_gt_u32 vcc, 32, v1
    s_mov_b64 exec, vcc
    s_mov_b32 s61, 0
Lpoll_34:
    buffer_load_dword v65, v64, s[96:99], 0 offen sc1
    s_waitcnt vmcnt(0)
    v_cmp_ne_u32 vcc, s91, v65
    s_cmp_eq_u64 vcc, 0
    s_cbranch_scc1 Lpd_35
    s_add_u32 s61, s61, 1
    s_cmp_lt_u32 s61, s93
    s_cbranch_scc1 Lpoll_34
Lpd_35:
    s_mov_b64 exec, -1
    s_mov_b32 s44, s30
    s_mov_b32 s45, s31
    s_mov_b32 s46, 2433024
    s_mov_b32 s47, 0x20000
    s_mul_i32 s52, s41, 4224
    buffer_load_dwordx4 v[84:87], v3, s[44:47], s52 offen offset:0 sc1
    buffer_load_dwordx4 v[88:91], v3, s[44:47], s52 offen offset:1024 sc1
    buffer_load_dwordx4 v[92:95], v3, s[44:47], s52 offen offset:2048 sc1
    buffer_load_dwordx4 v[96:99], v3, s[44:47], s52 offen offset:3072 sc1
    s_add_u32 s48, s30, 2490368
    s_addc_u32 s49, s31, 0
    s_mov_b32 s50, 2359296
    s_mov_b32 s51, 0x20000
    s_waitcnt vmcnt(3)
    ds_write_b128 v14, v[84:87] offset:16640
    s_waitcnt vmcnt(2)
    ds_write_b128 v14, v[88:91] offset:17664
    s_waitcnt vmcnt(1)
    ds_write_b128 v14, v[92:95] offset:18688
    s_waitcnt vmcnt(0)
    ds_write_b128 v14, v[96:99] offset:19712
    s_waitcnt lgkmcnt(0)
    v_mov_b32 v62, 139020
    v_mov_b32 v63, 1
    s_mov_b64 exec, 1
    ds_add_u32 v62, v63
    s_mov_b64 exec, -1
    ds_read_b128 v[80:83], v8 offset:3584
    ds_read_b64 v[48:49], v7 offset:0
    ds_read_b64 v[50:51], v7 offset:8
    ds_read_b128 v[84:87], v8 offset:3072
    ds_read_b64 v[52:53], v7 offset:512
    ds_read_b64 v[54:55], v7 offset:520
    ds_read_b128 v[88:91], v8 offset:2560
    ds_read_b64 v[56:57], v7 offset:1024
    ds_read_b64 v[58:59], v7 offset:1032
    ds_read_b128 v[92:95], v8 offset:2048
    ds_read_b64 v[60:61], v7 offset:1536
    ds_read_b64 v[62:63], v7 offset:1544
    ds_read_b128 v[96:99], v8 offset:1536
    ds_read_b64 v[64:65], v7 offset:2048
    ds_read_b64 v[66:67], v7 offset:2056
    ds_read_b128 v[100:103], v8 offset:1024
    ds_read_b64 v[68:69], v7 offset:2560
    ds_read_b64 v[70:71], v7 offset:2568
    ds_read_b128 v[104:107], v8 offset:512
    ds_read_b64 v[72:73], v7 offset:3072
    ds_read_b64 v[74:75], v7 offset:3080
    ds_read_b128 v[108:111], v8 offset:0
    ds_read_b64 v[76:77], v7 offset:3584
    ds_read_b64 v[78:79], v7 offset:3592
    s_mov_b32 s52, 0
    s_waitcnt lgkmcnt(0)
Lconv_36:
    v_add_u32 v7, 64, v7
    v_add_u32 v8, 64, v8
    v_mfma_f32_16x16x32_bf16 v[16:19], v[48:51], v[80:83], v[16:19]
    ds_read_b128 v[144:147], v8 offset:3584
    v_mfma_f32_16x16x32_bf16 v[20:23], v[48:51], v[84:87], v[20:23]
    ds_read_b64 v[112:113], v7 offset:0
    v_mfma_f32_16x16x32_bf16 v[24:27], v[48:51], v[88:91], v[24:27]
    ds_read_b64 v[114:115], v7 offset:8
    v_mfma_f32_16x16x32_bf16 v[28:31], v[48:51], v[92:95], v[28:31]
    ds_read_b128 v[148:151], v8 offset:3072
    v_mfma_f32_16x16x32_bf16 v[32:35], v[48:51], v[96:99], v[32:35]
    ds_read_b64 v[116:117], v7 offset:512
    v_mfma_f32_16x16x32_bf16 v[36:39], v[48:51], v[100:103], v[36:39]
    ds_read_b64 v[118:119], v7 offset:520
    v_mfma_f32_16x16x32_bf16 v[40:43], v[48:51], v[104:107], v[40:43]
    ds_read_b128 v[152:155], v8 offset:2560
    v_mfma_f32_16x16x32_bf16 v[44:47], v[48:51], v[108:111], v[44:47]
    ds_read_b64 v[120:121], v7 offset:1024
    v_mfma_f32_16x16x32_bf16 v[20:23], v[52:55], v[80:83], v[20:23]
    ds_read_b64 v[122:123], v7 offset:1032
    v_mfma_f32_16x16x32_bf16 v[24:27], v[52:55], v[84:87], v[24:27]
    ds_read_b128 v[156:159], v8 offset:2048
    v_mfma_f32_16x16x32_bf16 v[28:31], v[52:55], v[88:91], v[28:31]
    ds_read_b64 v[124:125], v7 offset:1536
    v_mfma_f32_16x16x32_bf16 v[32:35], v[52:55], v[92:95], v[32:35]
    ds_read_b64 v[126:127], v7 offset:1544
    v_mfma_f32_16x16x32_bf16 v[36:39], v[52:55], v[96:99], v[36:39]
    ds_read_b128 v[160:163], v8 offset:1536
    v_mfma_f32_16x16x32_bf16 v[40:43], v[52:55], v[100:103], v[40:43]
    ds_read_b64 v[128:129], v7 offset:2048
    v_mfma_f32_16x16x32_bf16 v[44:47], v[52:55], v[104:107], v[44:47]
    ds_read_b64 v[130:131], v7 offset:2056
    v_mfma_f32_16x16x32_bf16 v[24:27], v[56:59], v[80:83], v[24:27]
    ds_read_b128 v[164:167], v8 offset:1024
    v_mfma_f32_16x16x32_bf16 v[28:31], v[56:59], v[84:87], v[28:31]
    ds_read_b64 v[132:133], v7 offset:2560
    v_mfma_f32_16x16x32_bf16 v[32:35], v[56:59], v[88:91], v[32:35]
    ds_read_b64 v[134:135], v7 offset:2568
    v_mfma_f32_16x16x32_bf16 v[36:39], v[56:59], v[92:95], v[36:39]
    ds_read_b128 v[168:171], v8 offset:512
    v_mfma_f32_16x16x32_bf16 v[40:43], v[56:59], v[96:99], v[40:43]
    ds_read_b64 v[136:137], v7 offset:3072
    v_mfma_f32_16x16x32_bf16 v[44:47], v[56:59], v[100:103], v[44:47]
    ds_read_b64 v[138:139], v7 offset:3080
    v_mfma_f32_16x16x32_bf16 v[28:31], v[60:63], v[80:83], v[28:31]
    ds_read_b128 v[172:175], v8 offset:0
    v_mfma_f32_16x16x32_bf16 v[32:35], v[60:63], v[84:87], v[32:35]
    ds_read_b64 v[140:141], v7 offset:3584
    v_mfma_f32_16x16x32_bf16 v[36:39], v[60:63], v[88:91], v[36:39]
    ds_read_b64 v[142:143], v7 offset:3592
    v_mfma_f32_16x16x32_bf16 v[40:43], v[60:63], v[92:95], v[40:43]
    v_mfma_f32_16x16x32_bf16 v[44:47], v[60:63], v[96:99], v[44:47]
    v_mfma_f32_16x16x32_bf16 v[32:35], v[64:67], v[80:83], v[32:35]
    v_mfma_f32_16x16x32_bf16 v[36:39], v[64:67], v[84:87], v[36:39]
    v_mfma_f32_16x16x32_bf16 v[40:43], v[64:67], v[88:91], v[40:43]
    v_mfma_f32_16x16x32_bf16 v[44:47], v[64:67], v[92:95], v[44:47]
    v_mfma_f32_16x16x32_bf16 v[36:39], v[68:71], v[80:83], v[36:39]
    v_mfma_f32_16x16x32_bf16 v[40:43], v[68:71], v[84:87], v[40:43]
    v_mfma_f32_16x16x32_bf16 v[44:47], v[68:71], v[88:91], v[44:47]
    v_mfma_f32_16x16x32_bf16 v[40:43], v[72:75], v[80:83], v[40:43]
    v_mfma_f32_16x16x32_bf16 v[44:47], v[72:75], v[84:87], v[44:47]
    v_mfma_f32_16x16x32_bf16 v[44:47], v[76:79], v[80:83], v[44:47]
    s_waitcnt lgkmcnt(0)
    v_add_u32 v7, 64, v7
    v_add_u32 v8, 64, v8
    v_mfma_f32_16x16x32_bf16 v[16:19], v[112:115], v[144:147], v[16:19]
    ds_read_b128 v[80:83], v8 offset:3584
    v_mfma_f32_16x16x32_bf16 v[20:23], v[112:115], v[148:151], v[20:23]
    ds_read_b64 v[48:49], v7 offset:0
    v_mfma_f32_16x16x32_bf16 v[24:27], v[112:115], v[152:155], v[24:27]
    ds_read_b64 v[50:51], v7 offset:8
    v_mfma_f32_16x16x32_bf16 v[28:31], v[112:115], v[156:159], v[28:31]
    ds_read_b128 v[84:87], v8 offset:3072
    v_mfma_f32_16x16x32_bf16 v[32:35], v[112:115], v[160:163], v[32:35]
    ds_read_b64 v[52:53], v7 offset:512
    v_mfma_f32_16x16x32_bf16 v[36:39], v[112:115], v[164:167], v[36:39]
    ds_read_b64 v[54:55], v7 offset:520
    v_mfma_f32_16x16x32_bf16 v[40:43], v[112:115], v[168:171], v[40:43]
    ds_read_b128 v[88:91], v8 offset:2560
    v_mfma_f32_16x16x32_bf16 v[44:47], v[112:115], v[172:175], v[44:47]
    ds_read_b64 v[56:57], v7 offset:1024
    v_mfma_f32_16x16x32_bf16 v[20:23], v[116:119], v[144:147], v[20:23]
    ds_read_b64 v[58:59], v7 offset:1032
    v_mfma_f32_16x16x32_bf16 v[24:27], v[116:119], v[148:151], v[24:27]
    ds_read_b128 v[92:95], v8 offset:2048
    v_mfma_f32_16x16x32_bf16 v[28:31], v[116:119], v[152:155], v[28:31]
    ds_read_b64 v[60:61], v7 offset:1536
    v_mfma_f32_16x16x32_bf16 v[32:35], v[116:119], v[156:159], v[32:35]
    ds_read_b64 v[62:63], v7 offset:1544
    v_mfma_f32_16x16x32_bf16 v[36:39], v[116:119], v[160:163], v[36:39]
    ds_read_b128 v[96:99], v8 offset:1536
    v_mfma_f32_16x16x32_bf16 v[40:43], v[116:119], v[164:167], v[40:43]
    ds_read_b64 v[64:65], v7 offset:2048
    v_mfma_f32_16x16x32_bf16 v[44:47], v[116:119], v[168:171], v[44:47]
    ds_read_b64 v[66:67], v7 offset:2056
    v_mfma_f32_16x16x32_bf16 v[24:27], v[120:123], v[144:147], v[24:27]
    ds_read_b128 v[100:103], v8 offset:1024
    v_mfma_f32_16x16x32_bf16 v[28:31], v[120:123], v[148:151], v[28:31]
    ds_read_b64 v[68:69], v7 offset:2560
    v_mfma_f32_16x16x32_bf16 v[32:35], v[120:123], v[152:155], v[32:35]
    ds_read_b64 v[70:71], v7 offset:2568
    v_mfma_f32_16x16x32_bf16 v[36:39], v[120:123], v[156:159], v[36:39]
    ds_read_b128 v[104:107], v8 offset:512
    v_mfma_f32_16x16x32_bf16 v[40:43], v[120:123], v[160:163], v[40:43]
    ds_read_b64 v[72:73], v7 offset:3072
    v_mfma_f32_16x16x32_bf16 v[44:47], v[120:123], v[164:167], v[44:47]
    ds_read_b64 v[74:75], v7 offset:3080
    v_mfma_f32_16x16x32_bf16 v[28:31], v[124:127], v[144:147], v[28:31]
    ds_read_b128 v[108:111], v8 offset:0
    v_mfma_f32_16x16x32_bf16 v[32:35], v[124:127], v[148:151], v[32:35]
    ds_read_b64 v[76:77], v7 offset:3584
    v_mfma_f32_16x16x32_bf16 v[36:39], v[124:127], v[152:155], v[36:39]
    ds_read_b64 v[78:79], v7 offset:3592
    v_mfma_f32_16x16x32_bf16 v[40:43], v[124:127], v[156:159], v[40:43]
    v_mfma_f32_16x16x32_bf16 v[44:47], v[124:127], v[160:163], v[44:47]
    v_mfma_f32_16x16x32_bf16 v[32:35], v[128:131], v[144:147], v[32:35]
    v_mfma_f32_16x16x32_bf16 v[36:39], v[128:131], v[148:151], v[36:39]
    v_mfma_f32_16x16x32_bf16 v[40:43], v[128:131], v[152:155], v[40:43]
    v_mfma_f32_16x16x32_bf16 v[44:47], v[128:131], v[156:159], v[44:47]
    v_mfma_f32_16x16x32_bf16 v[36:39], v[132:135], v[144:147], v[36:39]
    v_mfma_f32_16x16x32_bf16 v[40:43], v[132:135], v[148:151], v[40:43]
    v_mfma_f32_16x16x32_bf16 v[44:47], v[132:135], v[152:155], v[44:47]
    v_mfma_f32_16x16x32_bf16 v[40:43], v[136:139], v[144:147], v[40:43]
    v_mfma_f32_16x16x32_bf16 v[44:47], v[136:139], v[148:151], v[44:47]
    v_mfma_f32_16x16x32_bf16 v[44:47], v[140:143], v[144:147], v[44:47]
    s_waitcnt lgkmcnt(0)
    s_add_u32 s52, s52, 1
    s_cmp_lt_u32 s52, 4
    s_cbranch_scc1 Lconv_36
    ds_read_b64 v[48:49], v13 offset:3584
    ds_read_b64 v[50:51], v13 offset:3072
    ds_read_b64 v[52:53], v13 offset:2560
    ds_read_b64 v[54:55], v13 offset:2048
    ds_read_b64 v[56:57], v13 offset:1536
    ds_read_b64 v[58:59], v13 offset:1024
    ds_read_b64 v[60:61], v13 offset:512
    ds_read_b64 v[62:63], v13 offset:0
    s_and_b32 s52, s41, 1
    s_lshl_b32 s52, s52, 4
    s_lshr_b32 s42, s42, s52
    s_lshl_b32 s42, s42, 16
    v_mov_b32 v64, s42
    v_mov_b32 v65, s42
    s_waitcnt lgkmcnt(0)
    v_and_b32 v66, s92, v49
    v_lshlrev_b32 v67, 16, v49
    v_and_b32 v68, s92, v48
    v_lshlrev_b32 v69, 16, v48
    v_pk_fma_f32 v[16:17], v[66:67], v[64:65], v[16:17]
    v_pk_fma_f32 v[18:19], v[68:69], v[64:65], v[18:19]
    v_cvt_pk_bf16_f32 v80, v16, v17
    v_cvt_pk_bf16_f32 v81, v18, v19
    s_mov_b32 s52, 0
    buffer_store_dwordx2 v[80:81], v15, s[48:51], s52 offen sc1
    v_and_b32 v70, s92, v51
    v_lshlrev_b32 v71, 16, v51
    v_and_b32 v72, s92, v50
    v_lshlrev_b32 v73, 16, v50
    v_pk_fma_f32 v[20:21], v[70:71], v[64:65], v[20:21]
    v_pk_fma_f32 v[22:23], v[72:73], v[64:65], v[22:23]
    v_cvt_pk_bf16_f32 v82, v20, v21
    v_cvt_pk_bf16_f32 v83, v22, v23
    s_mov_b32 s52, 294912
    buffer_store_dwordx2 v[82:83], v15, s[48:51], s52 offen sc1
    v_and_b32 v66, s92, v53
    v_lshlrev_b32 v67, 16, v53
    v_and_b32 v68, s92, v52
    v_lshlrev_b32 v69, 16, v52
    v_pk_fma_f32 v[24:25], v[66:67], v[64:65], v[24:25]
    v_pk_fma_f32 v[26:27], v[68:69], v[64:65], v[26:27]
    v_cvt_pk_bf16_f32 v84, v24, v25
    v_cvt_pk_bf16_f32 v85, v26, v27
    s_mov_b32 s52, 589824
    buffer_store_dwordx2 v[84:85], v15, s[48:51], s52 offen sc1
    v_and_b32 v70, s92, v55
    v_lshlrev_b32 v71, 16, v55
    v_and_b32 v72, s92, v54
    v_lshlrev_b32 v73, 16, v54
    v_pk_fma_f32 v[28:29], v[70:71], v[64:65], v[28:29]
    v_pk_fma_f32 v[30:31], v[72:73], v[64:65], v[30:31]
    v_cvt_pk_bf16_f32 v86, v28, v29
    v_cvt_pk_bf16_f32 v87, v30, v31
    s_mov_b32 s52, 884736
    buffer_store_dwordx2 v[86:87], v15, s[48:51], s52 offen sc1
    v_and_b32 v66, s92, v57
    v_lshlrev_b32 v67, 16, v57
    v_and_b32 v68, s92, v56
    v_lshlrev_b32 v69, 16, v56
    v_pk_fma_f32 v[32:33], v[66:67], v[64:65], v[32:33]
    v_pk_fma_f32 v[34:35], v[68:69], v[64:65], v[34:35]
    v_cvt_pk_bf16_f32 v88, v32, v33
    v_cvt_pk_bf16_f32 v89, v34, v35
    s_mov_b32 s52, 1179648
    buffer_store_dwordx2 v[88:89], v15, s[48:51], s52 offen sc1
    v_and_b32 v70, s92, v59
    v_lshlrev_b32 v71, 16, v59
    v_and_b32 v72, s92, v58
    v_lshlrev_b32 v73, 16, v58
    v_pk_fma_f32 v[36:37], v[70:71], v[64:65], v[36:37]
    v_pk_fma_f32 v[38:39], v[72:73], v[64:65], v[38:39]
    v_cvt_pk_bf16_f32 v90, v36, v37
    v_cvt_pk_bf16_f32 v91, v38, v39
    s_mov_b32 s52, 1474560
    buffer_store_dwordx2 v[90:91], v15, s[48:51], s52 offen sc1
    v_and_b32 v66, s92, v61
    v_lshlrev_b32 v67, 16, v61
    v_and_b32 v68, s92, v60
    v_lshlrev_b32 v69, 16, v60
    v_pk_fma_f32 v[40:41], v[66:67], v[64:65], v[40:41]
    v_pk_fma_f32 v[42:43], v[68:69], v[64:65], v[42:43]
    v_cvt_pk_bf16_f32 v92, v40, v41
    v_cvt_pk_bf16_f32 v93, v42, v43
    s_mov_b32 s52, 1769472
    buffer_store_dwordx2 v[92:93], v15, s[48:51], s52 offen sc1
    v_and_b32 v70, s92, v63
    v_lshlrev_b32 v71, 16, v63
    v_and_b32 v72, s92, v62
    v_lshlrev_b32 v73, 16, v62
    v_pk_fma_f32 v[44:45], v[70:71], v[64:65], v[44:45]
    v_pk_fma_f32 v[46:47], v[72:73], v[64:65], v[46:47]
    v_cvt_pk_bf16_f32 v94, v44, v45
    v_cvt_pk_bf16_f32 v95, v46, v47
    s_mov_b32 s52, 2064384
    buffer_store_dwordx2 v[94:95], v15, s[48:51], s52 offen sc1
Lp2end_33:
    s_waitcnt vmcnt(0)
    s_cmp_eq_u32 s41, -1
    s_cbranch_scc1 Lnc_37
    v_mov_b32 v2, 163784
    v_mov_b32 v3, 1
    s_mov_b64 exec, 1
    ds_add_rtn_u32 v3, v2, v3
    s_waitcnt lgkmcnt(0)
    v_readfirstlane_b32 s58, v3
    s_nop 0
    s_mov_b64 exec, -1
    s_cmp_lt_u32 s2, 64
    s_cselect_b32 s59, 2, 1
    s_cmp_eq_u32 s58, s59
    s_cbranch_scc0 Lnc_37
    s_lshl_b32 s60, s2, 4
    s_add_u32 s60, s60, 67584
    v_mul_u32_u24 v2, 4224, v1
    v_add_u32 v2, s60, v2
    v_mov_b32 v3, s91
    s_mov_b64 exec, 0xff
    buffer_store_dword v3, v2, s[96:99], 0 offen sc1
    s_mov_b64 exec, -1
Lnc_37:
    s_waitcnt lgkmcnt(0)
    s_barrier
    s_cmp_lt_u32 s90, 3
    s_cbranch_scc0 Lwp_38
    s_add_u32 m0, s37, s38
    s_nop 0
    buffer_load_dwordx4 v10, s[32:35], s36 offen lds
    buffer_load_dwordx4 v11, s[32:35], s36 offen offset:1024 lds
    s_mov_b64 exec, 0xffff
    buffer_load_dwordx4 v12, s[32:35], s36 offen offset:2048 lds
    s_mov_b64 exec, -1
    s_add_u32 s37, s37, 18432
    s_add_u32 s36, s36, 294912
    s_cmp_ge_u32 s37, 110592
    s_cselect_b32 s37, 0, s37
    s_add_u32 m0, s37, s38
    s_nop 0
    buffer_load_dwordx4 v10, s[32:35], s36 offen lds
    buffer_load_dwordx4 v11, s[32:35], s36 offen offset:1024 lds
    s_mov_b64 exec, 0xffff
    buffer_load_dwordx4 v12, s[32:35], s36 offen offset:2048 lds
    s_mov_b64 exec, -1
    s_add_u32 s37, s37, 18432
    s_add_u32 s36, s36, 294912
    s_cmp_ge_u32 s37, 110592
    s_cselect_b32 s37, 0, s37
    s_add_u32 m0, s37, s38
    s_nop 0
    buffer_load_dwordx4 v10, s[32:35], s36 offen lds
    buffer_load_dwordx4 v11, s[32:35], s36 offen offset:1024 lds
    s_mov_b64 exec, 0xffff
    buffer_load_dwordx4 v12, s[32:35], s36 offen offset:2048 lds
    s_mov_b64 exec, -1
    s_add_u32 s37, s37, 18432
    s_add_u32 s36, s36, 294912
    s_cmp_ge_u32 s37, 110592
    s_cselect_b32 s37, 0, s37
    s_add_u32 m0, s37, s38
    s_nop 0
    buffer_load_dwordx4 v10, s[32:35], s36 offen lds
    buffer_load_dwordx4 v11, s[32:35], s36 offen offset:1024 lds
    s_mov_b64 exec, 0xffff
    buffer_load_dwordx4 v12, s[32:35], s36 offen offset:2048 lds
    s_mov_b64 exec, -1
    s_add_u32 s37, s37, 18432
    s_add_u32 s36, s36, 294912
    s_cmp_ge_u32 s37, 110592
    s_cselect_b32 s37, 0, s37
Lwp_38:
    s_mov_b32 s62, 0x3ae38e39
    s_mov_b32 s63, 0x3727c5ac
    v_and_b32 v2, 7, v0
    v_lshrrev_b32 v5, 3, v0
    s_lshl_b32 s52, s3, 3
    v_add_u32 v6, s52, v2
    v_mul_u32_u24 v7, 1152, v6
    v_lshlrev_b32 v8, 4, v5
    v_add_u32 v7, v7, v8
    v_lshlrev_b32 v9, 5, v5
    v_lshlrev_b32 v3, 3, v1
    v_lshrrev_b32 v3, 6, v0
    v_lshlrev_b32 v3, 3, v3
    v_lshlrev_b32 v4, 7, v2
    v_add_u32 v4, 137472, v4
    v_add_u32 v3, v4, v3
    v_lshrrev_b32 v13, 4, v6
    v_mul_u32_u24 v13, 18, v13
    v_lshrrev_b32 v14, 2, v5
    v_add_u32 v13, v13, v14
    v_lshlrev_b32 v13, 10, v13
    v_and_b32 v14, 15, v6
    v_and_b32 v15, 1, v5
    v_lshlrev_b32 v15, 5, v15
    v_add_u32 v14, v14, v15
    v_lshlrev_b32 v14, 4, v14
    v_bfe_u32 v15, v5, 1, 1
    v_lshlrev_b32 v15, 3, v15
    v_add3_u32 v13, v13, v14, v15
    v_lshrrev_b32 v14, 4, v0
    v_lshlrev_b32 v14, 1, v14
    v_bfe_u32 v15, v0, 1, 1
    v_add_u32 v14, v14, v15
    v_lshlrev_b32 v14, 7, v14
    v_bfe_u32 v15, v0, 2, 2
    v_lshlrev_b32 v15, 4, v15
    v_add_u32 v14, v14, v15
    v_and_b32 v15, 1, v0
    v_lshlrev_b32 v15, 3, v15
    v_add_u32 v14, v14, v15
    v_add_u32 v14, 139520, v14
    v_lshlrev_b32 v15, 4, v0
    v_add_u32 v15, 139520, v15
    v_lshlrev_b32 v16, 6, v0
    s_lshr_b32 s52, s3, 2
    s_mul_i32 s52, s52, 36864
    s_and_b32 s53, s3, 3
    s_lshl_b32 s53, s53, 4
    s_add_u32 s52, s52, s53
    v_add_u32 v16, s52, v16
    v_add_u32 v9, 148736, v9
    v_lshlrev_b32 v17, 3, v2
    v_add_u32 v17, 138496, v17
    ds_read_b64 v[192:193], v17
    ds_read_b128 v[104:107], v9 offset:0
    ds_read_b128 v[108:111], v9 offset:16
    ds_read_b128 v[112:115], v9 offset:2304
    ds_read_b128 v[116:119], v9 offset:2320
    ds_read_b128 v[120:123], v9 offset:4608
    ds_read_b128 v[124:127], v9 offset:4624
    ds_read_b128 v[128:131], v9 offset:6912
    ds_read_b128 v[132:135], v9 offset:6928
    ds_read_b128 v[136:139], v9 offset:9216
    ds_read_b128 v[140:143], v9 offset:9232
    v_lshlrev_b32 v176, 16, v252
    v_and_b32 v177, s92, v252
    v_lshlrev_b32 v178, 16, v253
    v_and_b32 v179, s92, v253
    v_lshlrev_b32 v180, 16, v254
    v_and_b32 v181, s92, v254
    v_lshlrev_b32 v182, 16, v255
    v_and_b32 v183, s92, v255
    s_cmp_eq_u32 s90, 0
    s_cbranch_scc0 LB_39
    ds_read_b128 v[200:203], v9 offset:2048
    ds_read_b128 v[204:207], v9 offset:2064
    ds_read_b128 v[208:211], v9 offset:4352
    ds_read_b128 v[212:215], v9 offset:4368
    ds_read_b128 v[216:219], v9 offset:6656
    ds_read_b128 v[220:223], v9 offset:6672
    ds_read_b128 v[224:227], v9 offset:8960
    ds_read_b128 v[228:231], v9 offset:8976
    ds_read_b128 v[232:235], v9 offset:11264
    ds_read_b128 v[236:239], v9 offset:11280
    v_lshlrev_b32 v184, 16, v196
    v_and_b32 v185, s92, v196
    v_lshlrev_b32 v186, 16, v197
    v_and_b32 v187, s92, v197
    v_lshlrev_b32 v188, 16, v198
    v_and_b32 v189, s92, v198
    v_lshlrev_b32 v190, 16, v199
    v_and_b32 v191, s92, v199
LB_39:
    s_waitcnt lgkmcnt(0)
    v_mov_b32 v194, v193
    v_mov_b32 v195, v193
    v_mov_b32 v193, v192
    v_pk_fma_f32 v[96:97], v[112:113], v[194:195], v[194:195]
    v_pk_fma_f32 v[98:99], v[114:115], v[194:195], v[194:195]
    v_pk_fma_f32 v[100:101], v[116:117], v[194:195], v[194:195]
    v_pk_fma_f32 v[102:103], v[118:119], v[194:195], v[194:195]
    v_pk_add_f32 v[64:65], v[176:177], v[192:193] neg_lo:[0,1] neg_hi:[0,1]
    v_pk_add_f32 v[66:67], v[178:179], v[192:193] neg_lo:[0,1] neg_hi:[0,1]
    v_pk_add_f32 v[68:69], v[180:181], v[192:193] neg_lo:[0,1] neg_hi:[0,1]
    v_pk_add_f32 v[70:71], v[182:183], v[192:193] neg_lo:[0,1] neg_hi:[0,1]
    v_pk_fma_f32 v[64:65], v[64:65], v[96:97], v[104:105]
    v_pk_fma_f32 v[66:67], v[66:67], v[98:99], v[106:107]
    v_pk_fma_f32 v[68:69], v[68:69], v[100:101], v[108:109]
    v_pk_fma_f32 v[70:71], v[70:71], v[102:103], v[110:111]
    s_cmp_eq_u32 s90, 0
    s_cbranch_scc0 LB_40
    v_pk_fma_f32 v[96:97], v[208:209], v[194:195], v[194:195]
    v_pk_fma_f32 v[98:99], v[210:211], v[194:195], v[194:195]
    v_pk_fma_f32 v[100:101], v[212:213], v[194:195], v[194:195]
    v_pk_fma_f32 v[102:103], v[214:215], v[194:195], v[194:195]
    v_pk_add_f32 v[72:73], v[184:185], v[192:193] neg_lo:[0,1] neg_hi:[0,1]
    v_pk_add_f32 v[74:75], v[186:187], v[192:193] neg_lo:[0,1] neg_hi:[0,1]
    v_pk_add_f32 v[76:77], v[188:189], v[192:193] neg_lo:[0,1] neg_hi:[0,1]
    v_pk_add_f32 v[78:79], v[190:191], v[192:193] neg_lo:[0,1] neg_hi:[0,1]
    v_pk_fma_f32 v[72:73], v[72:73], v[96:97], v[200:201]
    v_pk_fma_f32 v[74:75], v[74:75], v[98:99], v[202:203]
    v_pk_fma_f32 v[76:77], v[76:77], v[100:101], v[204:205]
    v_pk_fma_f32 v[78:79], v[78:79], v[102:103], v[206:207]
LB_40:
    s_cmp_eq_u32 s90, 7
    s_cbranch_scc0 Lw_41
    s_and_b32 s88, s2, 7
    s_mul_i32 s88, s88, 4224
    s_add_u32 s88, s88, 67584
    v_lshlrev_b32 v34, 4, v1
    s_mov_b32 s61, 0
Lpoll_42:
    s_add_u32 s60, s88, 0
    buffer_load_dword v35, v34, s[96:99], s60 offen sc1
    s_add_u32 s60, s88, 1024
    buffer_load_dword v36, v34, s[96:99], s60 offen sc1
    s_add_u32 s60, s88, 2048
    buffer_load_dword v37, v34, s[96:99], s60 offen sc1
    s_add_u32 s60, s88, 3072
    buffer_load_dword v38, v34, s[96:99], s60 offen sc1
    s_waitcnt vmcnt(0)
    v_cmp_ne_u32 vcc, s91, v35
    v_cmp_ne_u32 s[86:87], s91, v36
    s_or_b64 vcc, vcc, s[86:87]
    v_cmp_ne_u32 s[86:87], s91, v37
    s_or_b64 vcc, vcc, s[86:87]
    v_cmp_ne_u32 s[86:87], s91, v38
    s_or_b64 vcc, vcc, s[86:87]
    s_cmp_eq_u64 vcc, 0
    s_cbranch_scc1 Lpd_43
    s_add_u32 s61, s61, 1
    s_cmp_lt_u32 s61, s93
    s_cbranch_scc1 Lpoll_42
Lpd_43:
    s_cmp_eq_u32 s2, 0
    s_cbranch_scc0 Le_44
    v_mov_b32 v34, 0
    v_mov_b32 v35, s91
    s_mov_b64 exec, 1
    buffer_store_dword v35, v34, s[96:99], 0 offen sc1
    s_mov_b64 exec, -1
Le_44:
Lw_41:
    s_barrier
    s_add_u32 s44, s30, 2490368
    s_addc_u32 s45, s31, 0
    s_mov_b32 s46, 2359296
    s_mov_b32 s47, 0x20000
    buffer_load_dwordx4 v[20:23], v16, s[44:47], 0 offen sc1
    s_cmp_eq_u32 s90, 0
    s_cbranch_scc0 LB_45
    s_mov_b32 s52, 32768
    buffer_load_dwordx4 v[24:27], v16, s[44:47], s52 offen sc1
    s_waitcnt vmcnt(0)
    ds_write_b128 v15, v[24:27] offset:8192
LB_45:
    s_waitcnt vmcnt(0)
    ds_write_b128 v15, v[20:23]
    s_add_u32 s44, s30, 7340032
    s_addc_u32 s45, s31, 0
    s_mov_b32 s46, 2359296
    s_mov_b32 s47, 0x20000
    s_add_u32 s52, s30, 4980736
    s_addc_u32 s53, s31, 0
    s_mov_b32 s54, 2359296
    s_mov_b32 s55, 0x20000
    s_waitcnt lgkmcnt(0)
    s_barrier
    ds_read_b64_tr_b16 v[20:21], v14
    ds_read_b64_tr_b16 v[22:23], v14 offset:64
    s_cmp_eq_u32 s90, 0
    s_cbranch_scc0 LB_46
    ds_read_b64_tr_b16 v[24:25], v14 offset:8192
    ds_read_b64_tr_b16 v[26:27], v14 offset:8256
    s_waitcnt lgkmcnt(0)
    v_lshlrev_b32 v88, 16, v24
    v_and_b32 v89, s92, v24
    v_lshlrev_b32 v90, 16, v25
    v_and_b32 v91, s92, v25
    v_lshlrev_b32 v92, 16, v26
    v_and_b32 v93, s92, v26
    v_lshlrev_b32 v94, 16, v27
    v_and_b32 v95, s92, v27
    v_pk_mul_f32 v[72:73], v[72:73], v[88:89]
    v_pk_mul_f32 v[74:75], v[74:75], v[90:91]
    v_pk_mul_f32 v[76:77], v[76:77], v[92:93]
    v_pk_mul_f32 v[78:79], v[78:79], v[94:95]
    v_pk_fma_f32 v[184:185], v[72:73], v[216:217], v[184:185]
    v_pk_fma_f32 v[186:187], v[74:75], v[218:219], v[186:187]
    v_pk_fma_f32 v[188:189], v[76:77], v[220:221], v[188:189]
    v_pk_fma_f32 v[190:191], v[78:79], v[222:223], v[190:191]
    v_cvt_pk_bf16_f32 v24, v184, v185
    v_cvt_pk_bf16_f32 v25, v186, v187
    v_cvt_pk_bf16_f32 v26, v188, v189
    v_cvt_pk_bf16_f32 v27, v190, v191
    buffer_store_dwordx4 v[24:27], v7, s[44:47], 0 offen offset:1024 sc1
LB_46:
    s_waitcnt lgkmcnt(0)
    v_lshlrev_b32 v80, 16, v20
    v_and_b32 v81, s92, v20
    v_lshlrev_b32 v82, 16, v21
    v_and_b32 v83, s92, v21
    v_lshlrev_b32 v84, 16, v22
    v_and_b32 v85, s92, v22
    v_lshlrev_b32 v86, 16, v23
    v_and_b32 v87, s92, v23
    v_pk_mul_f32 v[64:65], v[64:65], v[80:81]
    v_pk_mul_f32 v[66:67], v[66:67], v[82:83]
    v_pk_mul_f32 v[68:69], v[68:69], v[84:85]
    v_pk_mul_f32 v[70:71], v[70:71], v[86:87]
    v_pk_fma_f32 v[176:177], v[64:65], v[120:121], v[176:177]
    v_pk_fma_f32 v[178:179], v[66:67], v[122:123], v[178:179]
    v_pk_fma_f32 v[180:181], v[68:69], v[124:125], v[180:181]
    v_pk_fma_f32 v[182:183], v[70:71], v[126:127], v[182:183]
    v_cvt_pk_bf16_f32 v20, v176, v177
    v_cvt_pk_bf16_f32 v21, v178, v179
    v_cvt_pk_bf16_f32 v22, v180, v181
    v_cvt_pk_bf16_f32 v23, v182, v183
    buffer_store_dwordx4 v[20:23], v7, s[44:47], 0 offen offset:0 sc1
    v_pk_add_f32 v[44:45], v[176:177], v[178:179]
    v_pk_mul_f32 v[46:47], v[176:177], v[176:177]
    v_pk_add_f32 v[44:45], v[44:45], v[180:181]
    v_pk_fma_f32 v[46:47], v[178:179], v[178:179], v[46:47]
    v_pk_add_f32 v[44:45], v[44:45], v[182:183]
    v_pk_fma_f32 v[46:47], v[180:181], v[180:181], v[46:47]
    v_pk_fma_f32 v[46:47], v[182:183], v[182:183], v[46:47]
    s_cmp_eq_u32 s90, 0
    s_cbranch_scc0 Lx_47
    v_pk_add_f32 v[44:45], v[44:45], v[184:185]
    v_pk_fma_f32 v[46:47], v[184:185], v[184:185], v[46:47]
    v_pk_add_f32 v[44:45], v[44:45], v[186:187]
    v_pk_fma_f32 v[46:47], v[186:187], v[186:187], v[46:47]
    v_pk_add_f32 v[44:45], v[44:45], v[188:189]
    v_pk_fma_f32 v[46:47], v[188:189], v[188:189], v[46:47]
    v_pk_add_f32 v[44:45], v[44:45], v[190:191]
    v_pk_fma_f32 v[46:47], v[190:191], v[190:191], v[46:47]
Lx_47:
    v_add_f32 v40, v44, v45
    v_add_f32 v41, v46, v47
    s_nop 1
    v_add_f32_dpp v42, v40, v40 row_ror:8 row_mask:0xf bank_mask:0xf
    v_add_f32_dpp v43, v41, v41 row_ror:8 row_mask:0xf bank_mask:0xf
    v_mov_b32 v40, v42
    v_mov_b32 v41, v43
    s_nop 1
    v_permlane16_swap_b32 v40, v42
    v_permlane16_swap_b32 v41, v43
    s_nop 1
    v_pk_add_f32 v[42:43], v[40:41], v[42:43]
    v_mov_b32 v40, v42
    v_mov_b32 v41, v43
    s_nop 1
    v_permlane32_swap_b32 v40, v42
    v_permlane32_swap_b32 v41, v43
    s_nop 1
    v_pk_add_f32 v[42:43], v[40:41], v[42:43]
    s_mov_b64 exec, 0xff
    ds_write_b64 v3, v[42:43] offset:0
    s_mov_b64 exec, -1
    s_waitcnt lgkmcnt(0)
    s_barrier
    ds_read_b128 v[44:47], v4 offset:0
    ds_read_b128 v[48:51], v4 offset:16
    ds_read_b128 v[52:55], v4 offset:32
    ds_read_b128 v[56:59], v4 offset:48
    s_waitcnt lgkmcnt(0)
    v_pk_add_f32 v[44:45], v[44:45], v[46:47]
    v_pk_add_f32 v[48:49], v[48:49], v[50:51]
    v_pk_add_f32 v[52:53], v[52:53], v[54:55]
    v_pk_add_f32 v[56:57], v[56:57], v[58:59]
    v_pk_add_f32 v[44:45], v[44:45], v[48:49]
    v_pk_add_f32 v[52:53], v[52:53], v[56:57]
    v_pk_add_f32 v[44:45], v[44:45], v[52:53]
    v_mul_f32 v40, s62, v44
    v_mul_f32 v45, s62, v45
    v_fma_f32 v45, -v40, v40, v45
    v_max_f32 v45, 0, v45
    v_add_f32 v45, s63, v45
    v_rsq_f32 v42, v45
    v_mov_b32 v41, v40
    v_mov_b32 v43, v42
    s_cmp_eq_u32 s90, 0
    s_cbranch_scc0 LB_48
    v_pk_fma_f32 v[96:97], v[232:233], v[42:43], v[42:43]
    v_pk_fma_f32 v[98:99], v[234:235], v[42:43], v[42:43]
    v_pk_fma_f32 v[100:101], v[236:237], v[42:43], v[42:43]
    v_pk_fma_f32 v[102:103], v[238:239], v[42:43], v[42:43]
    v_pk_add_f32 v[72:73], v[184:185], v[40:41] neg_lo:[0,1] neg_hi:[0,1]
    v_pk_add_f32 v[74:75], v[186:187], v[40:41] neg_lo:[0,1] neg_hi:[0,1]
    v_pk_add_f32 v[76:77], v[188:189], v[40:41] neg_lo:[0,1] neg_hi:[0,1]
    v_pk_add_f32 v[78:79], v[190:191], v[40:41] neg_lo:[0,1] neg_hi:[0,1]
    v_pk_fma_f32 v[72:73], v[72:73], v[96:97], v[224:225]
    v_pk_fma_f32 v[74:75], v[74:75], v[98:99], v[226:227]
    v_pk_fma_f32 v[76:77], v[76:77], v[100:101], v[228:229]
    v_pk_fma_f32 v[78:79], v[78:79], v[102:103], v[230:231]
    v_cvt_pk_bf16_f32 v36, v72, v73
    v_cvt_pk_bf16_f32 v37, v74, v75
    v_cvt_pk_bf16_f32 v38, v76, v77
    v_cvt_pk_bf16_f32 v39, v78, v79
    s_mov_b32 s60, 16384
    buffer_store_dwordx2 v[36:37], v13, s[52:55], s60 offen sc1
    buffer_store_dwordx2 v[38:39], v13, s[52:55], s60 offen offset:256 sc1
LB_48:
    v_pk_fma_f32 v[96:97], v[136:137], v[42:43], v[42:43]
    v_pk_fma_f32 v[98:99], v[138:139], v[42:43], v[42:43]
    v_pk_fma_f32 v[100:101], v[140:141], v[42:43], v[42:43]
    v_pk_fma_f32 v[102:103], v[142:143], v[42:43], v[42:43]
    v_pk_add_f32 v[64:65], v[176:177], v[40:41] neg_lo:[0,1] neg_hi:[0,1]
    v_pk_add_f32 v[66:67], v[178:179], v[40:41] neg_lo:[0,1] neg_hi:[0,1]
    v_pk_add_f32 v[68:69], v[180:181], v[40:41] neg_lo:[0,1] neg_hi:[0,1]
    v_pk_add_f32 v[70:71], v[182:183], v[40:41] neg_lo:[0,1] neg_hi:[0,1]
    v_pk_fma_f32 v[64:65], v[64:65], v[96:97], v[128:129]
    v_pk_fma_f32 v[66:67], v[66:67], v[98:99], v[130:131]
    v_pk_fma_f32 v[68:69], v[68:69], v[100:101], v[132:133]
    v_pk_fma_f32 v[70:71], v[70:71], v[102:103], v[134:135]
    v_cvt_pk_bf16_f32 v24, v64, v65
    v_cvt_pk_bf16_f32 v25, v66, v67
    v_cvt_pk_bf16_f32 v26, v68, v69
    v_cvt_pk_bf16_f32 v27, v70, v71
    s_mov_b32 s60, 0
    buffer_store_dwordx2 v[24:25], v13, s[52:55], s60 offen sc1
    buffer_store_dwordx2 v[26:27], v13, s[52:55], s60 offen offset:256 sc1
    s_waitcnt vmcnt(0) lgkmcnt(0)
    s_barrier
    s_cmp_eq_u32 s90, 0
    s_cbranch_scc0 Lsig_49
    s_lshl_b32 s60, s3, 4
    s_add_u32 s60, s60, 101376
    v_mul_u32_u24 v2, 4224, v1
    v_add_u32 v2, s60, v2
    v_mov_b32 v3, s91
    s_mov_b64 exec, 0xff
    buffer_store_dword v3, v2, s[96:99], 0 offen sc1
    s_mov_b64 exec, -1
Lsig_49:
    s_cmp_eq_u32 s90, 6
    s_cbranch_scc0 Lt_50
    s_mov_b32 s44, s22
    s_mov_b32 s45, s23
    s_mov_b32 s46, 5308416
    s_mov_b32 s47, 0x20000
    s_mul_i32 s52, s2, 20736
    v_lshlrev_b32 v2, 7, v1
    v_add_u32 v2, s52, v2
    s_mov_b32 s53, 0
    buffer_load_dword v236, v2, s[44:47], s53 offen
    s_mov_b32 s53, 8192
    buffer_load_dword v237, v2, s[44:47], s53 offen
    s_mov_b32 exec_hi, 3
    s_mov_b32 s53, 16384
    buffer_load_dword v238, v2, s[44:47], s53 offen
    s_mov_b64 exec, -1
Lt_50:
    s_cmp_eq_u32 s90, 7
    s_cbranch_scc0 Lw_51
    s_lshl_b32 s52, s95, 5
    s_and_b32 s88, s2, 7
    s_mul_i32 s88, s88, 4224
    s_add_u32 s88, s88, 101376
    s_lshl_b32 s60, s52, 4
    s_add_u32 s60, s60, s88
    v_lshlrev_b32 v4, 4, v1
    v_add_u32 v4, s60, v4
    v_cmp_gt_u32 vcc, 32, v1
    s_mov_b64 exec, vcc
    s_mov_b32 s61, 0
Lpoll_52:
    buffer_load_dword v5, v4, s[96:99], 0 offen sc1
    s_waitcnt vmcnt(0)
    v_cmp_ne_u32 vcc, s91, v5
    s_cmp_eq_u64 vcc, 0
    s_cbranch_scc1 Lpd_53
    s_add_u32 s61, s61, 1
    s_cmp_lt_u32 s61, s93
    s_cbranch_scc1 Lpoll_52
Lpd_53:
    s_mov_b64 exec, -1
Lw_51:
    s_lshl_b32 s52, s95, 4
    s_lshl_b32 s53, s90, 1
    s_add_u32 s69, s52, s53
    s_mul_i32 s40, s69, 18432
    v_lshlrev_b32 v9, 4, v1
    s_add_u32 s44, s30, 4980736
    s_addc_u32 s45, s31, 0
    s_mov_b32 s46, 2359296
    s_mov_b32 s47, 0x20000
    v_lshrrev_b32 v5, 2, v1
    v_mul_u32_u24 v5, 288, v5
    v_and_b32 v6, 3, v1
    v_lshlrev_b32 v6, 3, v6
    v_add_u32 v13, v5, v6
    v_mov_b32 v16, 0
    v_mov_b32 v17, 0
    v_mov_b32 v18, 0
    v_mov_b32 v19, 0
    v_mov_b32 v20, 0
    v_mov_b32 v21, 0
    v_mov_b32 v22, 0
    v_mov_b32 v23, 0
    v_mov_b32 v24, 0
    v_mov_b32 v25, 0
    v_mov_b32 v26, 0
    v_mov_b32 v27, 0
    v_mov_b32 v28, 0
    v_mov_b32 v29, 0
    v_mov_b32 v30, 0
    v_mov_b32 v31, 0
    v_mov_b32 v32, 0
    v_mov_b32 v33, 0
    v_mov_b32 v34, 0
    v_mov_b32 v35, 0
    v_mov_b32 v36, 0
    v_mov_b32 v37, 0
    v_mov_b32 v38, 0
    v_mov_b32 v39, 0
    v_mov_b32 v40, 0
    v_mov_b32 v41, 0
    v_mov_b32 v42, 0
    v_mov_b32 v43, 0
    v_mov_b32 v44, 0
    v_mov_b32 v45, 0
    v_mov_b32 v46, 0
    v_mov_b32 v47, 0
    v_mov_b32 v48, 0
    v_mov_b32 v49, 0
    v_mov_b32 v50, 0
    v_mov_b32 v51, 0
    v_mov_b32 v52, 0
    v_mov_b32 v53, 0
    v_mov_b32 v54, 0
    v_mov_b32 v55, 0
    v_mov_b32 v56, 0
    v_mov_b32 v57, 0
    v_mov_b32 v58, 0
    v_mov_b32 v59, 0
    v_mov_b32 v60, 0
    v_mov_b32 v61, 0
    v_mov_b32 v62, 0
    v_mov_b32 v63, 0
    v_mov_b32 v64, 0
    v_mov_b32 v65, 0
    v_mov_b32 v66, 0
    v_mov_b32 v67, 0
    v_mov_b32 v68, 0
    v_mov_b32 v69, 0
    v_mov_b32 v70, 0
    v_mov_b32 v71, 0
    v_mov_b32 v72, 0
    v_mov_b32 v73, 0
    v_mov_b32 v74, 0
    v_mov_b32 v75, 0
    v_mov_b32 v76, 0
    v_mov_b32 v77, 0
    v_mov_b32 v78, 0
    v_mov_b32 v79, 0
    v_mov_b32 v80, 0
    v_mov_b32 v81, 0
    v_mov_b32 v82, 0
    v_mov_b32 v83, 0
    v_mov_b32 v84, 0
    v_mov_b32 v85, 0
    v_mov_b32 v86, 0
    v_mov_b32 v87, 0
    v_mov_b32 v88, 0
    v_mov_b32 v89, 0
    v_mov_b32 v90, 0
    v_mov_b32 v91, 0
    v_mov_b32 v92, 0
    v_mov_b32 v93, 0
    v_mov_b32 v94, 0
    v_mov_b32 v95, 0
    v_mov_b32 v96, 0
    v_mov_b32 v97, 0
    v_mov_b32 v98, 0
    v_mov_b32 v99, 0
    v_mov_b32 v100, 0
    v_mov_b32 v101, 0
    v_mov_b32 v102, 0
    v_mov_b32 v103, 0
    v_mov_b32 v104, 0
    v_mov_b32 v105, 0
    v_mov_b32 v106, 0
    v_mov_b32 v107, 0
    v_mov_b32 v108, 0
    v_mov_b32 v109, 0
    v_mov_b32 v110, 0
    v_mov_b32 v111, 0
    v_mov_b32 v112, 0
    v_mov_b32 v113, 0
    v_mov_b32 v114, 0
    v_mov_b32 v115, 0
    v_mov_b32 v116, 0
    v_mov_b32 v117, 0
    v_mov_b32 v118, 0
    v_mov_b32 v119, 0
    v_mov_b32 v120, 0
    v_mov_b32 v121, 0
    v_mov_b32 v122, 0
    v_mov_b32 v123, 0
    v_mov_b32 v124, 0
    v_mov_b32 v125, 0
    v_mov_b32 v126, 0
    v_mov_b32 v127, 0
    v_mov_b32 v128, 0
    v_mov_b32 v129, 0
    v_mov_b32 v130, 0
    v_mov_b32 v131, 0
    v_mov_b32 v132, 0
    v_mov_b32 v133, 0
    v_mov_b32 v134, 0
    v_mov_b32 v135, 0
    v_mov_b32 v136, 0
    v_mov_b32 v137, 0
    v_mov_b32 v138, 0
    v_mov_b32 v139, 0
    v_mov_b32 v140, 0
    v_mov_b32 v141, 0
    v_mov_b32 v142, 0
    v_mov_b32 v143, 0
    v_mov_b32 v144, 0
    v_mov_b32 v145, 0
    v_mov_b32 v146, 0
    v_mov_b32 v147, 0
    v_mov_b32 v148, 0
    v_mov_b32 v149, 0
    v_mov_b32 v150, 0
    v_mov_b32 v151, 0
    v_mov_b32 v152, 0
    v_mov_b32 v153, 0
    v_mov_b32 v154, 0
    v_mov_b32 v155, 0
    v_mov_b32 v156, 0
    v_mov_b32 v157, 0
    v_mov_b32 v158, 0
    v_mov_b32 v159, 0
    s_barrier
    s_add_u32 s41, s40, 18432
    buffer_load_dwordx4 v[184:187], v9, s[44:47], s40 offen sc1
    buffer_load_dwordx4 v[188:191], v9, s[44:47], s41 offen sc1
    s_add_u32 s40, s40, 1024
    s_add_u32 s41, s40, 18432
    buffer_load_dwordx4 v[192:195], v9, s[44:47], s40 offen sc1
    buffer_load_dwordx4 v[196:199], v9, s[44:47], s41 offen sc1
    s_add_u32 s40, s40, 1024
    v_mov_b32 v14, v13
    s_mov_b32 s42, 18432
    ds_read_b64_tr_b16 v[160:161], v14 offset:0
    ds_read_b64_tr_b16 v[162:163], v14 offset:4608
    ds_read_b64_tr_b16 v[164:165], v14 offset:9216
    ds_read_b64_tr_b16 v[166:167], v14 offset:13824
    ds_read_b64_tr_b16 v[168:169], v14 offset:32
    ds_read_b64_tr_b16 v[170:171], v14 offset:4640
    ds_read_b64_tr_b16 v[172:173], v14 offset:9248
    ds_read_b64_tr_b16 v[174:175], v14 offset:13856
    s_mov_b32 s43, 0
    s_waitcnt vmcnt(0)
Lg1_54:
    s_waitcnt vmcnt(8)
    s_barrier
    v_add_u32 v15, s42, v13
    s_add_u32 s42, s42, 18432
    s_cmp_ge_u32 s42, 110592
    s_cselect_b32 s42, 0, s42
    s_waitcnt lgkmcnt(6)
    v_mfma_f32_16x16x32_bf16 v[16:19], v[160:163], v[184:187], v[16:19]
    ds_read_b64_tr_b16 v[176:177], v14 offset:64
    v_mfma_f32_16x16x32_bf16 v[20:23], v[160:163], v[188:191], v[20:23]
    ds_read_b64_tr_b16 v[178:179], v14 offset:4672
    s_waitcnt lgkmcnt(6)
    v_mfma_f32_16x16x32_bf16 v[24:27], v[164:167], v[184:187], v[24:27]
    ds_read_b64_tr_b16 v[180:181], v14 offset:9280
    s_add_u32 s41, s40, 18432
    buffer_load_dwordx4 v[200:203], v9, s[44:47], s40 offen sc1
    v_mfma_f32_16x16x32_bf16 v[28:31], v[164:167], v[188:191], v[28:31]
    ds_read_b64_tr_b16 v[182:183], v14 offset:13888
    s_waitcnt lgkmcnt(6)
    v_mfma_f32_16x16x32_bf16 v[32:35], v[168:171], v[184:187], v[32:35]
    ds_read_b64_tr_b16 v[160:161], v14 offset:96
    v_mfma_f32_16x16x32_bf16 v[36:39], v[168:171], v[188:191], v[36:39]
    ds_read_b64_tr_b16 v[162:163], v14 offset:4704
    s_waitcnt lgkmcnt(6)
    v_mfma_f32_16x16x32_bf16 v[40:43], v[172:175], v[184:187], v[40:43]
    ds_read_b64_tr_b16 v[164:165], v14 offset:9312
    buffer_load_dwordx4 v[204:207], v9, s[44:47], s41 offen sc1
    s_add_u32 s40, s40, 1024
    v_mfma_f32_16x16x32_bf16 v[44:47], v[172:175], v[188:191], v[44:47]
    ds_read_b64_tr_b16 v[166:167], v14 offset:13920
    s_waitcnt lgkmcnt(6)
    v_mfma_f32_16x16x32_bf16 v[48:51], v[176:179], v[184:187], v[48:51]
    ds_read_b64_tr_b16 v[168:169], v14 offset:128
    v_mfma_f32_16x16x32_bf16 v[52:55], v[176:179], v[188:191], v[52:55]
    ds_read_b64_tr_b16 v[170:171], v14 offset:4736
    s_waitcnt lgkmcnt(6)
    v_mfma_f32_16x16x32_bf16 v[56:59], v[180:183], v[184:187], v[56:59]
    ds_read_b64_tr_b16 v[172:173], v14 offset:9344
    s_add_u32 m0, s37, s38
    s_nop 0
    buffer_load_dwordx4 v10, s[32:35], s36 offen lds
    v_mfma_f32_16x16x32_bf16 v[60:63], v[180:183], v[188:191], v[60:63]
    ds_read_b64_tr_b16 v[174:175], v14 offset:13952
    s_waitcnt lgkmcnt(6)
    v_mfma_f32_16x16x32_bf16 v[64:67], v[160:163], v[184:187], v[64:67]
    ds_read_b64_tr_b16 v[176:177], v14 offset:160
    v_mfma_f32_16x16x32_bf16 v[68:71], v[160:163], v[188:191], v[68:71]
    ds_read_b64_tr_b16 v[178:179], v14 offset:4768
    s_waitcnt lgkmcnt(6)
    v_mfma_f32_16x16x32_bf16 v[72:75], v[164:167], v[184:187], v[72:75]
    ds_read_b64_tr_b16 v[180:181], v14 offset:9376
    v_mfma_f32_16x16x32_bf16 v[76:79], v[164:167], v[188:191], v[76:79]
    ds_read_b64_tr_b16 v[182:183], v14 offset:13984
    s_waitcnt lgkmcnt(6)
    v_mfma_f32_16x16x32_bf16 v[80:83], v[168:171], v[184:187], v[80:83]
    ds_read_b64_tr_b16 v[160:161], v14 offset:192
    buffer_load_dwordx4 v11, s[32:35], s36 offen offset:1024 lds
    v_mfma_f32_16x16x32_bf16 v[84:87], v[168:171], v[188:191], v[84:87]
    ds_read_b64_tr_b16 v[162:163], v14 offset:4800
    s_waitcnt lgkmcnt(6)
    v_mfma_f32_16x16x32_bf16 v[88:91], v[172:175], v[184:187], v[88:91]
    ds_read_b64_tr_b16 v[164:165], v14 offset:9408
    v_mfma_f32_16x16x32_bf16 v[92:95], v[172:175], v[188:191], v[92:95]
    ds_read_b64_tr_b16 v[166:167], v14 offset:14016
    s_waitcnt lgkmcnt(6)
    v_mfma_f32_16x16x32_bf16 v[96:99], v[176:179], v[184:187], v[96:99]
    ds_read_b64_tr_b16 v[168:169], v14 offset:224
    v_mfma_f32_16x16x32_bf16 v[100:103], v[176:179], v[188:191], v[100:103]
    ds_read_b64_tr_b16 v[170:171], v14 offset:4832
    s_waitcnt lgkmcnt(6)
    v_mfma_f32_16x16x32_bf16 v[104:107], v[180:183], v[184:187], v[104:107]
    ds_read_b64_tr_b16 v[172:173], v14 offset:9440
    s_mov_b64 exec, 0xffff
    buffer_load_dwordx4 v12, s[32:35], s36 offen offset:2048 lds
    s_mov_b64 exec, -1
    s_add_u32 s37, s37, 18432
    s_add_u32 s36, s36, 294912
    s_cmp_ge_u32 s37, 110592
    s_cselect_b32 s37, 0, s37
    v_mfma_f32_16x16x32_bf16 v[108:111], v[180:183], v[188:191], v[108:111]
    ds_read_b64_tr_b16 v[174:175], v14 offset:14048
    s_waitcnt lgkmcnt(6)
    v_mfma_f32_16x16x32_bf16 v[112:115], v[160:163], v[184:187], v[112:115]
    ds_read_b64_tr_b16 v[176:177], v14 offset:256
    v_mfma_f32_16x16x32_bf16 v[116:119], v[160:163], v[188:191], v[116:119]
    ds_read_b64_tr_b16 v[178:179], v14 offset:4864
    s_waitcnt lgkmcnt(6)
    v_mfma_f32_16x16x32_bf16 v[120:123], v[164:167], v[184:187], v[120:123]
    ds_read_b64_tr_b16 v[180:181], v14 offset:9472
    v_mfma_f32_16x16x32_bf16 v[124:127], v[164:167], v[188:191], v[124:127]
    ds_read_b64_tr_b16 v[182:183], v14 offset:14080
    s_waitcnt lgkmcnt(6)
    v_mfma_f32_16x16x32_bf16 v[128:131], v[168:171], v[184:187], v[128:131]
    ds_read_b64_tr_b16 v[160:161], v15 offset:0
    v_mfma_f32_16x16x32_bf16 v[132:135], v[168:171], v[188:191], v[132:135]
    ds_read_b64_tr_b16 v[162:163], v15 offset:4608
    s_waitcnt lgkmcnt(6)
    v_mfma_f32_16x16x32_bf16 v[136:139], v[172:175], v[184:187], v[136:139]
    ds_read_b64_tr_b16 v[164:165], v15 offset:9216
    v_mfma_f32_16x16x32_bf16 v[140:143], v[172:175], v[188:191], v[140:143]
    ds_read_b64_tr_b16 v[166:167], v15 offset:13824
    s_waitcnt lgkmcnt(6)
    v_mfma_f32_16x16x32_bf16 v[144:147], v[176:179], v[184:187], v[144:147]
    ds_read_b64_tr_b16 v[168:169], v15 offset:32
    v_mfma_f32_16x16x32_bf16 v[148:151], v[176:179], v[188:191], v[148:151]
    ds_read_b64_tr_b16 v[170:171], v15 offset:4640
    s_waitcnt lgkmcnt(6)
    v_mfma_f32_16x16x32_bf16 v[152:155], v[180:183], v[184:187], v[152:155]
    ds_read_b64_tr_b16 v[172:173], v15 offset:9248
    v_mfma_f32_16x16x32_bf16 v[156:159], v[180:183], v[188:191], v[156:159]
    ds_read_b64_tr_b16 v[174:175], v15 offset:13856
    v_mov_b32 v14, v15
    s_waitcnt vmcnt(8)
    s_barrier
    v_add_u32 v15, s42, v13
    s_add_u32 s42, s42, 18432
    s_cmp_ge_u32 s42, 110592
    s_cselect_b32 s42, 0, s42
    s_waitcnt lgkmcnt(6)
    v_mfma_f32_16x16x32_bf16 v[16:19], v[160:163], v[192:195], v[16:19]
    ds_read_b64_tr_b16 v[176:177], v14 offset:64
    v_mfma_f32_16x16x32_bf16 v[20:23], v[160:163], v[196:199], v[20:23]
    ds_read_b64_tr_b16 v[178:179], v14 offset:4672
    s_waitcnt lgkmcnt(6)
    v_mfma_f32_16x16x32_bf16 v[24:27], v[164:167], v[192:195], v[24:27]
    ds_read_b64_tr_b16 v[180:181], v14 offset:9280
    s_add_u32 s41, s40, 18432
    buffer_load_dwordx4 v[184:187], v9, s[44:47], s40 offen sc1
    v_mfma_f32_16x16x32_bf16 v[28:31], v[164:167], v[196:199], v[28:31]
    ds_read_b64_tr_b16 v[182:183], v14 offset:13888
    s_waitcnt lgkmcnt(6)
    v_mfma_f32_16x16x32_bf16 v[32:35], v[168:171], v[192:195], v[32:35]
    ds_read_b64_tr_b16 v[160:161], v14 offset:96
    v_mfma_f32_16x16x32_bf16 v[36:39], v[168:171], v[196:199], v[36:39]
    ds_read_b64_tr_b16 v[162:163], v14 offset:4704
    s_waitcnt lgkmcnt(6)
    v_mfma_f32_16x16x32_bf16 v[40:43], v[172:175], v[192:195], v[40:43]
    ds_read_b64_tr_b16 v[164:165], v14 offset:9312
    buffer_load_dwordx4 v[188:191], v9, s[44:47], s41 offen sc1
    s_add_u32 s40, s40, 1024
    v_mfma_f32_16x16x32_bf16 v[44:47], v[172:175], v[196:199], v[44:47]
    ds_read_b64_tr_b16 v[166:167], v14 offset:13920
    s_waitcnt lgkmcnt(6)
    v_mfma_f32_16x16x32_bf16 v[48:51], v[176:179], v[192:195], v[48:51]
    ds_read_b64_tr_b16 v[168:169], v14 offset:128
    v_mfma_f32_16x16x32_bf16 v[52:55], v[176:179], v[196:199], v[52:55]
    ds_read_b64_tr_b16 v[170:171], v14 offset:4736
    s_waitcnt lgkmcnt(6)
    v_mfma_f32_16x16x32_bf16 v[56:59], v[180:183], v[192:195], v[56:59]
    ds_read_b64_tr_b16 v[172:173], v14 offset:9344
    s_add_u32 m0, s37, s38
    s_nop 0
    buffer_load_dwordx4 v10, s[32:35], s36 offen lds
    v_mfma_f32_16x16x32_bf16 v[60:63], v[180:183], v[196:199], v[60:63]
    ds_read_b64_tr_b16 v[174:175], v14 offset:13952
    s_waitcnt lgkmcnt(6)
    v_mfma_f32_16x16x32_bf16 v[64:67], v[160:163], v[192:195], v[64:67]
    ds_read_b64_tr_b16 v[176:177], v14 offset:160
    v_mfma_f32_16x16x32_bf16 v[68:71], v[160:163], v[196:199], v[68:71]
    ds_read_b64_tr_b16 v[178:179], v14 offset:4768
    s_waitcnt lgkmcnt(6)
    v_mfma_f32_16x16x32_bf16 v[72:75], v[164:167], v[192:195], v[72:75]
    ds_read_b64_tr_b16 v[180:181], v14 offset:9376
    v_mfma_f32_16x16x32_bf16 v[76:79], v[164:167], v[196:199], v[76:79]
    ds_read_b64_tr_b16 v[182:183], v14 offset:13984
    s_waitcnt lgkmcnt(6)
    v_mfma_f32_16x16x32_bf16 v[80:83], v[168:171], v[192:195], v[80:83]
    ds_read_b64_tr_b16 v[160:161], v14 offset:192
    buffer_load_dwordx4 v11, s[32:35], s36 offen offset:1024 lds
    v_mfma_f32_16x16x32_bf16 v[84:87], v[168:171], v[196:199], v[84:87]
    ds_read_b64_tr_b16 v[162:163], v14 offset:4800
    s_waitcnt lgkmcnt(6)
    v_mfma_f32_16x16x32_bf16 v[88:91], v[172:175], v[192:195], v[88:91]
    ds_read_b64_tr_b16 v[164:165], v14 offset:9408
    v_mfma_f32_16x16x32_bf16 v[92:95], v[172:175], v[196:199], v[92:95]
    ds_read_b64_tr_b16 v[166:167], v14 offset:14016
    s_waitcnt lgkmcnt(6)
    v_mfma_f32_16x16x32_bf16 v[96:99], v[176:179], v[192:195], v[96:99]
    ds_read_b64_tr_b16 v[168:169], v14 offset:224
    v_mfma_f32_16x16x32_bf16 v[100:103], v[176:179], v[196:199], v[100:103]
    ds_read_b64_tr_b16 v[170:171], v14 offset:4832
    s_waitcnt lgkmcnt(6)
    v_mfma_f32_16x16x32_bf16 v[104:107], v[180:183], v[192:195], v[104:107]
    ds_read_b64_tr_b16 v[172:173], v14 offset:9440
    s_mov_b64 exec, 0xffff
    buffer_load_dwordx4 v12, s[32:35], s36 offen offset:2048 lds
    s_mov_b64 exec, -1
    s_add_u32 s37, s37, 18432
    s_add_u32 s36, s36, 294912
    s_cmp_ge_u32 s37, 110592
    s_cselect_b32 s37, 0, s37
    v_mfma_f32_16x16x32_bf16 v[108:111], v[180:183], v[196:199], v[108:111]
    ds_read_b64_tr_b16 v[174:175], v14 offset:14048
    s_waitcnt lgkmcnt(6)
    v_mfma_f32_16x16x32_bf16 v[112:115], v[160:163], v[192:195], v[112:115]
    ds_read_b64_tr_b16 v[176:177], v14 offset:256
    v_mfma_f32_16x16x32_bf16 v[116:119], v[160:163], v[196:199], v[116:119]
    ds_read_b64_tr_b16 v[178:179], v14 offset:4864
    s_waitcnt lgkmcnt(6)
    v_mfma_f32_16x16x32_bf16 v[120:123], v[164:167], v[192:195], v[120:123]
    ds_read_b64_tr_b16 v[180:181], v14 offset:9472
    v_mfma_f32_16x16x32_bf16 v[124:127], v[164:167], v[196:199], v[124:127]
    ds_read_b64_tr_b16 v[182:183], v14 offset:14080
    s_waitcnt lgkmcnt(6)
    v_mfma_f32_16x16x32_bf16 v[128:131], v[168:171], v[192:195], v[128:131]
    ds_read_b64_tr_b16 v[160:161], v15 offset:0
    v_mfma_f32_16x16x32_bf16 v[132:135], v[168:171], v[196:199], v[132:135]
    ds_read_b64_tr_b16 v[162:163], v15 offset:4608
    s_waitcnt lgkmcnt(6)
    v_mfma_f32_16x16x32_bf16 v[136:139], v[172:175], v[192:195], v[136:139]
    ds_read_b64_tr_b16 v[164:165], v15 offset:9216
    v_mfma_f32_16x16x32_bf16 v[140:143], v[172:175], v[196:199], v[140:143]
    ds_read_b64_tr_b16 v[166:167], v15 offset:13824
    s_waitcnt lgkmcnt(6)
    v_mfma_f32_16x16x32_bf16 v[144:147], v[176:179], v[192:195], v[144:147]
    ds_read_b64_tr_b16 v[168:169], v15 offset:32
    v_mfma_f32_16x16x32_bf16 v[148:151], v[176:179], v[196:199], v[148:151]
    ds_read_b64_tr_b16 v[170:171], v15 offset:4640
    s_waitcnt lgkmcnt(6)
    v_mfma_f32_16x16x32_bf16 v[152:155], v[180:183], v[192:195], v[152:155]
    ds_read_b64_tr_b16 v[172:173], v15 offset:9248
    v_mfma_f32_16x16x32_bf16 v[156:159], v[180:183], v[196:199], v[156:159]
    ds_read_b64_tr_b16 v[174:175], v15 offset:13856
    v_mov_b32 v14, v15
    s_waitcnt vmcnt(8)
    s_barrier
    v_add_u32 v15, s42, v13
    s_add_u32 s42, s42, 18432
    s_cmp_ge_u32 s42, 110592
    s_cselect_b32 s42, 0, s42
    s_waitcnt lgkmcnt(6)
    v_mfma_f32_16x16x32_bf16 v[16:19], v[160:163], v[200:203], v[16:19]
    ds_read_b64_tr_b16 v[176:177], v14 offset:64
    v_mfma_f32_16x16x32_bf16 v[20:23], v[160:163], v[204:207], v[20:23]
    ds_read_b64_tr_b16 v[178:179], v14 offset:4672
    s_waitcnt lgkmcnt(6)
    v_mfma_f32_16x16x32_bf16 v[24:27], v[164:167], v[200:203], v[24:27]
    ds_read_b64_tr_b16 v[180:181], v14 offset:9280
    s_add_u32 s41, s40, 18432
    buffer_load_dwordx4 v[192:195], v9, s[44:47], s40 offen sc1
    v_mfma_f32_16x16x32_bf16 v[28:31], v[164:167], v[204:207], v[28:31]
    ds_read_b64_tr_b16 v[182:183], v14 offset:13888
    s_waitcnt lgkmcnt(6)
    v_mfma_f32_16x16x32_bf16 v[32:35], v[168:171], v[200:203], v[32:35]
    ds_read_b64_tr_b16 v[160:161], v14 offset:96
    v_mfma_f32_16x16x32_bf16 v[36:39], v[168:171], v[204:207], v[36:39]
    ds_read_b64_tr_b16 v[162:163], v14 offset:4704
    s_waitcnt lgkmcnt(6)
    v_mfma_f32_16x16x32_bf16 v[40:43], v[172:175], v[200:203], v[40:43]
    ds_read_b64_tr_b16 v[164:165], v14 offset:9312
    buffer_load_dwordx4 v[196:199], v9, s[44:47], s41 offen sc1
    s_add_u32 s40, s40, 1024
    v_mfma_f32_16x16x32_bf16 v[44:47], v[172:175], v[204:207], v[44:47]
    ds_read_b64_tr_b16 v[166:167], v14 offset:13920
    s_waitcnt lgkmcnt(6)
    v_mfma_f32_16x16x32_bf16 v[48:51], v[176:179], v[200:203], v[48:51]
    ds_read_b64_tr_b16 v[168:169], v14 offset:128
    v_mfma_f32_16x16x32_bf16 v[52:55], v[176:179], v[204:207], v[52:55]
    ds_read_b64_tr_b16 v[170:171], v14 offset:4736
    s_waitcnt lgkmcnt(6)
    v_mfma_f32_16x16x32_bf16 v[56:59], v[180:183], v[200:203], v[56:59]
    ds_read_b64_tr_b16 v[172:173], v14 offset:9344
    s_add_u32 m0, s37, s38
    s_nop 0
    buffer_load_dwordx4 v10, s[32:35], s36 offen lds
    v_mfma_f32_16x16x32_bf16 v[60:63], v[180:183], v[204:207], v[60:63]
    ds_read_b64_tr_b16 v[174:175], v14 offset:13952
    s_waitcnt lgkmcnt(6)
    v_mfma_f32_16x16x32_bf16 v[64:67], v[160:163], v[200:203], v[64:67]
    ds_read_b64_tr_b16 v[176:177], v14 offset:160
    v_mfma_f32_16x16x32_bf16 v[68:71], v[160:163], v[204:207], v[68:71]
    ds_read_b64_tr_b16 v[178:179], v14 offset:4768
    s_waitcnt lgkmcnt(6)
    v_mfma_f32_16x16x32_bf16 v[72:75], v[164:167], v[200:203], v[72:75]
    ds_read_b64_tr_b16 v[180:181], v14 offset:9376
    v_mfma_f32_16x16x32_bf16 v[76:79], v[164:167], v[204:207], v[76:79]
    ds_read_b64_tr_b16 v[182:183], v14 offset:13984
    s_waitcnt lgkmcnt(6)
    v_mfma_f32_16x16x32_bf16 v[80:83], v[168:171], v[200:203], v[80:83]
    ds_read_b64_tr_b16 v[160:161], v14 offset:192
    buffer_load_dwordx4 v11, s[32:35], s36 offen offset:1024 lds
    v_mfma_f32_16x16x32_bf16 v[84:87], v[168:171], v[204:207], v[84:87]
    ds_read_b64_tr_b16 v[162:163], v14 offset:4800
    s_waitcnt lgkmcnt(6)
    v_mfma_f32_16x16x32_bf16 v[88:91], v[172:175], v[200:203], v[88:91]
    ds_read_b64_tr_b16 v[164:165], v14 offset:9408
    v_mfma_f32_16x16x32_bf16 v[92:95], v[172:175], v[204:207], v[92:95]
    ds_read_b64_tr_b16 v[166:167], v14 offset:14016
    s_waitcnt lgkmcnt(6)
    v_mfma_f32_16x16x32_bf16 v[96:99], v[176:179], v[200:203], v[96:99]
    ds_read_b64_tr_b16 v[168:169], v14 offset:224
    v_mfma_f32_16x16x32_bf16 v[100:103], v[176:179], v[204:207], v[100:103]
    ds_read_b64_tr_b16 v[170:171], v14 offset:4832
    s_waitcnt lgkmcnt(6)
    v_mfma_f32_16x16x32_bf16 v[104:107], v[180:183], v[200:203], v[104:107]
    ds_read_b64_tr_b16 v[172:173], v14 offset:9440
    s_mov_b64 exec, 0xffff
    buffer_load_dwordx4 v12, s[32:35], s36 offen offset:2048 lds
    s_mov_b64 exec, -1
    s_add_u32 s37, s37, 18432
    s_add_u32 s36, s36, 294912
    s_cmp_ge_u32 s37, 110592
    s_cselect_b32 s37, 0, s37
    v_mfma_f32_16x16x32_bf16 v[108:111], v[180:183], v[204:207], v[108:111]
    ds_read_b64_tr_b16 v[174:175], v14 offset:14048
    s_waitcnt lgkmcnt(6)
    v_mfma_f32_16x16x32_bf16 v[112:115], v[160:163], v[200:203], v[112:115]
    ds_read_b64_tr_b16 v[176:177], v14 offset:256
    v_mfma_f32_16x16x32_bf16 v[116:119], v[160:163], v[204:207], v[116:119]
    ds_read_b64_tr_b16 v[178:179], v14 offset:4864
    s_waitcnt lgkmcnt(6)
    v_mfma_f32_16x16x32_bf16 v[120:123], v[164:167], v[200:203], v[120:123]
    ds_read_b64_tr_b16 v[180:181], v14 offset:9472
    v_mfma_f32_16x16x32_bf16 v[124:127], v[164:167], v[204:207], v[124:127]
    ds_read_b64_tr_b16 v[182:183], v14 offset:14080
    s_waitcnt lgkmcnt(6)
    v_mfma_f32_16x16x32_bf16 v[128:131], v[168:171], v[200:203], v[128:131]
    ds_read_b64_tr_b16 v[160:161], v15 offset:0
    v_mfma_f32_16x16x32_bf16 v[132:135], v[168:171], v[204:207], v[132:135]
    ds_read_b64_tr_b16 v[162:163], v15 offset:4608
    s_waitcnt lgkmcnt(6)
    v_mfma_f32_16x16x32_bf16 v[136:139], v[172:175], v[200:203], v[136:139]
    ds_read_b64_tr_b16 v[164:165], v15 offset:9216
    v_mfma_f32_16x16x32_bf16 v[140:143], v[172:175], v[204:207], v[140:143]
    ds_read_b64_tr_b16 v[166:167], v15 offset:13824
    s_waitcnt lgkmcnt(6)
    v_mfma_f32_16x16x32_bf16 v[144:147], v[176:179], v[200:203], v[144:147]
    ds_read_b64_tr_b16 v[168:169], v15 offset:32
    v_mfma_f32_16x16x32_bf16 v[148:151], v[176:179], v[204:207], v[148:151]
    ds_read_b64_tr_b16 v[170:171], v15 offset:4640
    s_waitcnt lgkmcnt(6)
    v_mfma_f32_16x16x32_bf16 v[152:155], v[180:183], v[200:203], v[152:155]
    ds_read_b64_tr_b16 v[172:173], v15 offset:9248
    v_mfma_f32_16x16x32_bf16 v[156:159], v[180:183], v[204:207], v[156:159]
    ds_read_b64_tr_b16 v[174:175], v15 offset:13856
    v_mov_b32 v14, v15
    s_add_u32 s43, s43, 1
    s_cmp_lt_u32 s43, 4
    s_cbranch_scc1 Lg1_54
    s_waitcnt vmcnt(8)
    s_barrier
    v_add_u32 v14, 55296, v13
    s_add_u32 s41, s40, 18432
    buffer_load_dwordx4 v[200:203], v9, s[44:47], s40 offen sc1
    buffer_load_dwordx4 v[204:207], v9, s[44:47], s41 offen sc1
    s_add_u32 s40, s40, 1024
    s_add_u32 s41, s40, 18432
    buffer_load_dwordx4 v[208:211], v9, s[44:47], s40 offen sc1
    buffer_load_dwordx4 v[212:215], v9, s[44:47], s41 offen sc1
    s_add_u32 s40, s40, 1024
    s_add_u32 s41, s40, 18432
    buffer_load_dwordx4 v[216:219], v9, s[44:47], s40 offen sc1
    buffer_load_dwordx4 v[220:223], v9, s[44:47], s41 offen sc1
    s_add_u32 s40, s40, 1024
    s_add_u32 s41, s40, 18432
    buffer_load_dwordx4 v[224:227], v9, s[44:47], s40 offen sc1
    buffer_load_dwordx4 v[228:231], v9, s[44:47], s41 offen sc1
    s_add_u32 s40, s40, 1024
    s_add_u32 m0, s37, s38
    s_nop 0
    buffer_load_dwordx4 v10, s[32:35], s36 offen lds
    buffer_load_dwordx4 v11, s[32:35], s36 offen offset:1024 lds
    s_mov_b64 exec, 0xffff
    buffer_load_dwordx4 v12, s[32:35], s36 offen offset:2048 lds
    s_mov_b64 exec, -1
    s_add_u32 s37, s37, 18432
    s_add_u32 s36, s36, 294912
    s_cmp_ge_u32 s37, 110592
    s_cselect_b32 s37, 0, s37
    s_add_u32 m0, s37, s38
    s_nop 0
    buffer_load_dwordx4 v10, s[32:35], s36 offen lds
    buffer_load_dwordx4 v11, s[32:35], s36 offen offset:1024 lds
    s_mov_b64 exec, 0xffff
    buffer_load_dwordx4 v12, s[32:35], s36 offen offset:2048 lds
    s_mov_b64 exec, -1
    s_add_u32 s37, s37, 18432
    s_add_u32 s36, s36, 294912
    s_cmp_ge_u32 s37, 110592
    s_cselect_b32 s37, 0, s37
    s_add_u32 s60, s30, 16777216
    s_addc_u32 s61, s31, 0
    s_mov_b32 s62, 18874368
    s_mov_b32 s63, 0x20000
    s_lshr_b32 s52, s94, 1
    s_mul_i32 s52, s52, 9
    s_and_b32 s53, s94, 1
    s_mul_i32 s54, s69, 144
    s_add_u32 s54, s54, s52
    s_add_u32 s57, s54, 8
    s_lshl_b32 s57, s57, 10
    s_lshl_b32 s56, s53, 3
    s_add_u32 s57, s57, s56
    s_lshl_b32 s56, s53, 2
    s_add_u32 s54, s54, s56
    s_lshl_b32 s58, s54, 10
    v_mov_b32 v240, 3222493025
    v_mov_b32 v241, 3222493025
    v_mov_b32 v242, 3184710632
    v_mov_b32 v243, 3184710632
    v_mov_b32 v244, 1.0
    v_mov_b32 v245, 1.0
    s_and_b32 s52, s2, 7
    s_lshr_b32 s53, s2, 3
    s_mul_i32 s54, s53, 0x5556
    s_lshr_b32 s54, s54, 16
    s_mul_i32 s64, s54, 3
    s_sub_u32 s64, s53, s64
    s_mul_i32 s52, s52, 10
    s_add_u32 s52, s52, s54
    s_lshr_b32 s66, s52, 4
    s_and_b32 s65, s52, 15
    s_mul_i32 s67, s66, 12
    s_cmp_eq_u32 s66, 0
    s_cselect_b32 s52, 0, 2
    s_add_u32 s67, s67, s52
    s_and_b32 s52, s66, 3
    s_cmp_eq_u32 s52, 0
    s_cselect_b32 s68, 14, 12
    s_lshl_b32 s46, s66, 4
    s_mov_b32 s47, 16
    v_add_u32 v2, s67, v1
    v_lshrrev_b32 v3, 2, v2
    v_mul_u32_u24 v3, 9, v3
    v_and_b32 v4, 1, v2
    v_add_u32 v3, v3, v4
    v_bfe_u32 v4, v2, 1, 1
    v_lshlrev_b32 v4, 2, v4
    v_add_u32 v3, v3, v4
    v_subrev_u32 v5, 14, v1
    v_add_u32 v2, s46, v5
    v_mul_u32_u24 v4, 13108, v2
    v_lshrrev_b32 v4, 16, v4
    v_mul_u32_u24 v6, 5, v4
    v_sub_u32 v6, v2, v6
    v_cmp_lt_u32 vcc, 1, v6
    v_mul_u32_u24 v4, 9, v4
    v_add_u32 v4, v4, v6
    v_add_u32 v4, 2, v4
    v_add_u32 v6, 2, v4
    v_cndmask_b32 v4, v4, v6, vcc
    v_mov_b32 v6, 200
    v_cmp_gt_u32 s[52:53], s68, v1
    v_cmp_gt_u32 s[54:55], s47, v5
    s_nop 1
    v_cndmask_b32 v6, v6, v4, s[54:55]
    v_cndmask_b32 v6, v6, v3, s[52:53]
    v_mul_u32_u24 v251, 36864, v6
    v_lshlrev_b32 v252, 10, v6
    v_lshrrev_b32 v2, 5, v1
    v_lshlrev_b32 v2, 6, v2
    v_bfe_u32 v3, v1, 2, 3
    v_bfe_u32 v4, v1, 1, 1
    v_lshrrev_b32 v5, 2, v3
    v_xor_b32 v4, v4, v5
    v_lshlrev_b32 v4, 5, v4
    v_mul_u32_u24 v3, 1152, v3
    v_add3_u32 v2, v2, v3, v4
    v_and_b32 v4, 1, v1
    v_lshlrev_b32 v4, 4, v4
    v_add_u32 v2, v2, v4
    s_mul_i32 s52, s64, 384
    s_add_u32 s53, s90, 0
    s_cmp_ge_u32 s53, 12
    s_cselect_b32 s54, 12, 0
    s_cselect_b32 s55, 0, 0
    s_sub_u32 s53, s53, s54
    s_and_b32 s54, s53, 3
    s_lshl_b32 s54, s54, 3
    s_add_u32 s55, s55, s54
    s_mul_i32 s55, s55, 1152
    s_lshr_b32 s53, s53, 2
    s_lshl_b32 s53, s53, 7
    s_add_u32 s53, s53, s52
    s_add_u32 s53, s53, s55
    v_add_u32 v246, s53, v2
    s_add_u32 s53, s90, 8
    s_cmp_ge_u32 s53, 12
    s_cselect_b32 s54, 12, 0
    s_cselect_b32 s55, 0, 0
    s_sub_u32 s53, s53, s54
    s_and_b32 s54, s53, 3
    s_lshl_b32 s54, s54, 3
    s_add_u32 s55, s55, s54
    s_mul_i32 s55, s55, 1152
    s_lshr_b32 s53, s53, 2
    s_lshl_b32 s53, s53, 7
    s_add_u32 s53, s53, s52
    s_add_u32 s53, s53, s55
    v_add_u32 v247, s53, v2
    s_add_u32 s53, s90, 16
    s_cmp_ge_u32 s53, 12
    s_cselect_b32 s54, 12, 0
    s_cselect_b32 s55, 0, 0
    s_sub_u32 s53, s53, s54
    s_and_b32 s54, s53, 3
    s_lshl_b32 s54, s54, 3
    s_add_u32 s55, s55, s54
    s_mul_i32 s55, s55, 1152
    s_lshr_b32 s53, s53, 2
    s_lshl_b32 s53, s53, 7
    s_add_u32 s53, s53, s52
    s_add_u32 s53, s53, s55
    v_add_u32 v248, s53, v2
    s_mov_b32 s41, 0
    v_readlane_b32 s36, v251, s41
    s_add_u32 s41, s41, 1
    v_readlane_b32 s39, v251, s41
    s_add_u32 s41, s41, 1
    s_cmp_lt_u32 s90, 4
    s_cselect_b32 s40, s36, s39
    s_mov_b32 s37, 0
    s_lshl_b32 s38, s90, 10
    s_mov_b32 s32, s22
    s_mov_b32 s33, s23
    s_mov_b32 s34, 5308416
    s_mov_b32 s35, 0x20000
    s_mul_i32 s52, s67, 16384
    s_lshr_b32 s52, s52, 16
    s_add_u32 s53, s67, s68
    s_sub_u32 s53, s53, 1
    s_mul_i32 s53, s53, 16384
    s_lshr_b32 s53, s53, 16
    s_sub_u32 s53, s53, s52
    s_add_u32 s53, s53, 1
    s_lshl_b32 s53, s53, 1
    s_lshl_b32 s52, s52, 1
    s_lshr_b32 s54, s65, 1
    s_lshl_b32 s54, s54, 5
    s_add_u32 s52, s52, s54
    s_and_b32 s88, s2, 7
    s_mul_i32 s88, s88, 4224
    s_add_u32 s88, s88, 135168
    s_lshl_b32 s55, s52, 4
    s_add_u32 s55, s55, s88
    v_lshlrev_b32 v8, 4, v1
    v_add_u32 v8, s55, v8
    v_cmp_gt_u32 s[84:85], s53, v1
    s_and_b32 s54, s90, 3
    s_lshl_b32 s54, s54, 1
    s_lshl_b32 s55, s65, 3
    s_add_u32 s69, s55, s54
    s_mul_i32 s54, s69, 144
    s_lshl_b32 s54, s54, 10
    s_add_u32 s4, s30, s54
    s_addc_u32 s5, s31, 0
    s_add_u32 s4, s4, 16777216
    s_addc_u32 s5, s5, 0
    s_mov_b32 s6, 147456
    s_mov_b32 s7, 0x20000
    s_add_u32 s8, s4, 147456
    s_addc_u32 s9, s5, 0
    s_mov_b32 s10, s6
    s_mov_b32 s11, 0x20000
    s_lshr_b32 s43, s90, 2
    s_mov_b32 s45, s43
    v_readlane_b32 s42, v252, s45
    s_waitcnt lgkmcnt(6)
    v_mfma_f32_16x16x32_bf16 v[16:19], v[160:163], v[184:187], v[16:19]
    ds_read_b64_tr_b16 v[176:177], v13 offset:64
    v_mfma_f32_16x16x32_bf16 v[20:23], v[160:163], v[188:191], v[20:23]
    ds_read_b64_tr_b16 v[178:179], v13 offset:4672
    s_waitcnt lgkmcnt(6)
    v_mfma_f32_16x16x32_bf16 v[24:27], v[164:167], v[184:187], v[24:27]
    ds_read_b64_tr_b16 v[180:181], v13 offset:9280
    v_mfma_f32_16x16x32_bf16 v[28:31], v[164:167], v[188:191], v[28:31]
    ds_read_b64_tr_b16 v[182:183], v13 offset:13888
    s_waitcnt lgkmcnt(6)
    v_mfma_f32_16x16x32_bf16 v[32:35], v[168:171], v[184:187], v[32:35]
    ds_read_b64_tr_b16 v[160:161], v13 offset:96
    v_mfma_f32_16x16x32_bf16 v[36:39], v[168:171], v[188:191], v[36:39]
    ds_read_b64_tr_b16 v[162:163], v13 offset:4704
    s_waitcnt lgkmcnt(6)
    v_mfma_f32_16x16x32_bf16 v[40:43], v[172:175], v[184:187], v[40:43]
    ds_read_b64_tr_b16 v[164:165], v13 offset:9312
    v_mfma_f32_16x16x32_bf16 v[44:47], v[172:175], v[188:191], v[44:47]
    ds_read_b64_tr_b16 v[166:167], v13 offset:13920
    s_waitcnt lgkmcnt(6)
    v_mfma_f32_16x16x32_bf16 v[48:51], v[176:179], v[184:187], v[48:51]
    ds_read_b64_tr_b16 v[168:169], v13 offset:18432
    v_mfma_f32_16x16x32_bf16 v[52:55], v[176:179], v[188:191], v[52:55]
    ds_read_b64_tr_b16 v[170:171], v13 offset:23040
    s_waitcnt lgkmcnt(6)
    v_mfma_f32_16x16x32_bf16 v[56:59], v[180:183], v[184:187], v[56:59]
    ds_read_b64_tr_b16 v[172:173], v13 offset:27648
    v_mfma_f32_16x16x32_bf16 v[60:63], v[180:183], v[188:191], v[60:63]
    ds_read_b64_tr_b16 v[174:175], v13 offset:32256
    s_waitcnt lgkmcnt(6)
    v_mfma_f32_16x16x32_bf16 v[64:67], v[160:163], v[184:187], v[64:67]
    ds_read_b64_tr_b16 v[176:177], v13 offset:18464
    v_mfma_f32_16x16x32_bf16 v[68:71], v[160:163], v[188:191], v[68:71]
    ds_read_b64_tr_b16 v[178:179], v13 offset:23072
    s_waitcnt lgkmcnt(6)
    v_mfma_f32_16x16x32_bf16 v[72:75], v[164:167], v[184:187], v[72:75]
    ds_read_b64_tr_b16 v[180:181], v13 offset:27680
    v_mfma_f32_16x16x32_bf16 v[76:79], v[164:167], v[188:191], v[76:79]
    ds_read_b64_tr_b16 v[182:183], v13 offset:32288
    s_waitcnt vmcnt(14)
    s_barrier
    s_waitcnt lgkmcnt(6)
    v_mfma_f32_16x16x32_bf16 v[16:19], v[168:171], v[192:195], v[16:19]
    ds_read_b64_tr_b16 v[160:161], v13 offset:18496
    v_mfma_f32_16x16x32_bf16 v[20:23], v[168:171], v[196:199], v[20:23]
    ds_read_b64_tr_b16 v[162:163], v13 offset:23104
    s_waitcnt lgkmcnt(6)
    v_mfma_f32_16x16x32_bf16 v[24:27], v[172:175], v[192:195], v[24:27]
    ds_read_b64_tr_b16 v[164:165], v13 offset:27712
    v_mfma_f32_16x16x32_bf16 v[28:31], v[172:175], v[196:199], v[28:31]
    ds_read_b64_tr_b16 v[166:167], v13 offset:32320
    s_waitcnt lgkmcnt(6)
    v_mfma_f32_16x16x32_bf16 v[32:35], v[176:179], v[192:195], v[32:35]
    ds_read_b64_tr_b16 v[168:169], v13 offset:18528
    v_mfma_f32_16x16x32_bf16 v[36:39], v[176:179], v[196:199], v[36:39]
    ds_read_b64_tr_b16 v[170:171], v13 offset:23136
    s_waitcnt lgkmcnt(6)
    v_mfma_f32_16x16x32_bf16 v[40:43], v[180:183], v[192:195], v[40:43]
    ds_read_b64_tr_b16 v[172:173], v13 offset:27744
    v_mfma_f32_16x16x32_bf16 v[44:47], v[180:183], v[196:199], v[44:47]
    ds_read_b64_tr_b16 v[174:175], v13 offset:32352
    s_waitcnt lgkmcnt(6)
    v_mfma_f32_16x16x32_bf16 v[48:51], v[160:163], v[192:195], v[48:51]
    ds_read_b64_tr_b16 v[176:177], v13 offset:36864
    v_mfma_f32_16x16x32_bf16 v[52:55], v[160:163], v[196:199], v[52:55]
    ds_read_b64_tr_b16 v[178:179], v13 offset:41472
    s_waitcnt lgkmcnt(6)
    v_mfma_f32_16x16x32_bf16 v[56:59], v[164:167], v[192:195], v[56:59]
    ds_read_b64_tr_b16 v[180:181], v13 offset:46080
    v_mfma_f32_16x16x32_bf16 v[60:63], v[164:167], v[196:199], v[60:63]
    ds_read_b64_tr_b16 v[182:183], v13 offset:50688
    s_waitcnt lgkmcnt(6)
    v_mfma_f32_16x16x32_bf16 v[64:67], v[168:171], v[192:195], v[64:67]
    ds_read_b64_tr_b16 v[160:161], v13 offset:36896
    v_mfma_f32_16x16x32_bf16 v[68:71], v[168:171], v[196:199], v[68:71]
    ds_read_b64_tr_b16 v[162:163], v13 offset:41504
    s_waitcnt lgkmcnt(6)
    v_mfma_f32_16x16x32_bf16 v[72:75], v[172:175], v[192:195], v[72:75]
    ds_read_b64_tr_b16 v[164:165], v13 offset:46112
    v_mfma_f32_16x16x32_bf16 v[76:79], v[172:175], v[196:199], v[76:79]
    ds_read_b64_tr_b16 v[166:167], v13 offset:50720
    s_waitcnt vmcnt(12)
    s_waitcnt lgkmcnt(6)
    v_mfma_f32_16x16x32_bf16 v[16:19], v[176:179], v[200:203], v[16:19]
    ds_read_b64_tr_b16 v[168:169], v13 offset:36928
    v_mfma_f32_16x16x32_bf16 v[20:23], v[176:179], v[204:207], v[20:23]
    ds_read_b64_tr_b16 v[170:171], v13 offset:41536
    s_waitcnt lgkmcnt(6)
    v_mfma_f32_16x16x32_bf16 v[24:27], v[180:183], v[200:203], v[24:27]
    ds_read_b64_tr_b16 v[172:173], v13 offset:46144
    v_mfma_f32_16x16x32_bf16 v[28:31], v[180:183], v[204:207], v[28:31]
    ds_read_b64_tr_b16 v[174:175], v13 offset:50752
    s_waitcnt lgkmcnt(6)
    v_mfma_f32_16x16x32_bf16 v[32:35], v[160:163], v[200:203], v[32:35]
    ds_read_b64_tr_b16 v[176:177], v13 offset:36960
    v_mfma_f32_16x16x32_bf16 v[36:39], v[160:163], v[204:207], v[36:39]
    ds_read_b64_tr_b16 v[178:179], v13 offset:41568
    s_waitcnt lgkmcnt(6)
    v_mfma_f32_16x16x32_bf16 v[40:43], v[164:167], v[200:203], v[40:43]
    ds_read_b64_tr_b16 v[180:181], v13 offset:46176
    v_mfma_f32_16x16x32_bf16 v[44:47], v[164:167], v[204:207], v[44:47]
    ds_read_b64_tr_b16 v[182:183], v13 offset:50784
    s_waitcnt lgkmcnt(6)
    v_mfma_f32_16x16x32_bf16 v[48:51], v[168:171], v[200:203], v[48:51]
    ds_read_b64_tr_b16 v[160:161], v14 offset:0
    v_mfma_f32_16x16x32_bf16 v[52:55], v[168:171], v[204:207], v[52:55]
    ds_read_b64_tr_b16 v[162:163], v14 offset:4608
    s_waitcnt lgkmcnt(6)
    v_mfma_f32_16x16x32_bf16 v[56:59], v[172:175], v[200:203], v[56:59]
    ds_read_b64_tr_b16 v[164:165], v14 offset:9216
    v_mfma_f32_16x16x32_bf16 v[60:63], v[172:175], v[204:207], v[60:63]
    ds_read_b64_tr_b16 v[166:167], v14 offset:13824
    s_waitcnt lgkmcnt(6)
    v_mfma_f32_16x16x32_bf16 v[64:67], v[176:179], v[200:203], v[64:67]
    ds_read_b64_tr_b16 v[168:169], v14 offset:32
    v_mfma_f32_16x16x32_bf16 v[68:71], v[176:179], v[204:207], v[68:71]
    ds_read_b64_tr_b16 v[170:171], v14 offset:4640
    s_waitcnt lgkmcnt(6)
    v_mfma_f32_16x16x32_bf16 v[72:75], v[180:183], v[200:203], v[72:75]
    ds_read_b64_tr_b16 v[172:173], v14 offset:9248
    v_mfma_f32_16x16x32_bf16 v[76:79], v[180:183], v[204:207], v[76:79]
    ds_read_b64_tr_b16 v[174:175], v14 offset:13856
    s_waitcnt vmcnt(0)
    s_barrier
    s_waitcnt lgkmcnt(6)
    v_mfma_f32_16x16x32_bf16 v[16:19], v[160:163], v[208:211], v[16:19]
    ds_read_b64_tr_b16 v[176:177], v14 offset:64
    v_mfma_f32_16x16x32_bf16 v[20:23], v[160:163], v[212:215], v[20:23]
    ds_read_b64_tr_b16 v[178:179], v14 offset:4672
    s_waitcnt lgkmcnt(6)
    v_mfma_f32_16x16x32_bf16 v[24:27], v[164:167], v[208:211], v[24:27]
    ds_read_b64_tr_b16 v[180:181], v14 offset:9280
    v_mfma_f32_16x16x32_bf16 v[28:31], v[164:167], v[212:215], v[28:31]
    ds_read_b64_tr_b16 v[182:183], v14 offset:13888
    s_waitcnt lgkmcnt(6)
    v_mfma_f32_16x16x32_bf16 v[32:35], v[168:171], v[208:211], v[32:35]
    ds_read_b64_tr_b16 v[160:161], v14 offset:96
    v_mfma_f32_16x16x32_bf16 v[36:39], v[168:171], v[212:215], v[36:39]
    ds_read_b64_tr_b16 v[162:163], v14 offset:4704
    s_waitcnt lgkmcnt(6)
    v_mfma_f32_16x16x32_bf16 v[40:43], v[172:175], v[208:211], v[40:43]
    ds_read_b64_tr_b16 v[164:165], v14 offset:9312
    v_mfma_f32_16x16x32_bf16 v[44:47], v[172:175], v[212:215], v[44:47]
    ds_read_b64_tr_b16 v[166:167], v14 offset:13920
    s_waitcnt lgkmcnt(6)
    v_mfma_f32_16x16x32_bf16 v[48:51], v[176:179], v[208:211], v[48:51]
    ds_read_b64_tr_b16 v[168:169], v14 offset:18432
    v_mfma_f32_16x16x32_bf16 v[52:55], v[176:179], v[212:215], v[52:55]
    ds_read_b64_tr_b16 v[170:171], v14 offset:23040
    s_waitcnt lgkmcnt(6)
    v_mfma_f32_16x16x32_bf16 v[56:59], v[180:183], v[208:211], v[56:59]
    ds_read_b64_tr_b16 v[172:173], v14 offset:27648
    v_mfma_f32_16x16x32_bf16 v[60:63], v[180:183], v[212:215], v[60:63]
    ds_read_b64_tr_b16 v[174:175], v14 offset:32256
    s_waitcnt lgkmcnt(6)
    v_mfma_f32_16x16x32_bf16 v[64:67], v[160:163], v[208:211], v[64:67]
    ds_read_b64_tr_b16 v[176:177], v14 offset:18464
    v_mfma_f32_16x16x32_bf16 v[68:71], v[160:163], v[212:215], v[68:71]
    ds_read_b64_tr_b16 v[178:179], v14 offset:23072
    s_waitcnt lgkmcnt(6)
    v_mfma_f32_16x16x32_bf16 v[72:75], v[164:167], v[208:211], v[72:75]
    ds_read_b64_tr_b16 v[180:181], v14 offset:27680
    v_mfma_f32_16x16x32_bf16 v[76:79], v[164:167], v[212:215], v[76:79]
    ds_read_b64_tr_b16 v[182:183], v14 offset:32288
    s_waitcnt lgkmcnt(6)
    v_mfma_f32_16x16x32_bf16 v[16:19], v[168:171], v[216:219], v[16:19]
    ds_read_b64_tr_b16 v[160:161], v14 offset:18496
    v_mfma_f32_16x16x32_bf16 v[20:23], v[168:171], v[220:223], v[20:23]
    ds_read_b64_tr_b16 v[162:163], v14 offset:23104
    s_waitcnt lgkmcnt(6)
    v_mfma_f32_16x16x32_bf16 v[24:27], v[172:175], v[216:219], v[24:27]
    ds_read_b64_tr_b16 v[164:165], v14 offset:27712
    v_mfma_f32_16x16x32_bf16 v[28:31], v[172:175], v[220:223], v[28:31]
    ds_read_b64_tr_b16 v[166:167], v14 offset:32320
    s_waitcnt lgkmcnt(6)
    v_mfma_f32_16x16x32_bf16 v[32:35], v[176:179], v[216:219], v[32:35]
    ds_read_b64_tr_b16 v[168:169], v14 offset:18528
    v_mfma_f32_16x16x32_bf16 v[36:39], v[176:179], v[220:223], v[36:39]
    ds_read_b64_tr_b16 v[170:171], v14 offset:23136
    s_waitcnt lgkmcnt(6)
    v_mfma_f32_16x16x32_bf16 v[40:43], v[180:183], v[216:219], v[40:43]
    ds_read_b64_tr_b16 v[172:173], v14 offset:27744
    v_mfma_f32_16x16x32_bf16 v[44:47], v[180:183], v[220:223], v[44:47]
    ds_read_b64_tr_b16 v[174:175], v14 offset:32352
    s_waitcnt lgkmcnt(6)
    v_mfma_f32_16x16x32_bf16 v[48:51], v[160:163], v[216:219], v[48:51]
    ds_read_b64_tr_b16 v[176:177], v14 offset:36864
    v_mfma_f32_16x16x32_bf16 v[52:55], v[160:163], v[220:223], v[52:55]
    ds_read_b64_tr_b16 v[178:179], v14 offset:41472
    s_waitcnt lgkmcnt(6)
    v_mfma_f32_16x16x32_bf16 v[56:59], v[164:167], v[216:219], v[56:59]
    ds_read_b64_tr_b16 v[180:181], v14 offset:46080
    v_mfma_f32_16x16x32_bf16 v[60:63], v[164:167], v[220:223], v[60:63]
    ds_read_b64_tr_b16 v[182:183], v14 offset:50688
    s_waitcnt lgkmcnt(6)
    v_mfma_f32_16x16x32_bf16 v[64:67], v[168:171], v[216:219], v[64:67]
    ds_read_b64_tr_b16 v[160:161], v14 offset:36896
    v_mfma_f32_16x16x32_bf16 v[68:71], v[168:171], v[220:223], v[68:71]
    ds_read_b64_tr_b16 v[162:163], v14 offset:41504
    s_waitcnt lgkmcnt(6)
    v_mfma_f32_16x16x32_bf16 v[72:75], v[172:175], v[216:219], v[72:75]
    ds_read_b64_tr_b16 v[164:165], v14 offset:46112
    v_mfma_f32_16x16x32_bf16 v[76:79], v[172:175], v[220:223], v[76:79]
    ds_read_b64_tr_b16 v[166:167], v14 offset:50720
    s_waitcnt lgkmcnt(6)
    v_mfma_f32_16x16x32_bf16 v[16:19], v[176:179], v[224:227], v[16:19]
    ds_read_b64_tr_b16 v[168:169], v14 offset:36928
    v_mfma_f32_16x16x32_bf16 v[20:23], v[176:179], v[228:231], v[20:23]
    ds_read_b64_tr_b16 v[170:171], v14 offset:41536
    s_waitcnt lgkmcnt(6)
    v_mfma_f32_16x16x32_bf16 v[24:27], v[180:183], v[224:227], v[24:27]
    ds_read_b64_tr_b16 v[172:173], v14 offset:46144
    v_mfma_f32_16x16x32_bf16 v[28:31], v[180:183], v[228:231], v[28:31]
    ds_read_b64_tr_b16 v[174:175], v14 offset:50752
    s_waitcnt lgkmcnt(6)
    v_mfma_f32_16x16x32_bf16 v[32:35], v[160:163], v[224:227], v[32:35]
    ds_read_b64_tr_b16 v[176:177], v14 offset:36960
    v_mfma_f32_16x16x32_bf16 v[36:39], v[160:163], v[228:231], v[36:39]
    ds_read_b64_tr_b16 v[178:179], v14 offset:41568
    s_waitcnt lgkmcnt(6)
    v_mfma_f32_16x16x32_bf16 v[40:43], v[164:167], v[224:227], v[40:43]
    ds_read_b64_tr_b16 v[180:181], v14 offset:46176
    v_mfma_f32_16x16x32_bf16 v[44:47], v[164:167], v[228:231], v[44:47]
    ds_read_b64_tr_b16 v[182:183], v14 offset:50784
    s_waitcnt lgkmcnt(6)
    v_mfma_f32_16x16x32_bf16 v[48:51], v[168:171], v[224:227], v[48:51]
    ds_read_b64_tr_b16 v[160:161], v13 offset:128
    v_mfma_f32_16x16x32_bf16 v[52:55], v[168:171], v[228:231], v[52:55]
    ds_read_b64_tr_b16 v[162:163], v13 offset:4736
    s_waitcnt lgkmcnt(6)
    v_mfma_f32_16x16x32_bf16 v[56:59], v[172:175], v[224:227], v[56:59]
    ds_read_b64_tr_b16 v[164:165], v13 offset:9344
    v_mfma_f32_16x16x32_bf16 v[60:63], v[172:175], v[228:231], v[60:63]
    ds_read_b64_tr_b16 v[166:167], v13 offset:13952
    s_waitcnt lgkmcnt(6)
    v_mfma_f32_16x16x32_bf16 v[64:67], v[176:179], v[224:227], v[64:67]
    ds_read_b64_tr_b16 v[168:169], v13 offset:160
    v_mfma_f32_16x16x32_bf16 v[68:71], v[176:179], v[228:231], v[68:71]
    ds_read_b64_tr_b16 v[170:171], v13 offset:4768
    s_waitcnt lgkmcnt(6)
    v_mfma_f32_16x16x32_bf16 v[72:75], v[180:183], v[224:227], v[72:75]
    ds_read_b64_tr_b16 v[172:173], v13 offset:9376
    v_mfma_f32_16x16x32_bf16 v[76:79], v[180:183], v[228:231], v[76:79]
    ds_read_b64_tr_b16 v[174:175], v13 offset:13984
    s_waitcnt lgkmcnt(6)
    v_mfma_f32_16x16x32_bf16 v[80:83], v[160:163], v[184:187], v[80:83]
    ds_read_b64_tr_b16 v[176:177], v13 offset:192
    v_mul_f32 v232, v16, v16
    v_mul_f32 v233, v17, v17
    v_mul_f32 v234, v18, v18
    v_mul_f32 v235, v19, v19
    v_fma_f32 v232, v232, v242, v240
    v_mfma_f32_16x16x32_bf16 v[84:87], v[160:163], v[188:191], v[84:87]
    ds_read_b64_tr_b16 v[178:179], v13 offset:4800
    v_fma_f32 v233, v233, v242, v240
    v_fma_f32 v234, v234, v242, v240
    v_fma_f32 v235, v235, v242, v240
    v_mul_f32 v232, v232, v16
    s_waitcnt lgkmcnt(6)
    v_mfma_f32_16x16x32_bf16 v[88:91], v[164:167], v[184:187], v[88:91]
    ds_read_b64_tr_b16 v[180:181], v13 offset:9408
    v_mul_f32 v233, v233, v17
    v_mul_f32 v234, v234, v18
    v_mul_f32 v235, v235, v19
    v_mul_f32 v16, v16, v24
    v_mul_f32 v17, v17, v25
    v_mfma_f32_16x16x32_bf16 v[92:95], v[164:167], v[188:191], v[92:95]
    ds_read_b64_tr_b16 v[182:183], v13 offset:14016
    v_mul_f32 v18, v18, v26
    v_mul_f32 v19, v19, v27
    v_exp_f32 v232, v232
    v_exp_f32 v233, v233
    s_waitcnt lgkmcnt(6)
    v_mfma_f32_16x16x32_bf16 v[96:99], v[168:171], v[184:187], v[96:99]
    ds_read_b64_tr_b16 v[160:161], v13 offset:224
    v_exp_f32 v234, v234
    v_exp_f32 v235, v235
    v_add_f32 v232, 1.0, v232
    v_add_f32 v233, 1.0, v233
    v_add_f32 v234, 1.0, v234
    v_mfma_f32_16x16x32_bf16 v[100:103], v[168:171], v[188:191], v[100:103]
    ds_read_b64_tr_b16 v[162:163], v13 offset:4832
    v_add_f32 v235, 1.0, v235
    v_rcp_f32 v232, v232
    v_rcp_f32 v233, v233
    v_rcp_f32 v234, v234
    s_waitcnt lgkmcnt(6)
    v_mfma_f32_16x16x32_bf16 v[104:107], v[172:175], v[184:187], v[104:107]
    ds_read_b64_tr_b16 v[164:165], v13 offset:9440
    v_rcp_f32 v235, v235
    s_nop 0
    v_mul_f32 v16, v16, v232
    v_mul_f32 v17, v17, v233
    v_mul_f32 v18, v18, v234
    v_mfma_f32_16x16x32_bf16 v[108:111], v[172:175], v[188:191], v[108:111]
    ds_read_b64_tr_b16 v[166:167], v13 offset:14048
    v_mul_f32 v19, v19, v235
    v_cvt_pk_bf16_f32 v24, v16, v17
    v_cvt_pk_bf16_f32 v25, v18, v19
    v_mul_f32 v236, v20, v20
    s_waitcnt lgkmcnt(6)
    v_mfma_f32_16x16x32_bf16 v[112:115], v[176:179], v[184:187], v[112:115]
    ds_read_b64_tr_b16 v[168:169], v13 offset:18560
    v_mul_f32 v237, v21, v21
    v_mul_f32 v238, v22, v22
    v_mul_f32 v239, v23, v23
    v_fma_f32 v236, v236, v242, v240
    v_fma_f32 v237, v237, v242, v240
    v_mfma_f32_16x16x32_bf16 v[116:119], v[176:179], v[188:191], v[116:119]
    ds_read_b64_tr_b16 v[170:171], v13 offset:23168
    v_fma_f32 v238, v238, v242, v240
    v_fma_f32 v239, v239, v242, v240
    v_mul_f32 v236, v236, v20
    v_mul_f32 v237, v237, v21
    s_waitcnt lgkmcnt(6)
    v_mfma_f32_16x16x32_bf16 v[120:123], v[180:183], v[184:187], v[120:123]
    ds_read_b64_tr_b16 v[172:173], v13 offset:27776
    v_mul_f32 v238, v238, v22
    v_mul_f32 v239, v239, v23
    v_mul_f32 v20, v20, v28
    v_mul_f32 v21, v21, v29
    v_mul_f32 v22, v22, v30
    v_mfma_f32_16x16x32_bf16 v[124:127], v[180:183], v[188:191], v[124:127]
    ds_read_b64_tr_b16 v[174:175], v13 offset:32384
    v_mul_f32 v23, v23, v31
    v_exp_f32 v236, v236
    v_exp_f32 v237, v237
    v_exp_f32 v238, v238
    s_waitcnt lgkmcnt(6)
    v_mfma_f32_16x16x32_bf16 v[128:131], v[160:163], v[184:187], v[128:131]
    ds_read_b64_tr_b16 v[176:177], v13 offset:18592
    v_exp_f32 v239, v239
    v_add_f32 v236, 1.0, v236
    v_add_f32 v237, 1.0, v237
    v_add_f32 v238, 1.0, v238
    v_add_f32 v239, 1.0, v239
    v_mfma_f32_16x16x32_bf16 v[132:135], v[160:163], v[188:191], v[132:135]
    ds_read_b64_tr_b16 v[178:179], v13 offset:23200
    v_rcp_f32 v236, v236
    v_rcp_f32 v237, v237
    v_rcp_f32 v238, v238
    v_rcp_f32 v239, v239
    s_waitcnt lgkmcnt(6)
    v_mfma_f32_16x16x32_bf16 v[136:139], v[164:167], v[184:187], v[136:139]
    ds_read_b64_tr_b16 v[180:181], v13 offset:27808
    s_nop 0
    v_mul_f32 v20, v20, v236
    v_mul_f32 v21, v21, v237
    v_mul_f32 v22, v22, v238
    v_mul_f32 v23, v23, v239
    v_mfma_f32_16x16x32_bf16 v[140:143], v[164:167], v[188:191], v[140:143]
    ds_read_b64_tr_b16 v[182:183], v13 offset:32416
    v_cvt_pk_bf16_f32 v28, v20, v21
    v_cvt_pk_bf16_f32 v29, v22, v23
    v_mul_f32 v232, v32, v32
    v_mul_f32 v233, v33, v33
    s_waitcnt lgkmcnt(6)
    v_mfma_f32_16x16x32_bf16 v[80:83], v[168:171], v[192:195], v[80:83]
    ds_read_b64_tr_b16 v[160:161], v13 offset:18624
    v_mul_f32 v234, v34, v34
    v_mul_f32 v235, v35, v35
    v_fma_f32 v232, v232, v242, v240
    v_fma_f32 v233, v233, v242, v240
    v_fma_f32 v234, v234, v242, v240
    v_mfma_f32_16x16x32_bf16 v[84:87], v[168:171], v[196:199], v[84:87]
    ds_read_b64_tr_b16 v[162:163], v13 offset:23232
    v_fma_f32 v235, v235, v242, v240
    v_mul_f32 v232, v232, v32
    v_mul_f32 v233, v233, v33
    v_mul_f32 v234, v234, v34
    s_waitcnt lgkmcnt(6)
    v_mfma_f32_16x16x32_bf16 v[88:91], v[172:175], v[192:195], v[88:91]
    ds_read_b64_tr_b16 v[164:165], v13 offset:27840
    v_mul_f32 v235, v235, v35
    v_mul_f32 v32, v32, v40
    v_mul_f32 v33, v33, v41
    v_mul_f32 v34, v34, v42
    v_mul_f32 v35, v35, v43
    v_mfma_f32_16x16x32_bf16 v[92:95], v[172:175], v[196:199], v[92:95]
    ds_read_b64_tr_b16 v[166:167], v13 offset:32448
    v_exp_f32 v232, v232
    v_exp_f32 v233, v233
    v_exp_f32 v234, v234
    v_exp_f32 v235, v235
    s_waitcnt lgkmcnt(6)
    v_mfma_f32_16x16x32_bf16 v[96:99], v[176:179], v[192:195], v[96:99]
    ds_read_b64_tr_b16 v[168:169], v13 offset:18656
    v_add_f32 v232, 1.0, v232
    v_add_f32 v233, 1.0, v233
    v_add_f32 v234, 1.0, v234
    v_add_f32 v235, 1.0, v235
    v_rcp_f32 v232, v232
    v_mfma_f32_16x16x32_bf16 v[100:103], v[176:179], v[196:199], v[100:103]
    ds_read_b64_tr_b16 v[170:171], v13 offset:23264
    v_rcp_f32 v233, v233
    v_rcp_f32 v234, v234
    v_rcp_f32 v235, v235
    s_nop 0
    s_waitcnt lgkmcnt(6)
    v_mfma_f32_16x16x32_bf16 v[104:107], v[180:183], v[192:195], v[104:107]
    ds_read_b64_tr_b16 v[172:173], v13 offset:27872
    v_mul_f32 v32, v32, v232
    v_mul_f32 v33, v33, v233
    v_mul_f32 v34, v34, v234
    v_mul_f32 v35, v35, v235
    v_cvt_pk_bf16_f32 v26, v32, v33
    v_mfma_f32_16x16x32_bf16 v[108:111], v[180:183], v[196:199], v[108:111]
    ds_read_b64_tr_b16 v[174:175], v13 offset:32480
    v_cvt_pk_bf16_f32 v27, v34, v35
    s_add_u32 s56, s58, 0
    buffer_store_dwordx4 v[24:27], v9, s[60:63], s56 offen sc1
    v_mul_f32 v236, v36, v36
    s_waitcnt lgkmcnt(6)
    v_mfma_f32_16x16x32_bf16 v[112:115], v[160:163], v[192:195], v[112:115]
    ds_read_b64_tr_b16 v[176:177], v13 offset:36992
    v_mul_f32 v237, v37, v37
    v_mul_f32 v238, v38, v38
    v_mul_f32 v239, v39, v39
    v_fma_f32 v236, v236, v242, v240
    v_fma_f32 v237, v237, v242, v240
    v_mfma_f32_16x16x32_bf16 v[116:119], v[160:163], v[196:199], v[116:119]
    ds_read_b64_tr_b16 v[178:179], v13 offset:41600
    v_fma_f32 v238, v238, v242, v240
    v_fma_f32 v239, v239, v242, v240
    v_mul_f32 v236, v236, v36
    v_mul_f32 v237, v237, v37
    s_waitcnt lgkmcnt(6)
    v_mfma_f32_16x16x32_bf16 v[120:123], v[164:167], v[192:195], v[120:123]
    ds_read_b64_tr_b16 v[180:181], v13 offset:46208
    v_mul_f32 v238, v238, v38
    v_mul_f32 v239, v239, v39
    v_mul_f32 v36, v36, v44
    v_mul_f32 v37, v37, v45
    v_mul_f32 v38, v38, v46
    v_mfma_f32_16x16x32_bf16 v[124:127], v[164:167], v[196:199], v[124:127]
    ds_read_b64_tr_b16 v[182:183], v13 offset:50816
    v_mul_f32 v39, v39, v47
    v_exp_f32 v236, v236
    v_exp_f32 v237, v237
    v_exp_f32 v238, v238
    s_waitcnt lgkmcnt(6)
    v_mfma_f32_16x16x32_bf16 v[128:131], v[168:171], v[192:195], v[128:131]
    ds_read_b64_tr_b16 v[160:161], v13 offset:37024
    v_exp_f32 v239, v239
    v_add_f32 v236, 1.0, v236
    v_add_f32 v237, 1.0, v237
    v_add_f32 v238, 1.0, v238
    v_add_f32 v239, 1.0, v239
    v_mfma_f32_16x16x32_bf16 v[132:135], v[168:171], v[196:199], v[132:135]
    ds_read_b64_tr_b16 v[162:163], v13 offset:41632
    v_rcp_f32 v236, v236
    v_rcp_f32 v237, v237
    v_rcp_f32 v238, v238
    v_rcp_f32 v239, v239
    s_waitcnt lgkmcnt(6)
    v_mfma_f32_16x16x32_bf16 v[136:139], v[172:175], v[192:195], v[136:139]
    ds_read_b64_tr_b16 v[164:165], v13 offset:46240
    s_nop 0
    v_mul_f32 v36, v36, v236
    v_mul_f32 v37, v37, v237
    v_mul_f32 v38, v38, v238
    v_mul_f32 v39, v39, v239
    v_mfma_f32_16x16x32_bf16 v[140:143], v[172:175], v[196:199], v[140:143]
    ds_read_b64_tr_b16 v[166:167], v13 offset:50848
    v_cvt_pk_bf16_f32 v30, v36, v37
    v_cvt_pk_bf16_f32 v31, v38, v39
    s_add_u32 s56, s58, 147456
    buffer_store_dwordx4 v[28:31], v9, s[60:63], s56 offen sc1
    s_waitcnt lgkmcnt(6)
    v_mfma_f32_16x16x32_bf16 v[80:83], v[176:179], v[200:203], v[80:83]
    ds_read_b64_tr_b16 v[168:169], v13 offset:37056
    v_mul_f32 v232, v48, v48
    v_mul_f32 v233, v49, v49
    v_mul_f32 v234, v50, v50
    v_mul_f32 v235, v51, v51
    v_fma_f32 v232, v232, v242, v240
    v_mfma_f32_16x16x32_bf16 v[84:87], v[176:179], v[204:207], v[84:87]
    ds_read_b64_tr_b16 v[170:171], v13 offset:41664
    v_fma_f32 v233, v233, v242, v240
    v_fma_f32 v234, v234, v242, v240
    v_fma_f32 v235, v235, v242, v240
    v_mul_f32 v232, v232, v48
    s_waitcnt lgkmcnt(6)
    v_mfma_f32_16x16x32_bf16 v[88:91], v[180:183], v[200:203], v[88:91]
    ds_read_b64_tr_b16 v[172:173], v13 offset:46272
    v_mul_f32 v233, v233, v49
    v_mul_f32 v234, v234, v50
    v_mul_f32 v235, v235, v51
    v_mul_f32 v48, v48, v56
    v_mul_f32 v49, v49, v57
    v_mfma_f32_16x16x32_bf16 v[92:95], v[180:183], v[204:207], v[92:95]
    ds_read_b64_tr_b16 v[174:175], v13 offset:50880
    v_mul_f32 v50, v50, v58
    v_mul_f32 v51, v51, v59
    v_exp_f32 v232, v232
    v_exp_f32 v233, v233
    s_waitcnt lgkmcnt(6)
    v_mfma_f32_16x16x32_bf16 v[96:99], v[160:163], v[200:203], v[96:99]
    ds_read_b64_tr_b16 v[176:177], v13 offset:37088
    v_exp_f32 v234, v234
    v_exp_f32 v235, v235
    v_add_f32 v232, 1.0, v232
    v_add_f32 v233, 1.0, v233
    v_add_f32 v234, 1.0, v234
    v_mfma_f32_16x16x32_bf16 v[100:103], v[160:163], v[204:207], v[100:103]
    ds_read_b64_tr_b16 v[178:179], v13 offset:41696
    v_add_f32 v235, 1.0, v235
    v_rcp_f32 v232, v232
    v_rcp_f32 v233, v233
    v_rcp_f32 v234, v234
    s_waitcnt lgkmcnt(6)
    v_mfma_f32_16x16x32_bf16 v[104:107], v[164:167], v[200:203], v[104:107]
    ds_read_b64_tr_b16 v[180:181], v13 offset:46304
    v_rcp_f32 v235, v235
    s_nop 0
    v_mul_f32 v48, v48, v232
    v_mul_f32 v49, v49, v233
    v_mul_f32 v50, v50, v234
    v_mfma_f32_16x16x32_bf16 v[108:111], v[164:167], v[204:207], v[108:111]
    ds_read_b64_tr_b16 v[182:183], v13 offset:50912
    v_mul_f32 v51, v51, v235
    v_cvt_pk_bf16_f32 v56, v48, v49
    v_cvt_pk_bf16_f32 v57, v50, v51
    v_mul_f32 v236, v52, v52
    s_waitcnt lgkmcnt(6)
    v_mfma_f32_16x16x32_bf16 v[112:115], v[168:171], v[200:203], v[112:115]
    ds_read_b64_tr_b16 v[160:161], v14 offset:128
    v_mul_f32 v237, v53, v53
    v_mul_f32 v238, v54, v54
    v_mul_f32 v239, v55, v55
    v_fma_f32 v236, v236, v242, v240
    v_fma_f32 v237, v237, v242, v240
    v_mfma_f32_16x16x32_bf16 v[116:119], v[168:171], v[204:207], v[116:119]
    ds_read_b64_tr_b16 v[162:163], v14 offset:4736
    v_fma_f32 v238, v238, v242, v240
    v_fma_f32 v239, v239, v242, v240
    v_mul_f32 v236, v236, v52
    v_mul_f32 v237, v237, v53
    s_waitcnt lgkmcnt(6)
    v_mfma_f32_16x16x32_bf16 v[120:123], v[172:175], v[200:203], v[120:123]
    ds_read_b64_tr_b16 v[164:165], v14 offset:9344
    v_mul_f32 v238, v238, v54
    v_mul_f32 v239, v239, v55
    v_mul_f32 v52, v52, v60
    v_mul_f32 v53, v53, v61
    v_mul_f32 v54, v54, v62
    v_mfma_f32_16x16x32_bf16 v[124:127], v[172:175], v[204:207], v[124:127]
    ds_read_b64_tr_b16 v[166:167], v14 offset:13952
    v_mul_f32 v55, v55, v63
    v_exp_f32 v236, v236
    v_exp_f32 v237, v237
    v_exp_f32 v238, v238
    s_waitcnt lgkmcnt(6)
    v_mfma_f32_16x16x32_bf16 v[128:131], v[176:179], v[200:203], v[128:131]
    ds_read_b64_tr_b16 v[168:169], v14 offset:160
    v_exp_f32 v239, v239
    v_add_f32 v236, 1.0, v236
    v_add_f32 v237, 1.0, v237
    v_add_f32 v238, 1.0, v238
    v_add_f32 v239, 1.0, v239
    v_mfma_f32_16x16x32_bf16 v[132:135], v[176:179], v[204:207], v[132:135]
    ds_read_b64_tr_b16 v[170:171], v14 offset:4768
    v_rcp_f32 v236, v236
    v_rcp_f32 v237, v237
    v_rcp_f32 v238, v238
    v_rcp_f32 v239, v239
    s_waitcnt lgkmcnt(6)
    v_mfma_f32_16x16x32_bf16 v[136:139], v[180:183], v[200:203], v[136:139]
    ds_read_b64_tr_b16 v[172:173], v14 offset:9376
    s_nop 0
    v_mul_f32 v52, v52, v236
    v_mul_f32 v53, v53, v237
    v_mul_f32 v54, v54, v238
    v_mul_f32 v55, v55, v239
    v_mfma_f32_16x16x32_bf16 v[140:143], v[180:183], v[204:207], v[140:143]
    ds_read_b64_tr_b16 v[174:175], v14 offset:13984
    v_cvt_pk_bf16_f32 v60, v52, v53
    v_cvt_pk_bf16_f32 v61, v54, v55
    v_mul_f32 v232, v64, v64
    v_mul_f32 v233, v65, v65
    s_waitcnt lgkmcnt(6)
    v_mfma_f32_16x16x32_bf16 v[80:83], v[160:163], v[208:211], v[80:83]
    ds_read_b64_tr_b16 v[176:177], v14 offset:192
    v_mul_f32 v234, v66, v66
    v_mul_f32 v235, v67, v67
    v_fma_f32 v232, v232, v242, v240
    v_fma_f32 v233, v233, v242, v240
    v_fma_f32 v234, v234, v242, v240
    v_mfma_f32_16x16x32_bf16 v[84:87], v[160:163], v[212:215], v[84:87]
    ds_read_b64_tr_b16 v[178:179], v14 offset:4800
    v_fma_f32 v235, v235, v242, v240
    v_mul_f32 v232, v232, v64
    v_mul_f32 v233, v233, v65
    v_mul_f32 v234, v234, v66
    s_waitcnt lgkmcnt(6)
    v_mfma_f32_16x16x32_bf16 v[88:91], v[164:167], v[208:211], v[88:91]
    ds_read_b64_tr_b16 v[180:181], v14 offset:9408
    v_mul_f32 v235, v235, v67
    v_mul_f32 v64, v64, v72
    v_mul_f32 v65, v65, v73
    v_mul_f32 v66, v66, v74
    v_mul_f32 v67, v67, v75
    v_mfma_f32_16x16x32_bf16 v[92:95], v[164:167], v[212:215], v[92:95]
    ds_read_b64_tr_b16 v[182:183], v14 offset:14016
    v_exp_f32 v232, v232
    v_exp_f32 v233, v233
    v_exp_f32 v234, v234
    v_exp_f32 v235, v235
    s_waitcnt lgkmcnt(6)
    v_mfma_f32_16x16x32_bf16 v[96:99], v[168:171], v[208:211], v[96:99]
    ds_read_b64_tr_b16 v[160:161], v14 offset:224
    v_add_f32 v232, 1.0, v232
    v_add_f32 v233, 1.0, v233
    v_add_f32 v234, 1.0, v234
    v_add_f32 v235, 1.0, v235
    v_rcp_f32 v232, v232
    v_mfma_f32_16x16x32_bf16 v[100:103], v[168:171], v[212:215], v[100:103]
    ds_read_b64_tr_b16 v[162:163], v14 offset:4832
    v_rcp_f32 v233, v233
    v_rcp_f32 v234, v234
    v_rcp_f32 v235, v235
    s_nop 0
    s_waitcnt lgkmcnt(6)
    v_mfma_f32_16x16x32_bf16 v[104:107], v[172:175], v[208:211], v[104:107]
    ds_read_b64_tr_b16 v[164:165], v14 offset:9440
    v_mul_f32 v64, v64, v232
    v_mul_f32 v65, v65, v233
    v_mul_f32 v66, v66, v234
    v_mul_f32 v67, v67, v235
    v_cvt_pk_bf16_f32 v58, v64, v65
    v_mfma_f32_16x16x32_bf16 v[108:111], v[172:175], v[212:215], v[108:111]
    ds_read_b64_tr_b16 v[166:167], v14 offset:14048
    v_cvt_pk_bf16_f32 v59, v66, v67
    s_add_u32 s56, s58, 1024
    buffer_store_dwordx4 v[56:59], v9, s[60:63], s56 offen sc1
    v_mul_f32 v236, v68, v68
    s_waitcnt lgkmcnt(6)
    v_mfma_f32_16x16x32_bf16 v[112:115], v[176:179], v[208:211], v[112:115]
    ds_read_b64_tr_b16 v[168:169], v14 offset:18560
    v_mul_f32 v237, v69, v69
    v_mul_f32 v238, v70, v70
    v_mul_f32 v239, v71, v71
    v_fma_f32 v236, v236, v242, v240
    v_fma_f32 v237, v237, v242, v240
    v_mfma_f32_16x16x32_bf16 v[116:119], v[176:179], v[212:215], v[116:119]
    ds_read_b64_tr_b16 v[170:171], v14 offset:23168
    v_fma_f32 v238, v238, v242, v240
    v_fma_f32 v239, v239, v242, v240
    v_mul_f32 v236, v236, v68
    v_mul_f32 v237, v237, v69
    s_waitcnt lgkmcnt(6)
    v_mfma_f32_16x16x32_bf16 v[120:123], v[180:183], v[208:211], v[120:123]
    ds_read_b64_tr_b16 v[172:173], v14 offset:27776
    v_mul_f32 v238, v238, v70
    v_mul_f32 v239, v239, v71
    v_mul_f32 v68, v68, v76
    v_mul_f32 v69, v69, v77
    v_mul_f32 v70, v70, v78
    v_mfma_f32_16x16x32_bf16 v[124:127], v[180:183], v[212:215], v[124:127]
    ds_read_b64_tr_b16 v[174:175], v14 offset:32384
    v_mul_f32 v71, v71, v79
    v_exp_f32 v236, v236
    v_exp_f32 v237, v237
    v_exp_f32 v238, v238
    s_waitcnt lgkmcnt(6)
    v_mfma_f32_16x16x32_bf16 v[128:131], v[160:163], v[208:211], v[128:131]
    ds_read_b64_tr_b16 v[176:177], v14 offset:18592
    v_exp_f32 v239, v239
    v_add_f32 v236, 1.0, v236
    v_add_f32 v237, 1.0, v237
    v_add_f32 v238, 1.0, v238
    v_add_f32 v239, 1.0, v239
    v_mfma_f32_16x16x32_bf16 v[132:135], v[160:163], v[212:215], v[132:135]
    ds_read_b64_tr_b16 v[178:179], v14 offset:23200
    v_rcp_f32 v236, v236
    v_rcp_f32 v237, v237
    v_rcp_f32 v238, v238
    v_rcp_f32 v239, v239
    s_waitcnt lgkmcnt(6)
    v_mfma_f32_16x16x32_bf16 v[136:139], v[164:167], v[208:211], v[136:139]
    ds_read_b64_tr_b16 v[180:181], v14 offset:27808
    s_nop 0
    v_mul_f32 v68, v68, v236
    v_mul_f32 v69, v69, v237
    v_mul_f32 v70, v70, v238
    v_mul_f32 v71, v71, v239
    v_mfma_f32_16x16x32_bf16 v[140:143], v[164:167], v[212:215], v[140:143]
    ds_read_b64_tr_b16 v[182:183], v14 offset:32416
    v_cvt_pk_bf16_f32 v62, v68, v69
    v_cvt_pk_bf16_f32 v63, v70, v71
    s_add_u32 s56, s58, 148480
    buffer_store_dwordx4 v[60:63], v9, s[60:63], s56 offen sc1
    s_waitcnt lgkmcnt(6)
    v_mfma_f32_16x16x32_bf16 v[80:83], v[168:171], v[216:219], v[80:83]
    ds_read_b64_tr_b16 v[160:161], v14 offset:18624
    v_mfma_f32_16x16x32_bf16 v[84:87], v[168:171], v[220:223], v[84:87]
    ds_read_b64_tr_b16 v[162:163], v14 offset:23232
    s_waitcnt lgkmcnt(6)
    v_mfma_f32_16x16x32_bf16 v[88:91], v[172:175], v[216:219], v[88:91]
    ds_read_b64_tr_b16 v[164:165], v14 offset:27840
    v_mfma_f32_16x16x32_bf16 v[92:95], v[172:175], v[220:223], v[92:95]
    ds_read_b64_tr_b16 v[166:167], v14 offset:32448
    s_waitcnt lgkmcnt(6)
    v_mfma_f32_16x16x32_bf16 v[96:99], v[176:179], v[216:219], v[96:99]
    ds_read_b64_tr_b16 v[168:169], v14 offset:18656
    v_mfma_f32_16x16x32_bf16 v[100:103], v[176:179], v[220:223], v[100:103]
    ds_read_b64_tr_b16 v[170:171], v14 offset:23264
    s_waitcnt lgkmcnt(6)
    v_mfma_f32_16x16x32_bf16 v[104:107], v[180:183], v[216:219], v[104:107]
    ds_read_b64_tr_b16 v[172:173], v14 offset:27872
    v_mfma_f32_16x16x32_bf16 v[108:111], v[180:183], v[220:223], v[108:111]
    ds_read_b64_tr_b16 v[174:175], v14 offset:32480
    s_waitcnt lgkmcnt(6)
    v_mfma_f32_16x16x32_bf16 v[112:115], v[160:163], v[216:219], v[112:115]
    ds_read_b64_tr_b16 v[176:177], v14 offset:36992
    v_mfma_f32_16x16x32_bf16 v[116:119], v[160:163], v[220:223], v[116:119]
    ds_read_b64_tr_b16 v[178:179], v14 offset:41600
    s_waitcnt lgkmcnt(6)
    v_mfma_f32_16x16x32_bf16 v[120:123], v[164:167], v[216:219], v[120:123]
    ds_read_b64_tr_b16 v[180:181], v14 offset:46208
    v_mfma_f32_16x16x32_bf16 v[124:127], v[164:167], v[220:223], v[124:127]
    ds_read_b64_tr_b16 v[182:183], v14 offset:50816
    s_waitcnt lgkmcnt(6)
    v_mfma_f32_16x16x32_bf16 v[128:131], v[168:171], v[216:219], v[128:131]
    ds_read_b64_tr_b16 v[160:161], v14 offset:37024
    v_mfma_f32_16x16x32_bf16 v[132:135], v[168:171], v[220:223], v[132:135]
    ds_read_b64_tr_b16 v[162:163], v14 offset:41632
    s_waitcnt lgkmcnt(6)
    v_mfma_f32_16x16x32_bf16 v[136:139], v[172:175], v[216:219], v[136:139]
    ds_read_b64_tr_b16 v[164:165], v14 offset:46240
    v_mfma_f32_16x16x32_bf16 v[140:143], v[172:175], v[220:223], v[140:143]
    ds_read_b64_tr_b16 v[166:167], v14 offset:50848
    s_waitcnt lgkmcnt(6)
    v_mfma_f32_16x16x32_bf16 v[80:83], v[176:179], v[224:227], v[80:83]
    ds_read_b64_tr_b16 v[168:169], v14 offset:37056
    v_mfma_f32_16x16x32_bf16 v[84:87], v[176:179], v[228:231], v[84:87]
    ds_read_b64_tr_b16 v[170:171], v14 offset:41664
    s_waitcnt lgkmcnt(6)
    v_mfma_f32_16x16x32_bf16 v[88:91], v[180:183], v[224:227], v[88:91]
    ds_read_b64_tr_b16 v[172:173], v14 offset:46272
    v_mfma_f32_16x16x32_bf16 v[92:95], v[180:183], v[228:231], v[92:95]
    ds_read_b64_tr_b16 v[174:175], v14 offset:50880
    s_waitcnt lgkmcnt(6)
    v_mfma_f32_16x16x32_bf16 v[96:99], v[160:163], v[224:227], v[96:99]
    ds_read_b64_tr_b16 v[176:177], v14 offset:37088
    v_mfma_f32_16x16x32_bf16 v[100:103], v[160:163], v[228:231], v[100:103]
    ds_read_b64_tr_b16 v[178:179], v14 offset:41696
    s_waitcnt lgkmcnt(6)
    v_mfma_f32_16x16x32_bf16 v[104:107], v[164:167], v[224:227], v[104:107]
    ds_read_b64_tr_b16 v[180:181], v14 offset:46304
    v_mfma_f32_16x16x32_bf16 v[108:111], v[164:167], v[228:231], v[108:111]
    ds_read_b64_tr_b16 v[182:183], v14 offset:50912
    s_waitcnt lgkmcnt(6)
    v_mfma_f32_16x16x32_bf16 v[112:115], v[168:171], v[224:227], v[112:115]
    ds_read_b64_tr_b16 v[160:161], v13 offset:256
    v_mfma_f32_16x16x32_bf16 v[116:119], v[168:171], v[228:231], v[116:119]
    ds_read_b64_tr_b16 v[162:163], v13 offset:4864
    s_waitcnt lgkmcnt(6)
    v_mfma_f32_16x16x32_bf16 v[120:123], v[172:175], v[224:227], v[120:123]
    ds_read_b64_tr_b16 v[164:165], v13 offset:9472
    v_mfma_f32_16x16x32_bf16 v[124:127], v[172:175], v[228:231], v[124:127]
    ds_read_b64_tr_b16 v[166:167], v13 offset:14080
    s_waitcnt lgkmcnt(6)
    v_mfma_f32_16x16x32_bf16 v[128:131], v[176:179], v[224:227], v[128:131]
    ds_read_b64_tr_b16 v[168:169], v13 offset:18688
    v_mfma_f32_16x16x32_bf16 v[132:135], v[176:179], v[228:231], v[132:135]
    ds_read_b64_tr_b16 v[170:171], v13 offset:23296
    s_waitcnt lgkmcnt(6)
    v_mfma_f32_16x16x32_bf16 v[136:139], v[180:183], v[224:227], v[136:139]
    ds_read_b64_tr_b16 v[172:173], v13 offset:27904
    v_mfma_f32_16x16x32_bf16 v[140:143], v[180:183], v[228:231], v[140:143]
    ds_read_b64_tr_b16 v[174:175], v13 offset:32512
    s_waitcnt vmcnt(0)
    v_mov_b32 v2, 163776
    v_mov_b32 v3, 1
    s_mov_b64 exec, 1
    ds_add_rtn_u32 v3, v2, v3
    s_waitcnt lgkmcnt(0)
    v_readfirstlane_b32 s59, v3
    s_nop 0
    s_mov_b64 exec, -1
    s_cmp_eq_u32 s59, 7
    s_cbranch_scc0 Lpub_55
    s_lshl_b32 s59, s95, 5
    s_add_u32 s59, s59, s94
    s_lshl_b32 s59, s59, 4
    s_add_u32 s59, s59, 135168
    v_mul_u32_u24 v2, 4224, v1
    v_add_u32 v2, s59, v2
    v_mov_b32 v3, s91
    s_mov_b64 exec, 0xff
    buffer_store_dword v3, v2, s[96:99], 0 offen sc1
    s_mov_b64 exec, -1
Lpub_55:
    s_waitcnt lgkmcnt(6)
    v_mfma_f32_16x16x32_bf16 v[144:147], v[160:163], v[184:187], v[144:147]
    ds_read_b64_tr_b16 v[176:177], v13 offset:37120
    v_mul_f32 v232, v80, v80
    v_mul_f32 v233, v81, v81
    v_mul_f32 v234, v82, v82
    v_mfma_f32_16x16x32_bf16 v[148:151], v[160:163], v[188:191], v[148:151]
    ds_read_b64_tr_b16 v[178:179], v13 offset:41728
    v_mul_f32 v235, v83, v83
    v_fma_f32 v232, v232, v242, v240
    v_fma_f32 v233, v233, v242, v240
    s_waitcnt lgkmcnt(6)
    v_mfma_f32_16x16x32_bf16 v[152:155], v[164:167], v[184:187], v[152:155]
    ds_read_b64_tr_b16 v[180:181], v13 offset:46336
    v_fma_f32 v234, v234, v242, v240
    v_fma_f32 v235, v235, v242, v240
    v_mul_f32 v232, v232, v80
    v_mfma_f32_16x16x32_bf16 v[156:159], v[164:167], v[188:191], v[156:159]
    ds_read_b64_tr_b16 v[182:183], v13 offset:50944
    v_mul_f32 v233, v233, v81
    v_mul_f32 v234, v234, v82
    v_mul_f32 v235, v235, v83
    s_waitcnt lgkmcnt(6)
    v_mfma_f32_16x16x32_bf16 v[144:147], v[168:171], v[192:195], v[144:147]
    ds_read_b64_tr_b16 v[160:161], v14 offset:256
    v_mul_f32 v80, v80, v88
    v_mul_f32 v81, v81, v89
    v_mul_f32 v82, v82, v90
    v_mfma_f32_16x16x32_bf16 v[148:151], v[168:171], v[196:199], v[148:151]
    ds_read_b64_tr_b16 v[162:163], v14 offset:4864
    v_mul_f32 v83, v83, v91
    v_exp_f32 v232, v232
    v_exp_f32 v233, v233
    s_waitcnt lgkmcnt(6)
    v_mfma_f32_16x16x32_bf16 v[152:155], v[172:175], v[192:195], v[152:155]
    ds_read_b64_tr_b16 v[164:165], v14 offset:9472
    v_exp_f32 v234, v234
    v_exp_f32 v235, v235
    v_add_f32 v232, 1.0, v232
    v_mfma_f32_16x16x32_bf16 v[156:159], v[172:175], v[196:199], v[156:159]
    ds_read_b64_tr_b16 v[166:167], v14 offset:14080
    v_add_f32 v233, 1.0, v233
    v_add_f32 v234, 1.0, v234
    v_add_f32 v235, 1.0, v235
    s_waitcnt lgkmcnt(6)
    v_mfma_f32_16x16x32_bf16 v[144:147], v[176:179], v[200:203], v[144:147]
    ds_read_b64_tr_b16 v[168:169], v14 offset:18688
    v_rcp_f32 v232, v232
    v_rcp_f32 v233, v233
    v_rcp_f32 v234, v234
    v_mfma_f32_16x16x32_bf16 v[148:151], v[176:179], v[204:207], v[148:151]
    ds_read_b64_tr_b16 v[170:171], v14 offset:23296
    v_rcp_f32 v235, v235
    s_nop 0
    v_mul_f32 v80, v80, v232
    s_waitcnt lgkmcnt(6)
    v_mfma_f32_16x16x32_bf16 v[152:155], v[180:183], v[200:203], v[152:155]
    ds_read_b64_tr_b16 v[172:173], v14 offset:27904
    v_mul_f32 v81, v81, v233
    v_mul_f32 v82, v82, v234
    v_mul_f32 v83, v83, v235
    v_mfma_f32_16x16x32_bf16 v[156:159], v[180:183], v[204:207], v[156:159]
    ds_read_b64_tr_b16 v[174:175], v14 offset:32512
    v_cvt_pk_bf16_f32 v88, v80, v81
    v_cvt_pk_bf16_f32 v89, v82, v83
    v_mul_f32 v236, v84, v84
    s_waitcnt lgkmcnt(6)
    v_mfma_f32_16x16x32_bf16 v[144:147], v[160:163], v[208:211], v[144:147]
    ds_read_b64_tr_b16 v[176:177], v14 offset:37120
    v_mul_f32 v237, v85, v85
    v_mul_f32 v238, v86, v86
    v_mul_f32 v239, v87, v87
    v_mfma_f32_16x16x32_bf16 v[148:151], v[160:163], v[212:215], v[148:151]
    ds_read_b64_tr_b16 v[178:179], v14 offset:41728
    v_fma_f32 v236, v236, v242, v240
    v_fma_f32 v237, v237, v242, v240
    v_fma_f32 v238, v238, v242, v240
    s_waitcnt lgkmcnt(6)
    v_mfma_f32_16x16x32_bf16 v[152:155], v[164:167], v[208:211], v[152:155]
    ds_read_b64_tr_b16 v[180:181], v14 offset:46336
    v_fma_f32 v239, v239, v242, v240
    v_mul_f32 v236, v236, v84
    v_mul_f32 v237, v237, v85
    v_mfma_f32_16x16x32_bf16 v[156:159], v[164:167], v[212:215], v[156:159]
    ds_read_b64_tr_b16 v[182:183], v14 offset:50944
    v_mul_f32 v238, v238, v86
    v_mul_f32 v239, v239, v87
    v_mul_f32 v84, v84, v92
    s_waitcnt lgkmcnt(6)
    v_mfma_f32_16x16x32_bf16 v[144:147], v[168:171], v[216:219], v[144:147]
    v_mul_f32 v85, v85, v93
    v_mul_f32 v86, v86, v94
    v_mul_f32 v87, v87, v95
    v_mfma_f32_16x16x32_bf16 v[148:151], v[168:171], v[220:223], v[148:151]
    v_exp_f32 v236, v236
    v_exp_f32 v237, v237
    v_exp_f32 v238, v238
    s_waitcnt lgkmcnt(4)
    v_mfma_f32_16x16x32_bf16 v[152:155], v[172:175], v[216:219], v[152:155]
    v_exp_f32 v239, v239
    v_add_f32 v236, 1.0, v236
    v_add_f32 v237, 1.0, v237
    v_mfma_f32_16x16x32_bf16 v[156:159], v[172:175], v[220:223], v[156:159]
    v_add_f32 v238, 1.0, v238
    v_add_f32 v239, 1.0, v239
    v_rcp_f32 v236, v236
    s_waitcnt lgkmcnt(2)
    v_mfma_f32_16x16x32_bf16 v[144:147], v[176:179], v[224:227], v[144:147]
    v_rcp_f32 v237, v237
    v_rcp_f32 v238, v238
    v_rcp_f32 v239, v239
    v_mfma_f32_16x16x32_bf16 v[148:151], v[176:179], v[228:231], v[148:151]
    s_nop 0
    v_mul_f32 v84, v84, v236
    s_waitcnt lgkmcnt(0)
    v_mfma_f32_16x16x32_bf16 v[152:155], v[180:183], v[224:227], v[152:155]
    v_mul_f32 v85, v85, v237
    v_mul_f32 v86, v86, v238
    v_mul_f32 v87, v87, v239
    v_mfma_f32_16x16x32_bf16 v[156:159], v[180:183], v[228:231], v[156:159]
    v_cvt_pk_bf16_f32 v92, v84, v85
    v_cvt_pk_bf16_f32 v93, v86, v87
    s_barrier
    s_cmp_ge_u32 s2, 240
    s_cbranch_scc0 Lg2go_56
    v_pk_mul_f32 v[232:233], v[96:97], v[96:97]
    v_pk_mul_f32 v[234:235], v[98:99], v[98:99]
    v_pk_fma_f32 v[232:233], v[232:233], v[242:243], v[240:241]
    v_pk_fma_f32 v[234:235], v[234:235], v[242:243], v[240:241]
    v_pk_mul_f32 v[232:233], v[232:233], v[96:97]
    v_pk_mul_f32 v[234:235], v[234:235], v[98:99]
    v_pk_mul_f32 v[96:97], v[96:97], v[104:105]
    v_pk_mul_f32 v[98:99], v[98:99], v[106:107]
    v_exp_f32 v232, v232
    v_exp_f32 v233, v233
    v_exp_f32 v234, v234
    v_exp_f32 v235, v235
    v_pk_add_f32 v[232:233], v[232:233], v[244:245]
    v_pk_add_f32 v[234:235], v[234:235], v[244:245]
    v_rcp_f32 v232, v232
    v_rcp_f32 v233, v233
    v_rcp_f32 v234, v234
    v_rcp_f32 v235, v235
    v_pk_mul_f32 v[96:97], v[96:97], v[232:233]
    v_pk_mul_f32 v[98:99], v[98:99], v[234:235]
    v_cvt_pk_bf16_f32 v90, v96, v97
    v_cvt_pk_bf16_f32 v91, v98, v99
    s_add_u32 s56, s58, 2048
    buffer_store_dwordx4 v[88:91], v9, s[60:63], s56 offen sc1
    v_pk_mul_f32 v[236:237], v[100:101], v[100:101]
    v_pk_mul_f32 v[238:239], v[102:103], v[102:103]
    v_pk_fma_f32 v[236:237], v[236:237], v[242:243], v[240:241]
    v_pk_fma_f32 v[238:239], v[238:239], v[242:243], v[240:241]
    v_pk_mul_f32 v[236:237], v[236:237], v[100:101]
    v_pk_mul_f32 v[238:239], v[238:239], v[102:103]
    v_pk_mul_f32 v[100:101], v[100:101], v[108:109]
    v_pk_mul_f32 v[102:103], v[102:103], v[110:111]
    v_exp_f32 v236, v236
    v_exp_f32 v237, v237
    v_exp_f32 v238, v238
    v_exp_f32 v239, v239
    v_pk_add_f32 v[236:237], v[236:237], v[244:245]
    v_pk_add_f32 v[238:239], v[238:239], v[244:245]
    v_rcp_f32 v236, v236
    v_rcp_f32 v237, v237
    v_rcp_f32 v238, v238
    v_rcp_f32 v239, v239
    v_pk_mul_f32 v[100:101], v[100:101], v[236:237]
    v_pk_mul_f32 v[102:103], v[102:103], v[238:239]
    v_cvt_pk_bf16_f32 v94, v100, v101
    v_cvt_pk_bf16_f32 v95, v102, v103
    s_add_u32 s56, s58, 149504
    buffer_store_dwordx4 v[92:95], v9, s[60:63], s56 offen sc1
    v_pk_mul_f32 v[232:233], v[112:113], v[112:113]
    v_pk_mul_f32 v[234:235], v[114:115], v[114:115]
    v_pk_fma_f32 v[232:233], v[232:233], v[242:243], v[240:241]
    v_pk_fma_f32 v[234:235], v[234:235], v[242:243], v[240:241]
    v_pk_mul_f32 v[232:233], v[232:233], v[112:113]
    v_pk_mul_f32 v[234:235], v[234:235], v[114:115]
    v_pk_mul_f32 v[112:113], v[112:113], v[120:121]
    v_pk_mul_f32 v[114:115], v[114:115], v[122:123]
    v_exp_f32 v232, v232
    v_exp_f32 v233, v233
    v_exp_f32 v234, v234
    v_exp_f32 v235, v235
    v_pk_add_f32 v[232:233], v[232:233], v[244:245]
    v_pk_add_f32 v[234:235], v[234:235], v[244:245]
    v_rcp_f32 v232, v232
    v_rcp_f32 v233, v233
    v_rcp_f32 v234, v234
    v_rcp_f32 v235, v235
    v_pk_mul_f32 v[112:113], v[112:113], v[232:233]
    v_pk_mul_f32 v[114:115], v[114:115], v[234:235]
    v_cvt_pk_bf16_f32 v120, v112, v113
    v_cvt_pk_bf16_f32 v121, v114, v115
    v_pk_mul_f32 v[236:237], v[116:117], v[116:117]
    v_pk_mul_f32 v[238:239], v[118:119], v[118:119]
    v_pk_fma_f32 v[236:237], v[236:237], v[242:243], v[240:241]
    v_pk_fma_f32 v[238:239], v[238:239], v[242:243], v[240:241]
    v_pk_mul_f32 v[236:237], v[236:237], v[116:117]
    v_pk_mul_f32 v[238:239], v[238:239], v[118:119]
    v_pk_mul_f32 v[116:117], v[116:117], v[124:125]
    v_pk_mul_f32 v[118:119], v[118:119], v[126:127]
    v_exp_f32 v236, v236
    v_exp_f32 v237, v237
    v_exp_f32 v238, v238
    v_exp_f32 v239, v239
    v_pk_add_f32 v[236:237], v[236:237], v[244:245]
    v_pk_add_f32 v[238:239], v[238:239], v[244:245]
    v_rcp_f32 v236, v236
    v_rcp_f32 v237, v237
    v_rcp_f32 v238, v238
    v_rcp_f32 v239, v239
    v_pk_mul_f32 v[116:117], v[116:117], v[236:237]
    v_pk_mul_f32 v[118:119], v[118:119], v[238:239]
    v_cvt_pk_bf16_f32 v124, v116, v117
    v_cvt_pk_bf16_f32 v125, v118, v119
    v_pk_mul_f32 v[232:233], v[128:129], v[128:129]
    v_pk_mul_f32 v[234:235], v[130:131], v[130:131]
    v_pk_fma_f32 v[232:233], v[232:233], v[242:243], v[240:241]
    v_pk_fma_f32 v[234:235], v[234:235], v[242:243], v[240:241]
    v_pk_mul_f32 v[232:233], v[232:233], v[128:129]
    v_pk_mul_f32 v[234:235], v[234:235], v[130:131]
    v_pk_mul_f32 v[128:129], v[128:129], v[136:137]
    v_pk_mul_f32 v[130:131], v[130:131], v[138:139]
    v_exp_f32 v232, v232
    v_exp_f32 v233, v233
    v_exp_f32 v234, v234
    v_exp_f32 v235, v235
    v_pk_add_f32 v[232:233], v[232:233], v[244:245]
    v_pk_add_f32 v[234:235], v[234:235], v[244:245]
    v_rcp_f32 v232, v232
    v_rcp_f32 v233, v233
    v_rcp_f32 v234, v234
    v_rcp_f32 v235, v235
    v_pk_mul_f32 v[128:129], v[128:129], v[232:233]
    v_pk_mul_f32 v[130:131], v[130:131], v[234:235]
    v_cvt_pk_bf16_f32 v122, v128, v129
    v_cvt_pk_bf16_f32 v123, v130, v131
    s_add_u32 s56, s58, 3072
    buffer_store_dwordx4 v[120:123], v9, s[60:63], s56 offen sc1
    v_pk_mul_f32 v[236:237], v[132:133], v[132:133]
    v_pk_mul_f32 v[238:239], v[134:135], v[134:135]
    v_pk_fma_f32 v[236:237], v[236:237], v[242:243], v[240:241]
    v_pk_fma_f32 v[238:239], v[238:239], v[242:243], v[240:241]
    v_pk_mul_f32 v[236:237], v[236:237], v[132:133]
    v_pk_mul_f32 v[238:239], v[238:239], v[134:135]
    v_pk_mul_f32 v[132:133], v[132:133], v[140:141]
    v_pk_mul_f32 v[134:135], v[134:135], v[142:143]
    v_exp_f32 v236, v236
    v_exp_f32 v237, v237
    v_exp_f32 v238, v238
    v_exp_f32 v239, v239
    v_pk_add_f32 v[236:237], v[236:237], v[244:245]
    v_pk_add_f32 v[238:239], v[238:239], v[244:245]
    v_rcp_f32 v236, v236
    v_rcp_f32 v237, v237
    v_rcp_f32 v238, v238
    v_rcp_f32 v239, v239
    v_pk_mul_f32 v[132:133], v[132:133], v[236:237]
    v_pk_mul_f32 v[134:135], v[134:135], v[238:239]
    v_cvt_pk_bf16_f32 v126, v132, v133
    v_cvt_pk_bf16_f32 v127, v134, v135
    s_add_u32 s56, s58, 150528
    buffer_store_dwordx4 v[124:127], v9, s[60:63], s56 offen sc1
    v_pk_mul_f32 v[232:233], v[144:145], v[144:145]
    v_pk_mul_f32 v[234:235], v[146:147], v[146:147]
    v_pk_fma_f32 v[232:233], v[232:233], v[242:243], v[240:241]
    v_pk_fma_f32 v[234:235], v[234:235], v[242:243], v[240:241]
    v_pk_mul_f32 v[232:233], v[232:233], v[144:145]
    v_pk_mul_f32 v[234:235], v[234:235], v[146:147]
    v_pk_mul_f32 v[144:145], v[144:145], v[152:153]
    v_pk_mul_f32 v[146:147], v[146:147], v[154:155]
    v_exp_f32 v232, v232
    v_exp_f32 v233, v233
    v_exp_f32 v234, v234
    v_exp_f32 v235, v235
    v_pk_add_f32 v[232:233], v[232:233], v[244:245]
    v_pk_add_f32 v[234:235], v[234:235], v[244:245]
    v_rcp_f32 v232, v232
    v_rcp_f32 v233, v233
    v_rcp_f32 v234, v234
    v_rcp_f32 v235, v235
    v_pk_mul_f32 v[144:145], v[144:145], v[232:233]
    v_pk_mul_f32 v[146:147], v[146:147], v[234:235]
    v_cvt_pk_bf16_f32 v152, v144, v145
    v_cvt_pk_bf16_f32 v153, v146, v147
    s_add_u32 s56, s57, 0
    buffer_store_dwordx2 v[152:153], v9, s[60:63], s56 offen sc1
    v_pk_mul_f32 v[236:237], v[148:149], v[148:149]
    v_pk_mul_f32 v[238:239], v[150:151], v[150:151]
    v_pk_fma_f32 v[236:237], v[236:237], v[242:243], v[240:241]
    v_pk_fma_f32 v[238:239], v[238:239], v[242:243], v[240:241]
    v_pk_mul_f32 v[236:237], v[236:237], v[148:149]
    v_pk_mul_f32 v[238:239], v[238:239], v[150:151]
    v_pk_mul_f32 v[148:149], v[148:149], v[156:157]
    v_pk_mul_f32 v[150:151], v[150:151], v[158:159]
    v_exp_f32 v236, v236
    v_exp_f32 v237, v237
    v_exp_f32 v238, v238
    v_exp_f32 v239, v239
    v_pk_add_f32 v[236:237], v[236:237], v[244:245]
    v_pk_add_f32 v[238:239], v[238:239], v[244:245]
    v_rcp_f32 v236, v236
    v_rcp_f32 v237, v237
    v_rcp_f32 v238, v238
    v_rcp_f32 v239, v239
    v_pk_mul_f32 v[148:149], v[148:149], v[236:237]
    v_pk_mul_f32 v[150:151], v[150:151], v[238:239]
    v_cvt_pk_bf16_f32 v156, v148, v149
    v_cvt_pk_bf16_f32 v157, v150, v151
    s_add_u32 s56, s57, 147456
    buffer_store_dwordx2 v[156:157], v9, s[60:63], s56 offen sc1
    s_lshl_b32 s58, s95, 5
    s_add_u32 s58, s58, s94
    s_waitcnt vmcnt(0) lgkmcnt(0)
    s_barrier
    s_cmp_eq_u32 s90, 0
    s_cbranch_scc0 Lsig_57
    s_lshl_b32 s60, s58, 4
    s_add_u32 s60, s60, 236544
    v_mul_u32_u24 v2, 4224, v1
    v_add_u32 v2, s60, v2
    v_mov_b32 v3, s91
    s_mov_b64 exec, 0xff
    buffer_store_dword v3, v2, s[96:99], 0 offen sc1
    s_mov_b64 exec, -1
Lsig_57:
    s_endpgm
Lg2go_56:
    s_mov_b64 exec, s[84:85]
    buffer_load_dword v3, v8, s[96:99], 0 offen sc1
    s_mov_b64 exec, -1
    v_pk_mul_f32 v[232:233], v[96:97], v[96:97]
    v_pk_mul_f32 v[234:235], v[98:99], v[98:99]
    v_pk_fma_f32 v[232:233], v[232:233], v[242:243], v[240:241]
    v_pk_fma_f32 v[234:235], v[234:235], v[242:243], v[240:241]
    v_pk_mul_f32 v[232:233], v[232:233], v[96:97]
    v_pk_mul_f32 v[234:235], v[234:235], v[98:99]
    v_pk_mul_f32 v[96:97], v[96:97], v[104:105]
    v_pk_mul_f32 v[98:99], v[98:99], v[106:107]
    v_exp_f32 v232, v232
    v_exp_f32 v233, v233
    v_exp_f32 v234, v234
    v_exp_f32 v235, v235
    v_pk_add_f32 v[232:233], v[232:233], v[244:245]
    v_pk_add_f32 v[234:235], v[234:235], v[244:245]
    v_rcp_f32 v232, v232
    v_rcp_f32 v233, v233
    v_rcp_f32 v234, v234
    v_rcp_f32 v235, v235
    v_pk_mul_f32 v[96:97], v[96:97], v[232:233]
    v_pk_mul_f32 v[98:99], v[98:99], v[234:235]
    v_cvt_pk_bf16_f32 v90, v96, v97
    v_cvt_pk_bf16_f32 v91, v98, v99
    v_pk_mul_f32 v[236:237], v[100:101], v[100:101]
    v_pk_mul_f32 v[238:239], v[102:103], v[102:103]
    v_pk_fma_f32 v[236:237], v[236:237], v[242:243], v[240:241]
    v_pk_fma_f32 v[238:239], v[238:239], v[242:243], v[240:241]
    v_pk_mul_f32 v[236:237], v[236:237], v[100:101]
    v_pk_mul_f32 v[238:239], v[238:239], v[102:103]
    v_pk_mul_f32 v[100:101], v[100:101], v[108:109]
    v_pk_mul_f32 v[102:103], v[102:103], v[110:111]
    v_exp_f32 v236, v236
    v_exp_f32 v237, v237
    v_exp_f32 v238, v238
    v_exp_f32 v239, v239
    v_pk_add_f32 v[236:237], v[236:237], v[244:245]
    v_pk_add_f32 v[238:239], v[238:239], v[244:245]
    v_rcp_f32 v236, v236
    v_rcp_f32 v237, v237
    v_rcp_f32 v238, v238
    v_rcp_f32 v239, v239
    v_pk_mul_f32 v[100:101], v[100:101], v[236:237]
    v_pk_mul_f32 v[102:103], v[102:103], v[238:239]
    v_cvt_pk_bf16_f32 v94, v100, v101
    v_cvt_pk_bf16_f32 v95, v102, v103
    s_waitcnt vmcnt(0)
    s_mov_b64 exec, s[84:85]
    v_cmp_ne_u32 vcc, s91, v3
    s_mov_b64 exec, -1
    s_cmp_eq_u64 vcc, 0
    s_cbranch_scc1 Lok_58
    s_mul_i32 s52, s67, 16384
    s_lshr_b32 s52, s52, 16
    s_add_u32 s53, s67, s68
    s_sub_u32 s53, s53, 1
    s_mul_i32 s53, s53, 16384
    s_lshr_b32 s53, s53, 16
    s_sub_u32 s53, s53, s52
    s_add_u32 s53, s53, 1
    s_lshl_b32 s53, s53, 1
    s_lshl_b32 s52, s52, 1
    s_lshr_b32 s54, s65, 1
    s_lshl_b32 s54, s54, 5
    s_add_u32 s52, s52, s54
    s_and_b32 s88, s2, 7
    s_mul_i32 s88, s88, 4224
    s_add_u32 s88, s88, 135168
    s_lshl_b32 s60, s52, 4
    s_add_u32 s60, s60, s88
    v_lshlrev_b32 v2, 4, v1
    v_add_u32 v2, s60, v2
    v_cmp_gt_u32 vcc, s53, v1
    s_mov_b64 exec, vcc
    s_mov_b32 s61, 0
Lpoll_59:
    buffer_load_dword v3, v2, s[96:99], 0 offen sc1
    s_waitcnt vmcnt(0)
    v_cmp_ne_u32 vcc, s91, v3
    s_cmp_eq_u64 vcc, 0
    s_cbranch_scc1 Lpd_60
    s_add_u32 s61, s61, 1
    s_cmp_lt_u32 s61, s93
    s_cbranch_scc1 Lpoll_59
Lpd_60:
    s_mov_b64 exec, -1
    s_add_u32 s60, s30, 16777216
    s_addc_u32 s61, s31, 0
    s_mov_b32 s62, 18874368
    s_mov_b32 s63, 0x20000
Lok_58:
    s_add_u32 s56, s58, 2048
    buffer_store_dwordx4 v[88:91], v9, s[60:63], s56 offen sc1
    s_add_u32 s56, s58, 149504
    buffer_store_dwordx4 v[92:95], v9, s[60:63], s56 offen sc1
    s_add_u32 m0, s38, 0
    s_nop 0
    buffer_load_dwordx4 v246, s[32:35], s36 offen lds
    v_pk_mul_f32 v[232:233], v[112:113], v[112:113]
    v_pk_mul_f32 v[234:235], v[114:115], v[114:115]
    v_pk_fma_f32 v[232:233], v[232:233], v[242:243], v[240:241]
    v_pk_fma_f32 v[234:235], v[234:235], v[242:243], v[240:241]
    v_pk_mul_f32 v[232:233], v[232:233], v[112:113]
    v_pk_mul_f32 v[234:235], v[234:235], v[114:115]
    v_pk_mul_f32 v[112:113], v[112:113], v[120:121]
    v_pk_mul_f32 v[114:115], v[114:115], v[122:123]
    v_exp_f32 v232, v232
    v_exp_f32 v233, v233
    v_exp_f32 v234, v234
    v_exp_f32 v235, v235
    buffer_load_dwordx4 v[184:187], v9, s[4:7], s42 offen sc1
    v_pk_add_f32 v[232:233], v[232:233], v[244:245]
    v_pk_add_f32 v[234:235], v[234:235], v[244:245]
    v_rcp_f32 v232, v232
    v_rcp_f32 v233, v233
    v_rcp_f32 v234, v234
    v_rcp_f32 v235, v235
    v_pk_mul_f32 v[112:113], v[112:113], v[232:233]
    v_pk_mul_f32 v[114:115], v[114:115], v[234:235]
    v_cvt_pk_bf16_f32 v120, v112, v113
    v_cvt_pk_bf16_f32 v121, v114, v115
    v_pk_mul_f32 v[236:237], v[116:117], v[116:117]
    v_pk_mul_f32 v[238:239], v[118:119], v[118:119]
    s_add_u32 m0, s38, 8192
    s_nop 0
    buffer_load_dwordx4 v247, s[32:35], s40 offen lds
    v_pk_fma_f32 v[236:237], v[236:237], v[242:243], v[240:241]
    v_pk_fma_f32 v[238:239], v[238:239], v[242:243], v[240:241]
    v_pk_mul_f32 v[236:237], v[236:237], v[116:117]
    v_pk_mul_f32 v[238:239], v[238:239], v[118:119]
    v_pk_mul_f32 v[116:117], v[116:117], v[124:125]
    v_pk_mul_f32 v[118:119], v[118:119], v[126:127]
    v_exp_f32 v236, v236
    v_exp_f32 v237, v237
    v_exp_f32 v238, v238
    v_exp_f32 v239, v239
    v_pk_add_f32 v[236:237], v[236:237], v[244:245]
    v_pk_add_f32 v[238:239], v[238:239], v[244:245]
    buffer_load_dwordx4 v[188:191], v9, s[8:11], s42 offen sc1
    s_add_u32 s45, s45, 2
    v_readlane_b32 s42, v252, s45
    v_rcp_f32 v236, v236
    v_rcp_f32 v237, v237
    v_rcp_f32 v238, v238
    v_rcp_f32 v239, v239
    v_pk_mul_f32 v[116:117], v[116:117], v[236:237]
    v_pk_mul_f32 v[118:119], v[118:119], v[238:239]
    v_cvt_pk_bf16_f32 v124, v116, v117
    v_cvt_pk_bf16_f32 v125, v118, v119
    v_pk_mul_f32 v[232:233], v[128:129], v[128:129]
    v_pk_mul_f32 v[234:235], v[130:131], v[130:131]
    v_pk_fma_f32 v[232:233], v[232:233], v[242:243], v[240:241]
    v_pk_fma_f32 v[234:235], v[234:235], v[242:243], v[240:241]
    s_add_u32 m0, s38, 16384
    s_nop 0
    buffer_load_dwordx4 v248, s[32:35], s39 offen lds
    v_readlane_b32 s36, v251, s41
    s_add_u32 s41, s41, 1
    v_readlane_b32 s39, v251, s41
    s_add_u32 s41, s41, 1
    s_cmp_lt_u32 s90, 4
    s_cselect_b32 s40, s36, s39
    v_pk_mul_f32 v[232:233], v[232:233], v[128:129]
    v_pk_mul_f32 v[234:235], v[234:235], v[130:131]
    v_pk_mul_f32 v[128:129], v[128:129], v[136:137]
    v_pk_mul_f32 v[130:131], v[130:131], v[138:139]
    v_exp_f32 v232, v232
    v_exp_f32 v233, v233
    v_exp_f32 v234, v234
    v_exp_f32 v235, v235
    v_pk_add_f32 v[232:233], v[232:233], v[244:245]
    v_pk_add_f32 v[234:235], v[234:235], v[244:245]
    v_rcp_f32 v232, v232
    v_rcp_f32 v233, v233
    s_add_u32 m0, s38, 24576
    s_nop 0
    buffer_load_dwordx4 v246, s[32:35], s36 offen lds
    v_rcp_f32 v234, v234
    v_rcp_f32 v235, v235
    v_pk_mul_f32 v[128:129], v[128:129], v[232:233]
    v_pk_mul_f32 v[130:131], v[130:131], v[234:235]
    v_cvt_pk_bf16_f32 v122, v128, v129
    v_cvt_pk_bf16_f32 v123, v130, v131
    s_add_u32 s56, s58, 3072
    buffer_store_dwordx4 v[120:123], v9, s[60:63], s56 offen sc1
    v_pk_mul_f32 v[236:237], v[132:133], v[132:133]
    v_pk_mul_f32 v[238:239], v[134:135], v[134:135]
    v_pk_fma_f32 v[236:237], v[236:237], v[242:243], v[240:241]
    v_pk_fma_f32 v[238:239], v[238:239], v[242:243], v[240:241]
    buffer_load_dwordx4 v[192:195], v9, s[4:7], s42 offen sc1
    v_pk_mul_f32 v[236:237], v[236:237], v[132:133]
    v_pk_mul_f32 v[238:239], v[238:239], v[134:135]
    v_pk_mul_f32 v[132:133], v[132:133], v[140:141]
    v_pk_mul_f32 v[134:135], v[134:135], v[142:143]
    v_exp_f32 v236, v236
    v_exp_f32 v237, v237
    v_exp_f32 v238, v238
    v_exp_f32 v239, v239
    v_pk_add_f32 v[236:237], v[236:237], v[244:245]
    v_pk_add_f32 v[238:239], v[238:239], v[244:245]
    v_rcp_f32 v236, v236
    v_rcp_f32 v237, v237
    s_add_u32 m0, s38, 32768
    s_nop 0
    buffer_load_dwordx4 v247, s[32:35], s40 offen lds
    v_rcp_f32 v238, v238
    v_rcp_f32 v239, v239
    v_pk_mul_f32 v[132:133], v[132:133], v[236:237]
    v_pk_mul_f32 v[134:135], v[134:135], v[238:239]
    v_cvt_pk_bf16_f32 v126, v132, v133
    v_cvt_pk_bf16_f32 v127, v134, v135
    s_add_u32 s56, s58, 150528
    buffer_store_dwordx4 v[124:127], v9, s[60:63], s56 offen sc1
    v_pk_mul_f32 v[232:233], v[144:145], v[144:145]
    v_pk_mul_f32 v[234:235], v[146:147], v[146:147]
    v_pk_fma_f32 v[232:233], v[232:233], v[242:243], v[240:241]
    v_pk_fma_f32 v[234:235], v[234:235], v[242:243], v[240:241]
    buffer_load_dwordx4 v[196:199], v9, s[8:11], s42 offen sc1
    s_add_u32 s45, s45, 2
    v_readlane_b32 s42, v252, s45
    v_pk_mul_f32 v[232:233], v[232:233], v[144:145]
    v_pk_mul_f32 v[234:235], v[234:235], v[146:147]
    v_pk_mul_f32 v[144:145], v[144:145], v[152:153]
    v_pk_mul_f32 v[146:147], v[146:147], v[154:155]
    v_exp_f32 v232, v232
    v_exp_f32 v233, v233
    v_exp_f32 v234, v234
    v_exp_f32 v235, v235
    v_pk_add_f32 v[232:233], v[232:233], v[244:245]
    v_pk_add_f32 v[234:235], v[234:235], v[244:245]
    v_rcp_f32 v232, v232
    v_rcp_f32 v233, v233
    s_add_u32 m0, s38, 40960
    s_nop 0
    buffer_load_dwordx4 v248, s[32:35], s39 offen lds
    v_readlane_b32 s36, v251, s41
    s_add_u32 s41, s41, 1
    v_readlane_b32 s39, v251, s41
    s_add_u32 s41, s41, 1
    s_cmp_lt_u32 s90, 4
    s_cselect_b32 s40, s36, s39
    v_rcp_f32 v234, v234
    v_rcp_f32 v235, v235
    v_pk_mul_f32 v[144:145], v[144:145], v[232:233]
    v_pk_mul_f32 v[146:147], v[146:147], v[234:235]
    v_cvt_pk_bf16_f32 v152, v144, v145
    v_cvt_pk_bf16_f32 v153, v146, v147
    s_add_u32 s56, s57, 0
    buffer_store_dwordx2 v[152:153], v9, s[60:63], s56 offen sc1
    v_pk_mul_f32 v[236:237], v[148:149], v[148:149]
    v_pk_mul_f32 v[238:239], v[150:151], v[150:151]
    v_pk_fma_f32 v[236:237], v[236:237], v[242:243], v[240:241]
    v_pk_fma_f32 v[238:239], v[238:239], v[242:243], v[240:241]
    v_pk_mul_f32 v[236:237], v[236:237], v[148:149]
    v_pk_mul_f32 v[238:239], v[238:239], v[150:151]
    v_pk_mul_f32 v[148:149], v[148:149], v[156:157]
    v_pk_mul_f32 v[150:151], v[150:151], v[158:159]
    v_exp_f32 v236, v236
    v_exp_f32 v237, v237
    v_exp_f32 v238, v238
    v_exp_f32 v239, v239
    v_pk_add_f32 v[236:237], v[236:237], v[244:245]
    v_pk_add_f32 v[238:239], v[238:239], v[244:245]
    v_rcp_f32 v236, v236
    v_rcp_f32 v237, v237
    v_rcp_f32 v238, v238
    v_rcp_f32 v239, v239
    v_pk_mul_f32 v[148:149], v[148:149], v[236:237]
    v_pk_mul_f32 v[150:151], v[150:151], v[238:239]
    v_cvt_pk_bf16_f32 v156, v148, v149
    v_cvt_pk_bf16_f32 v157, v150, v151
    s_add_u32 s56, s57, 147456
    buffer_store_dwordx2 v[156:157], v9, s[60:63], s56 offen sc1
    v_lshrrev_b32 v4, 5, v1
    v_lshlrev_b32 v4, 10, v4
    v_bfe_u32 v5, v1, 2, 3
    v_lshlrev_b32 v5, 6, v5
    v_and_b32 v6, 3, v1
    v_lshlrev_b32 v6, 3, v6
    v_add3_u32 v13, v4, v5, v6
    v_bfe_u32 v4, v1, 4, 1
    v_lshlrev_b32 v4, 5, v4
    s_mul_i32 s52, s43, 12288
    v_add3_u32 v13, v13, v4, s52
    v_add_u32 v224, 0, v13
    v_xor_b32 v225, 32, v224
    v_add_u32 v226, 49152, v13
    v_xor_b32 v227, 32, v226
    v_add_u32 v228, 98304, v13
    v_xor_b32 v229, 32, v228
    v_mov_b32 v16, 0
    v_mov_b32 v17, 0
    v_mov_b32 v18, 0
    v_mov_b32 v19, 0
    v_mov_b32 v20, 0
    v_mov_b32 v21, 0
    v_mov_b32 v22, 0
    v_mov_b32 v23, 0
    v_mov_b32 v24, 0
    v_mov_b32 v25, 0
    v_mov_b32 v26, 0
    v_mov_b32 v27, 0
    v_mov_b32 v28, 0
    v_mov_b32 v29, 0
    v_mov_b32 v30, 0
    v_mov_b32 v31, 0
    v_mov_b32 v32, 0
    v_mov_b32 v33, 0
    v_mov_b32 v34, 0
    v_mov_b32 v35, 0
    v_mov_b32 v36, 0
    v_mov_b32 v37, 0
    v_mov_b32 v38, 0
    v_mov_b32 v39, 0
    v_mov_b32 v40, 0
    v_mov_b32 v41, 0
    v_mov_b32 v42, 0
    v_mov_b32 v43, 0
    v_mov_b32 v44, 0
    v_mov_b32 v45, 0
    v_mov_b32 v46, 0
    v_mov_b32 v47, 0
    v_mov_b32 v48, 0
    v_mov_b32 v49, 0
    v_mov_b32 v50, 0
    v_mov_b32 v51, 0
    v_mov_b32 v52, 0
    v_mov_b32 v53, 0
    v_mov_b32 v54, 0
    v_mov_b32 v55, 0
    v_mov_b32 v56, 0
    v_mov_b32 v57, 0
    v_mov_b32 v58, 0
    v_mov_b32 v59, 0
    v_mov_b32 v60, 0
    v_mov_b32 v61, 0
    v_mov_b32 v62, 0
    v_mov_b32 v63, 0
    v_mov_b32 v64, 0
    v_mov_b32 v65, 0
    v_mov_b32 v66, 0
    v_mov_b32 v67, 0
    v_mov_b32 v68, 0
    v_mov_b32 v69, 0
    v_mov_b32 v70, 0
    v_mov_b32 v71, 0
    v_mov_b32 v72, 0
    v_mov_b32 v73, 0
    v_mov_b32 v74, 0
    v_mov_b32 v75, 0
    v_mov_b32 v76, 0
    v_mov_b32 v77, 0
    v_mov_b32 v78, 0
    v_mov_b32 v79, 0
    v_mov_b32 v80, 0
    v_mov_b32 v81, 0
    v_mov_b32 v82, 0
    v_mov_b32 v83, 0
    v_mov_b32 v84, 0
    v_mov_b32 v85, 0
    v_mov_b32 v86, 0
    v_mov_b32 v87, 0
    v_mov_b32 v88, 0
    v_mov_b32 v89, 0
    v_mov_b32 v90, 0
    v_mov_b32 v91, 0
    v_mov_b32 v92, 0
    v_mov_b32 v93, 0
    v_mov_b32 v94, 0
    v_mov_b32 v95, 0
    v_mov_b32 v96, 0
    v_mov_b32 v97, 0
    v_mov_b32 v98, 0
    v_mov_b32 v99, 0
    v_mov_b32 v100, 0
    v_mov_b32 v101, 0
    v_mov_b32 v102, 0
    v_mov_b32 v103, 0
    v_mov_b32 v104, 0
    v_mov_b32 v105, 0
    v_mov_b32 v106, 0
    v_mov_b32 v107, 0
    v_mov_b32 v108, 0
    v_mov_b32 v109, 0
    v_mov_b32 v110, 0
    v_mov_b32 v111, 0
    s_waitcnt vmcnt(2)
    s_barrier
    ds_read_b64_tr_b16 v[112:113], v224 offset:0
    ds_read_b64_tr_b16 v[114:115], v224 offset:2048
    ds_read_b64_tr_b16 v[116:117], v225 offset:0
    ds_read_b64_tr_b16 v[118:119], v225 offset:2048
    ds_read_b64_tr_b16 v[120:121], v224 offset:512
    ds_read_b64_tr_b16 v[122:123], v224 offset:2560
    ds_read_b64_tr_b16 v[124:125], v225 offset:512
    ds_read_b64_tr_b16 v[126:127], v225 offset:2560
    s_waitcnt lgkmcnt(6)
    v_mfma_f32_16x16x32_bf16 v[16:19], v[112:115], v[184:187], v[16:19]
    ds_read_b64_tr_b16 v[128:129], v224 offset:4096
    s_add_u32 m0, s38, 49152
    s_nop 0
    buffer_load_dwordx4 v246, s[32:35], s36 offen lds
    v_mfma_f32_16x16x32_bf16 v[20:23], v[112:115], v[188:191], v[20:23]
    ds_read_b64_tr_b16 v[130:131], v224 offset:6144
    s_waitcnt lgkmcnt(6)
    v_mfma_f32_16x16x32_bf16 v[24:27], v[116:119], v[184:187], v[24:27]
    ds_read_b64_tr_b16 v[132:133], v225 offset:4096
    s_add_u32 m0, s38, 57344
    s_nop 0
    buffer_load_dwordx4 v247, s[32:35], s40 offen lds
    v_mfma_f32_16x16x32_bf16 v[28:31], v[116:119], v[188:191], v[28:31]
    ds_read_b64_tr_b16 v[134:135], v225 offset:6144
    s_waitcnt lgkmcnt(6)
    v_mfma_f32_16x16x32_bf16 v[32:35], v[120:123], v[184:187], v[32:35]
    ds_read_b64_tr_b16 v[112:113], v224 offset:4608
    v_mfma_f32_16x16x32_bf16 v[36:39], v[120:123], v[188:191], v[36:39]
    ds_read_b64_tr_b16 v[114:115], v224 offset:6656
    s_waitcnt lgkmcnt(6)
    v_mfma_f32_16x16x32_bf16 v[40:43], v[124:127], v[184:187], v[40:43]
    ds_read_b64_tr_b16 v[116:117], v225 offset:4608
    s_add_u32 m0, s38, 65536
    s_nop 0
    buffer_load_dwordx4 v248, s[32:35], s39 offen lds
    v_readlane_b32 s36, v251, s41
    s_add_u32 s41, s41, 1
    v_readlane_b32 s39, v251, s41
    s_add_u32 s41, s41, 1
    s_cmp_lt_u32 s90, 4
    s_cselect_b32 s40, s36, s39
    v_mfma_f32_16x16x32_bf16 v[44:47], v[124:127], v[188:191], v[44:47]
    ds_read_b64_tr_b16 v[118:119], v225 offset:6656
    s_waitcnt lgkmcnt(6)
    v_mfma_f32_16x16x32_bf16 v[48:51], v[128:131], v[184:187], v[48:51]
    ds_read_b64_tr_b16 v[120:121], v224 offset:8192
    buffer_load_dwordx4 v[200:203], v9, s[4:7], s42 offen sc1
    v_mfma_f32_16x16x32_bf16 v[52:55], v[128:131], v[188:191], v[52:55]
    ds_read_b64_tr_b16 v[122:123], v224 offset:10240
    s_waitcnt lgkmcnt(6)
    v_mfma_f32_16x16x32_bf16 v[56:59], v[132:135], v[184:187], v[56:59]
    ds_read_b64_tr_b16 v[124:125], v225 offset:8192
    v_mfma_f32_16x16x32_bf16 v[60:63], v[132:135], v[188:191], v[60:63]
    ds_read_b64_tr_b16 v[126:127], v225 offset:10240
    s_waitcnt lgkmcnt(6)
    v_mfma_f32_16x16x32_bf16 v[64:67], v[112:115], v[184:187], v[64:67]
    ds_read_b64_tr_b16 v[128:129], v224 offset:8704
    buffer_load_dwordx4 v[204:207], v9, s[8:11], s42 offen sc1
    s_add_u32 s45, s45, 2
    v_readlane_b32 s42, v252, s45
    v_mfma_f32_16x16x32_bf16 v[68:71], v[112:115], v[188:191], v[68:71]
    ds_read_b64_tr_b16 v[130:131], v224 offset:10752
    s_waitcnt lgkmcnt(6)
    v_mfma_f32_16x16x32_bf16 v[72:75], v[116:119], v[184:187], v[72:75]
    ds_read_b64_tr_b16 v[132:133], v225 offset:8704
    s_add_u32 m0, s38, 73728
    s_nop 0
    buffer_load_dwordx4 v246, s[32:35], s36 offen lds
    v_mfma_f32_16x16x32_bf16 v[76:79], v[116:119], v[188:191], v[76:79]
    ds_read_b64_tr_b16 v[134:135], v225 offset:10752
    s_waitcnt lgkmcnt(6)
    v_mfma_f32_16x16x32_bf16 v[80:83], v[120:123], v[184:187], v[80:83]
    ds_read_b64_tr_b16 v[112:113], v224 offset:24576
    v_mfma_f32_16x16x32_bf16 v[84:87], v[120:123], v[188:191], v[84:87]
    ds_read_b64_tr_b16 v[114:115], v224 offset:26624
    s_waitcnt lgkmcnt(6)
    v_mfma_f32_16x16x32_bf16 v[88:91], v[124:127], v[184:187], v[88:91]
    ds_read_b64_tr_b16 v[116:117], v225 offset:24576
    s_add_u32 m0, s38, 81920
    s_nop 0
    buffer_load_dwordx4 v247, s[32:35], s40 offen lds
    v_mfma_f32_16x16x32_bf16 v[92:95], v[124:127], v[188:191], v[92:95]
    ds_read_b64_tr_b16 v[118:119], v225 offset:26624
    s_waitcnt lgkmcnt(6)
    v_mfma_f32_16x16x32_bf16 v[96:99], v[128:131], v[184:187], v[96:99]
    ds_read_b64_tr_b16 v[120:121], v224 offset:25088
    s_add_u32 m0, s38, 90112
    s_nop 0
    buffer_load_dwordx4 v248, s[32:35], s39 offen lds
    v_readlane_b32 s36, v251, s41
    s_add_u32 s41, s41, 1
    v_readlane_b32 s39, v251, s41
    s_add_u32 s41, s41, 1
    s_cmp_lt_u32 s90, 4
    s_cselect_b32 s40, s36, s39
    v_mfma_f32_16x16x32_bf16 v[100:103], v[128:131], v[188:191], v[100:103]
    ds_read_b64_tr_b16 v[122:123], v224 offset:27136
    s_waitcnt lgkmcnt(6)
    v_mfma_f32_16x16x32_bf16 v[104:107], v[132:135], v[184:187], v[104:107]
    ds_read_b64_tr_b16 v[124:125], v225 offset:25088
    v_mfma_f32_16x16x32_bf16 v[108:111], v[132:135], v[188:191], v[108:111]
    ds_read_b64_tr_b16 v[126:127], v225 offset:27136
    s_waitcnt vmcnt(5)
    s_barrier
    s_waitcnt lgkmcnt(6)
    v_mfma_f32_16x16x32_bf16 v[16:19], v[112:115], v[192:195], v[16:19]
    ds_read_b64_tr_b16 v[128:129], v224 offset:28672
    buffer_load_dwordx4 v[208:211], v9, s[4:7], s42 offen sc1
    v_mfma_f32_16x16x32_bf16 v[20:23], v[112:115], v[196:199], v[20:23]
    ds_read_b64_tr_b16 v[130:131], v224 offset:30720
    s_waitcnt lgkmcnt(6)
    v_mfma_f32_16x16x32_bf16 v[24:27], v[116:119], v[192:195], v[24:27]
    ds_read_b64_tr_b16 v[132:133], v225 offset:28672
    v_mfma_f32_16x16x32_bf16 v[28:31], v[116:119], v[196:199], v[28:31]
    ds_read_b64_tr_b16 v[134:135], v225 offset:30720
    s_waitcnt lgkmcnt(6)
    v_mfma_f32_16x16x32_bf16 v[32:35], v[120:123], v[192:195], v[32:35]
    ds_read_b64_tr_b16 v[112:113], v224 offset:29184
    buffer_load_dwordx4 v[212:215], v9, s[8:11], s42 offen sc1
    s_add_u32 s45, s45, 2
    v_readlane_b32 s42, v252, s45
    v_mfma_f32_16x16x32_bf16 v[36:39], v[120:123], v[196:199], v[36:39]
    ds_read_b64_tr_b16 v[114:115], v224 offset:31232
    s_waitcnt lgkmcnt(6)
    v_mfma_f32_16x16x32_bf16 v[40:43], v[124:127], v[192:195], v[40:43]
    ds_read_b64_tr_b16 v[116:117], v225 offset:29184
    v_mfma_f32_16x16x32_bf16 v[44:47], v[124:127], v[196:199], v[44:47]
    ds_read_b64_tr_b16 v[118:119], v225 offset:31232
    s_waitcnt lgkmcnt(6)
    v_mfma_f32_16x16x32_bf16 v[48:51], v[128:131], v[192:195], v[48:51]
    ds_read_b64_tr_b16 v[120:121], v224 offset:32768
    s_add_u32 m0, s38, 98304
    s_nop 0
    buffer_load_dwordx4 v246, s[32:35], s36 offen lds
    v_mfma_f32_16x16x32_bf16 v[52:55], v[128:131], v[196:199], v[52:55]
    ds_read_b64_tr_b16 v[122:123], v224 offset:34816
    s_waitcnt lgkmcnt(6)
    v_mfma_f32_16x16x32_bf16 v[56:59], v[132:135], v[192:195], v[56:59]
    ds_read_b64_tr_b16 v[124:125], v225 offset:32768
    v_mfma_f32_16x16x32_bf16 v[60:63], v[132:135], v[196:199], v[60:63]
    ds_read_b64_tr_b16 v[126:127], v225 offset:34816
    s_waitcnt lgkmcnt(6)
    v_mfma_f32_16x16x32_bf16 v[64:67], v[112:115], v[192:195], v[64:67]
    ds_read_b64_tr_b16 v[128:129], v224 offset:33280
    s_add_u32 m0, s38, 106496
    s_nop 0
    buffer_load_dwordx4 v247, s[32:35], s40 offen lds
    v_mfma_f32_16x16x32_bf16 v[68:71], v[112:115], v[196:199], v[68:71]
    ds_read_b64_tr_b16 v[130:131], v224 offset:35328
    s_waitcnt lgkmcnt(6)
    v_mfma_f32_16x16x32_bf16 v[72:75], v[116:119], v[192:195], v[72:75]
    ds_read_b64_tr_b16 v[132:133], v225 offset:33280
    v_mfma_f32_16x16x32_bf16 v[76:79], v[116:119], v[196:199], v[76:79]
    ds_read_b64_tr_b16 v[134:135], v225 offset:35328
    s_waitcnt lgkmcnt(6)
    v_mfma_f32_16x16x32_bf16 v[80:83], v[120:123], v[192:195], v[80:83]
    ds_read_b64_tr_b16 v[112:113], v226 offset:0
    s_add_u32 m0, s38, 114688
    s_nop 0
    buffer_load_dwordx4 v248, s[32:35], s39 offen lds
    v_readlane_b32 s36, v251, s41
    s_add_u32 s41, s41, 1
    v_readlane_b32 s39, v251, s41
    s_add_u32 s41, s41, 1
    s_cmp_lt_u32 s90, 4
    s_cselect_b32 s40, s36, s39
    v_mfma_f32_16x16x32_bf16 v[84:87], v[120:123], v[196:199], v[84:87]
    ds_read_b64_tr_b16 v[114:115], v226 offset:2048
    s_waitcnt lgkmcnt(6)
    v_mfma_f32_16x16x32_bf16 v[88:91], v[124:127], v[192:195], v[88:91]
    ds_read_b64_tr_b16 v[116:117], v227 offset:0
    v_mfma_f32_16x16x32_bf16 v[92:95], v[124:127], v[196:199], v[92:95]
    ds_read_b64_tr_b16 v[118:119], v227 offset:2048
    s_waitcnt lgkmcnt(6)
    v_mfma_f32_16x16x32_bf16 v[96:99], v[128:131], v[192:195], v[96:99]
    ds_read_b64_tr_b16 v[120:121], v226 offset:512
    buffer_load_dwordx4 v[216:219], v9, s[4:7], s42 offen sc1
    v_mfma_f32_16x16x32_bf16 v[100:103], v[128:131], v[196:199], v[100:103]
    ds_read_b64_tr_b16 v[122:123], v226 offset:2560
    s_waitcnt lgkmcnt(6)
    v_mfma_f32_16x16x32_bf16 v[104:107], v[132:135], v[192:195], v[104:107]
    ds_read_b64_tr_b16 v[124:125], v227 offset:512
    buffer_load_dwordx4 v[220:223], v9, s[8:11], s42 offen sc1
    s_add_u32 s45, s45, 2
    v_readlane_b32 s42, v252, s45
    v_mfma_f32_16x16x32_bf16 v[108:111], v[132:135], v[196:199], v[108:111]
    ds_read_b64_tr_b16 v[126:127], v227 offset:2560
    s_waitcnt vmcnt(7)
    v_mov_b32 v2, 163780
    v_mov_b32 v3, 1
    s_mov_b64 exec, 1
    ds_add_rtn_u32 v3, v2, v3
    s_waitcnt lgkmcnt(0)
    v_readfirstlane_b32 s59, v3
    s_nop 0
    s_mov_b64 exec, -1
    s_cmp_eq_u32 s59, 7
    s_cbranch_scc0 Lpub_61
    s_lshl_b32 s59, s95, 5
    s_add_u32 s59, s59, s94
    s_lshl_b32 s59, s59, 4
    s_add_u32 s59, s59, 236544
    v_mul_u32_u24 v2, 4224, v1
    v_add_u32 v2, s59, v2
    v_mov_b32 v3, s91
    s_mov_b64 exec, 0xff
    buffer_store_dword v3, v2, s[96:99], 0 offen sc1
    s_mov_b64 exec, -1
Lpub_61:
    s_barrier
    s_waitcnt lgkmcnt(6)
    v_mfma_f32_16x16x32_bf16 v[16:19], v[112:115], v[200:203], v[16:19]
    ds_read_b64_tr_b16 v[128:129], v226 offset:4096
    s_add_u32 m0, s38, 122880
    s_nop 0
    buffer_load_dwordx4 v246, s[32:35], s36 offen lds
    v_mfma_f32_16x16x32_bf16 v[20:23], v[112:115], v[204:207], v[20:23]
    ds_read_b64_tr_b16 v[130:131], v226 offset:6144
    s_waitcnt lgkmcnt(6)
    v_mfma_f32_16x16x32_bf16 v[24:27], v[116:119], v[200:203], v[24:27]
    ds_read_b64_tr_b16 v[132:133], v227 offset:4096
    s_add_u32 m0, s38, 131072
    s_nop 0
    buffer_load_dwordx4 v247, s[32:35], s40 offen lds
    v_mfma_f32_16x16x32_bf16 v[28:31], v[116:119], v[204:207], v[28:31]
    ds_read_b64_tr_b16 v[134:135], v227 offset:6144
    s_waitcnt lgkmcnt(6)
    v_mfma_f32_16x16x32_bf16 v[32:35], v[120:123], v[200:203], v[32:35]
    ds_read_b64_tr_b16 v[112:113], v226 offset:4608
    v_mfma_f32_16x16x32_bf16 v[36:39], v[120:123], v[204:207], v[36:39]
    ds_read_b64_tr_b16 v[114:115], v226 offset:6656
    s_waitcnt lgkmcnt(6)
    v_mfma_f32_16x16x32_bf16 v[40:43], v[124:127], v[200:203], v[40:43]
    ds_read_b64_tr_b16 v[116:117], v227 offset:4608
    s_add_u32 m0, s38, 139264
    s_nop 0
    buffer_load_dwordx4 v248, s[32:35], s39 offen lds
    v_readlane_b32 s36, v251, s41
    s_add_u32 s41, s41, 1
    v_readlane_b32 s39, v251, s41
    s_add_u32 s41, s41, 1
    s_cmp_lt_u32 s90, 4
    s_cselect_b32 s40, s36, s39
    v_mfma_f32_16x16x32_bf16 v[44:47], v[124:127], v[204:207], v[44:47]
    ds_read_b64_tr_b16 v[118:119], v227 offset:6656
    s_waitcnt lgkmcnt(6)
    v_mfma_f32_16x16x32_bf16 v[48:51], v[128:131], v[200:203], v[48:51]
    ds_read_b64_tr_b16 v[120:121], v226 offset:8192
    buffer_load_dwordx4 v[184:187], v9, s[4:7], s42 offen sc1
    v_mfma_f32_16x16x32_bf16 v[52:55], v[128:131], v[204:207], v[52:55]
    ds_read_b64_tr_b16 v[122:123], v226 offset:10240
    s_waitcnt lgkmcnt(6)
    v_mfma_f32_16x16x32_bf16 v[56:59], v[132:135], v[200:203], v[56:59]
    ds_read_b64_tr_b16 v[124:125], v227 offset:8192
    v_mfma_f32_16x16x32_bf16 v[60:63], v[132:135], v[204:207], v[60:63]
    ds_read_b64_tr_b16 v[126:127], v227 offset:10240
    s_waitcnt lgkmcnt(6)
    v_mfma_f32_16x16x32_bf16 v[64:67], v[112:115], v[200:203], v[64:67]
    ds_read_b64_tr_b16 v[128:129], v226 offset:8704
    buffer_load_dwordx4 v[188:191], v9, s[8:11], s42 offen sc1
    s_add_u32 s45, s45, 2
    v_readlane_b32 s42, v252, s45
    v_mfma_f32_16x16x32_bf16 v[68:71], v[112:115], v[204:207], v[68:71]
    ds_read_b64_tr_b16 v[130:131], v226 offset:10752
    s_waitcnt lgkmcnt(6)
    v_mfma_f32_16x16x32_bf16 v[72:75], v[116:119], v[200:203], v[72:75]
    ds_read_b64_tr_b16 v[132:133], v227 offset:8704
    s_add_u32 m0, s38, 0
    s_nop 0
    buffer_load_dwordx4 v246, s[32:35], s36 offen lds
    v_mfma_f32_16x16x32_bf16 v[76:79], v[116:119], v[204:207], v[76:79]
    ds_read_b64_tr_b16 v[134:135], v227 offset:10752
    s_waitcnt lgkmcnt(6)
    v_mfma_f32_16x16x32_bf16 v[80:83], v[120:123], v[200:203], v[80:83]
    ds_read_b64_tr_b16 v[112:113], v226 offset:24576
    v_mfma_f32_16x16x32_bf16 v[84:87], v[120:123], v[204:207], v[84:87]
    ds_read_b64_tr_b16 v[114:115], v226 offset:26624
    s_waitcnt lgkmcnt(6)
    v_mfma_f32_16x16x32_bf16 v[88:91], v[124:127], v[200:203], v[88:91]
    ds_read_b64_tr_b16 v[116:117], v227 offset:24576
    s_add_u32 m0, s38, 8192
    s_nop 0
    buffer_load_dwordx4 v247, s[32:35], s40 offen lds
    v_mfma_f32_16x16x32_bf16 v[92:95], v[124:127], v[204:207], v[92:95]
    ds_read_b64_tr_b16 v[118:119], v227 offset:26624
    s_waitcnt lgkmcnt(6)
    v_mfma_f32_16x16x32_bf16 v[96:99], v[128:131], v[200:203], v[96:99]
    ds_read_b64_tr_b16 v[120:121], v226 offset:25088
    s_add_u32 m0, s38, 16384
    s_nop 0
    buffer_load_dwordx4 v248, s[32:35], s39 offen lds
    v_readlane_b32 s36, v251, s41
    s_add_u32 s41, s41, 1
    v_readlane_b32 s39, v251, s41
    s_add_u32 s41, s41, 1
    s_cmp_lt_u32 s90, 4
    s_cselect_b32 s40, s36, s39
    v_mfma_f32_16x16x32_bf16 v[100:103], v[128:131], v[204:207], v[100:103]
    ds_read_b64_tr_b16 v[122:123], v226 offset:27136
    s_waitcnt lgkmcnt(6)
    v_mfma_f32_16x16x32_bf16 v[104:107], v[132:135], v[200:203], v[104:107]
    ds_read_b64_tr_b16 v[124:125], v227 offset:25088
    v_mfma_f32_16x16x32_bf16 v[108:111], v[132:135], v[204:207], v[108:111]
    ds_read_b64_tr_b16 v[126:127], v227 offset:27136
    s_waitcnt vmcnt(10)
    s_barrier
    s_waitcnt lgkmcnt(6)
    v_mfma_f32_16x16x32_bf16 v[16:19], v[112:115], v[208:211], v[16:19]
    ds_read_b64_tr_b16 v[128:129], v226 offset:28672
    buffer_load_dwordx4 v[192:195], v9, s[4:7], s42 offen sc1
    v_mfma_f32_16x16x32_bf16 v[20:23], v[112:115], v[212:215], v[20:23]
    ds_read_b64_tr_b16 v[130:131], v226 offset:30720
    s_waitcnt lgkmcnt(6)
    v_mfma_f32_16x16x32_bf16 v[24:27], v[116:119], v[208:211], v[24:27]
    ds_read_b64_tr_b16 v[132:133], v227 offset:28672
    buffer_load_dwordx4 v[196:199], v9, s[8:11], s42 offen sc1
    s_add_u32 s45, s45, 2
    v_readlane_b32 s42, v252, s45
    v_mfma_f32_16x16x32_bf16 v[28:31], v[116:119], v[212:215], v[28:31]
    ds_read_b64_tr_b16 v[134:135], v227 offset:30720
    s_waitcnt lgkmcnt(6)
    v_mfma_f32_16x16x32_bf16 v[32:35], v[120:123], v[208:211], v[32:35]
    ds_read_b64_tr_b16 v[112:113], v226 offset:29184
    v_mfma_f32_16x16x32_bf16 v[36:39], v[120:123], v[212:215], v[36:39]
    ds_read_b64_tr_b16 v[114:115], v226 offset:31232
    s_waitcnt lgkmcnt(6)
    v_mfma_f32_16x16x32_bf16 v[40:43], v[124:127], v[208:211], v[40:43]
    ds_read_b64_tr_b16 v[116:117], v227 offset:29184
    s_add_u32 m0, s38, 24576
    s_nop 0
    buffer_load_dwordx4 v246, s[32:35], s36 offen lds
    v_mfma_f32_16x16x32_bf16 v[44:47], v[124:127], v[212:215], v[44:47]
    ds_read_b64_tr_b16 v[118:119], v227 offset:31232
    s_waitcnt lgkmcnt(6)
    v_mfma_f32_16x16x32_bf16 v[48:51], v[128:131], v[208:211], v[48:51]
    ds_read_b64_tr_b16 v[120:121], v226 offset:32768
    s_add_u32 m0, s38, 32768
    s_nop 0
    buffer_load_dwordx4 v247, s[32:35], s40 offen lds
    v_mfma_f32_16x16x32_bf16 v[52:55], v[128:131], v[212:215], v[52:55]
    ds_read_b64_tr_b16 v[122:123], v226 offset:34816
    s_waitcnt lgkmcnt(6)
    v_mfma_f32_16x16x32_bf16 v[56:59], v[132:135], v[208:211], v[56:59]
    ds_read_b64_tr_b16 v[124:125], v227 offset:32768
    v_mfma_f32_16x16x32_bf16 v[60:63], v[132:135], v[212:215], v[60:63]
    ds_read_b64_tr_b16 v[126:127], v227 offset:34816
    s_waitcnt lgkmcnt(6)
    v_mfma_f32_16x16x32_bf16 v[64:67], v[112:115], v[208:211], v[64:67]
    ds_read_b64_tr_b16 v[128:129], v226 offset:33280
    s_add_u32 m0, s38, 40960
    s_nop 0
    buffer_load_dwordx4 v248, s[32:35], s39 offen lds
    v_readlane_b32 s36, v251, s41
    s_add_u32 s41, s41, 1
    v_readlane_b32 s39, v251, s41
    s_add_u32 s41, s41, 1
    s_cmp_lt_u32 s90, 4
    s_cselect_b32 s40, s36, s39
    v_mfma_f32_16x16x32_bf16 v[68:71], v[112:115], v[212:215], v[68:71]
    ds_read_b64_tr_b16 v[130:131], v226 offset:35328
    s_waitcnt lgkmcnt(6)
    v_mfma_f32_16x16x32_bf16 v[72:75], v[116:119], v[208:211], v[72:75]
    ds_read_b64_tr_b16 v[132:133], v227 offset:33280
    s_add_u32 m0, s38, 49152
    s_nop 0
    buffer_load_dwordx4 v246, s[32:35], s36 offen lds
    v_mfma_f32_16x16x32_bf16 v[76:79], v[116:119], v[212:215], v[76:79]
    ds_read_b64_tr_b16 v[134:135], v227 offset:35328
    s_waitcnt lgkmcnt(6)
    v_mfma_f32_16x16x32_bf16 v[80:83], v[120:123], v[208:211], v[80:83]
    ds_read_b64_tr_b16 v[112:113], v228 offset:0
    v_mfma_f32_16x16x32_bf16 v[84:87], v[120:123], v[212:215], v[84:87]
    ds_read_b64_tr_b16 v[114:115], v228 offset:2048
    s_waitcnt lgkmcnt(6)
    v_mfma_f32_16x16x32_bf16 v[88:91], v[124:127], v[208:211], v[88:91]
    ds_read_b64_tr_b16 v[116:117], v229 offset:0
    s_add_u32 m0, s38, 57344
    s_nop 0
    buffer_load_dwordx4 v247, s[32:35], s40 offen lds
    v_mfma_f32_16x16x32_bf16 v[92:95], v[124:127], v[212:215], v[92:95]
    ds_read_b64_tr_b16 v[118:119], v229 offset:2048
    s_waitcnt lgkmcnt(6)
    v_mfma_f32_16x16x32_bf16 v[96:99], v[128:131], v[208:211], v[96:99]
    ds_read_b64_tr_b16 v[120:121], v228 offset:512
    s_add_u32 m0, s38, 65536
    s_nop 0
    buffer_load_dwordx4 v248, s[32:35], s39 offen lds
    v_readlane_b32 s36, v251, s41
    s_add_u32 s41, s41, 1
    v_readlane_b32 s39, v251, s41
    s_add_u32 s41, s41, 1
    s_cmp_lt_u32 s90, 4
    s_cselect_b32 s40, s36, s39
    v_mfma_f32_16x16x32_bf16 v[100:103], v[128:131], v[212:215], v[100:103]
    ds_read_b64_tr_b16 v[122:123], v228 offset:2560
    s_waitcnt lgkmcnt(6)
    v_mfma_f32_16x16x32_bf16 v[104:107], v[132:135], v[208:211], v[104:107]
    ds_read_b64_tr_b16 v[124:125], v229 offset:512
    v_mfma_f32_16x16x32_bf16 v[108:111], v[132:135], v[212:215], v[108:111]
    ds_read_b64_tr_b16 v[126:127], v229 offset:2560
    s_cmp_eq_u32 s90, 7
    s_cbranch_scc0 Lq_62
    s_mul_i32 s52, s46, 13108
    s_lshr_b32 s52, s52, 16
    s_add_u32 s53, s46, s47
    s_sub_u32 s53, s53, 1
    s_mul_i32 s53, s53, 13108
    s_lshr_b32 s53, s53, 16
    s_sub_u32 s53, s53, s52
    s_add_u32 s53, s53, 1
    s_lshl_b32 s53, s53, 1
    s_lshl_b32 s52, s52, 1
    s_lshr_b32 s54, s65, 1
    s_lshl_b32 s54, s54, 5
    s_add_u32 s52, s52, s54
    s_and_b32 s88, s2, 7
    s_mul_i32 s88, s88, 4224
    s_add_u32 s88, s88, 236544
    s_lshl_b32 s60, s52, 4
    s_add_u32 s60, s60, s88
    v_lshlrev_b32 v2, 4, v1
    v_add_u32 v2, s60, v2
    v_cmp_gt_u32 vcc, s53, v1
    s_mov_b64 exec, vcc
    s_mov_b32 s61, 0
Lpoll_63:
    buffer_load_dword v3, v2, s[96:99], 0 offen sc1
    s_waitcnt vmcnt(0)
    v_cmp_ne_u32 vcc, s91, v3
    s_cmp_eq_u64 vcc, 0
    s_cbranch_scc1 Lpd_64
    s_add_u32 s61, s61, 1
    s_cmp_lt_u32 s61, s93
    s_cbranch_scc1 Lpoll_63
Lpd_64:
    s_mov_b64 exec, -1
Lq_62:
    s_waitcnt vmcnt(13)
    s_barrier
    s_waitcnt lgkmcnt(6)
    v_mfma_f32_16x16x32_bf16 v[16:19], v[112:115], v[216:219], v[16:19]
    ds_read_b64_tr_b16 v[128:129], v228 offset:4096
    buffer_load_dwordx4 v[200:203], v9, s[4:7], s42 offen sc1
    v_mfma_f32_16x16x32_bf16 v[20:23], v[112:115], v[220:223], v[20:23]
    ds_read_b64_tr_b16 v[130:131], v228 offset:6144
    s_waitcnt lgkmcnt(6)
    v_mfma_f32_16x16x32_bf16 v[24:27], v[116:119], v[216:219], v[24:27]
    ds_read_b64_tr_b16 v[132:133], v229 offset:4096
    v_mfma_f32_16x16x32_bf16 v[28:31], v[116:119], v[220:223], v[28:31]
    ds_read_b64_tr_b16 v[134:135], v229 offset:6144
    s_waitcnt lgkmcnt(6)
    v_mfma_f32_16x16x32_bf16 v[32:35], v[120:123], v[216:219], v[32:35]
    ds_read_b64_tr_b16 v[112:113], v228 offset:4608
    buffer_load_dwordx4 v[204:207], v9, s[8:11], s42 offen sc1
    s_add_u32 s45, s45, 2
    v_readlane_b32 s42, v252, s45
    v_mfma_f32_16x16x32_bf16 v[36:39], v[120:123], v[220:223], v[36:39]
    ds_read_b64_tr_b16 v[114:115], v228 offset:6656
    s_waitcnt lgkmcnt(6)
    v_mfma_f32_16x16x32_bf16 v[40:43], v[124:127], v[216:219], v[40:43]
    ds_read_b64_tr_b16 v[116:117], v229 offset:4608
    v_mfma_f32_16x16x32_bf16 v[44:47], v[124:127], v[220:223], v[44:47]
    ds_read_b64_tr_b16 v[118:119], v229 offset:6656
    s_waitcnt lgkmcnt(6)
    v_mfma_f32_16x16x32_bf16 v[48:51], v[128:131], v[216:219], v[48:51]
    ds_read_b64_tr_b16 v[120:121], v228 offset:8192
    buffer_load_dwordx4 v[208:211], v9, s[4:7], s42 offen sc1
    v_mfma_f32_16x16x32_bf16 v[52:55], v[128:131], v[220:223], v[52:55]
    ds_read_b64_tr_b16 v[122:123], v228 offset:10240
    s_waitcnt lgkmcnt(6)
    v_mfma_f32_16x16x32_bf16 v[56:59], v[132:135], v[216:219], v[56:59]
    ds_read_b64_tr_b16 v[124:125], v229 offset:8192
    v_mfma_f32_16x16x32_bf16 v[60:63], v[132:135], v[220:223], v[60:63]
    ds_read_b64_tr_b16 v[126:127], v229 offset:10240
    s_waitcnt lgkmcnt(6)
    v_mfma_f32_16x16x32_bf16 v[64:67], v[112:115], v[216:219], v[64:67]
    ds_read_b64_tr_b16 v[128:129], v228 offset:8704
    buffer_load_dwordx4 v[212:215], v9, s[8:11], s42 offen sc1
    s_add_u32 s45, s45, 2
    v_readlane_b32 s42, v252, s45
    v_mfma_f32_16x16x32_bf16 v[68:71], v[112:115], v[220:223], v[68:71]
    ds_read_b64_tr_b16 v[130:131], v228 offset:10752
    s_waitcnt lgkmcnt(6)
    v_mfma_f32_16x16x32_bf16 v[72:75], v[116:119], v[216:219], v[72:75]
    ds_read_b64_tr_b16 v[132:133], v229 offset:8704
    v_mfma_f32_16x16x32_bf16 v[76:79], v[116:119], v[220:223], v[76:79]
    ds_read_b64_tr_b16 v[134:135], v229 offset:10752
    s_waitcnt lgkmcnt(6)
    v_mfma_f32_16x16x32_bf16 v[80:83], v[120:123], v[216:219], v[80:83]
    ds_read_b64_tr_b16 v[112:113], v228 offset:24576
    s_add_u32 m0, s38, 73728
    s_nop 0
    buffer_load_dwordx4 v246, s[32:35], s36 offen lds
    v_mfma_f32_16x16x32_bf16 v[84:87], v[120:123], v[220:223], v[84:87]
    ds_read_b64_tr_b16 v[114:115], v228 offset:26624
    s_waitcnt lgkmcnt(6)
    v_mfma_f32_16x16x32_bf16 v[88:91], v[124:127], v[216:219], v[88:91]
    ds_read_b64_tr_b16 v[116:117], v229 offset:24576
    v_mfma_f32_16x16x32_bf16 v[92:95], v[124:127], v[220:223], v[92:95]
    ds_read_b64_tr_b16 v[118:119], v229 offset:26624
    s_waitcnt lgkmcnt(6)
    v_mfma_f32_16x16x32_bf16 v[96:99], v[128:131], v[216:219], v[96:99]
    ds_read_b64_tr_b16 v[120:121], v228 offset:25088
    s_add_u32 m0, s38, 81920
    s_nop 0
    buffer_load_dwordx4 v247, s[32:35], s40 offen lds
    v_mfma_f32_16x16x32_bf16 v[100:103], v[128:131], v[220:223], v[100:103]
    ds_read_b64_tr_b16 v[122:123], v228 offset:27136
    s_waitcnt lgkmcnt(6)
    v_mfma_f32_16x16x32_bf16 v[104:107], v[132:135], v[216:219], v[104:107]
    ds_read_b64_tr_b16 v[124:125], v229 offset:25088
    s_add_u32 m0, s38, 90112
    s_nop 0
    buffer_load_dwordx4 v248, s[32:35], s39 offen lds
    v_readlane_b32 s36, v251, s41
    s_add_u32 s41, s41, 1
    v_readlane_b32 s39, v251, s41
    s_add_u32 s41, s41, 1
    s_cmp_lt_u32 s90, 4
    s_cselect_b32 s40, s36, s39
    v_mfma_f32_16x16x32_bf16 v[108:111], v[132:135], v[220:223], v[108:111]
    ds_read_b64_tr_b16 v[126:127], v229 offset:27136
    s_waitcnt vmcnt(15)
    s_barrier
    s_waitcnt lgkmcnt(6)
    v_mfma_f32_16x16x32_bf16 v[16:19], v[112:115], v[184:187], v[16:19]
    ds_read_b64_tr_b16 v[128:129], v228 offset:28672
    buffer_load_dwordx4 v[216:219], v9, s[4:7], s42 offen sc1
    v_mfma_f32_16x16x32_bf16 v[20:23], v[112:115], v[188:191], v[20:23]
    ds_read_b64_tr_b16 v[130:131], v228 offset:30720
    s_waitcnt lgkmcnt(6)
    v_mfma_f32_16x16x32_bf16 v[24:27], v[116:119], v[184:187], v[24:27]
    ds_read_b64_tr_b16 v[132:133], v229 offset:28672
    v_mfma_f32_16x16x32_bf16 v[28:31], v[116:119], v[188:191], v[28:31]
    ds_read_b64_tr_b16 v[134:135], v229 offset:30720
    s_waitcnt lgkmcnt(6)
    v_mfma_f32_16x16x32_bf16 v[32:35], v[120:123], v[184:187], v[32:35]
    ds_read_b64_tr_b16 v[112:113], v228 offset:29184
    buffer_load_dwordx4 v[220:223], v9, s[8:11], s42 offen sc1
    s_add_u32 s45, s45, 2
    v_readlane_b32 s42, v252, s45
    v_mfma_f32_16x16x32_bf16 v[36:39], v[120:123], v[188:191], v[36:39]
    ds_read_b64_tr_b16 v[114:115], v228 offset:31232
    s_waitcnt lgkmcnt(6)
    v_mfma_f32_16x16x32_bf16 v[40:43], v[124:127], v[184:187], v[40:43]
    ds_read_b64_tr_b16 v[116:117], v229 offset:29184
    v_mfma_f32_16x16x32_bf16 v[44:47], v[124:127], v[188:191], v[44:47]
    ds_read_b64_tr_b16 v[118:119], v229 offset:31232
    s_waitcnt lgkmcnt(6)
    v_mfma_f32_16x16x32_bf16 v[48:51], v[128:131], v[184:187], v[48:51]
    ds_read_b64_tr_b16 v[120:121], v228 offset:32768
    s_add_u32 m0, s38, 98304
    s_nop 0
    buffer_load_dwordx4 v246, s[32:35], s36 offen lds
    v_mfma_f32_16x16x32_bf16 v[52:55], v[128:131], v[188:191], v[52:55]
    ds_read_b64_tr_b16 v[122:123], v228 offset:34816
    s_waitcnt lgkmcnt(6)
    v_mfma_f32_16x16x32_bf16 v[56:59], v[132:135], v[184:187], v[56:59]
    ds_read_b64_tr_b16 v[124:125], v229 offset:32768
    v_mfma_f32_16x16x32_bf16 v[60:63], v[132:135], v[188:191], v[60:63]
    ds_read_b64_tr_b16 v[126:127], v229 offset:34816
    s_waitcnt lgkmcnt(6)
    v_mfma_f32_16x16x32_bf16 v[64:67], v[112:115], v[184:187], v[64:67]
    ds_read_b64_tr_b16 v[128:129], v228 offset:33280
    s_add_u32 m0, s38, 106496
    s_nop 0
    buffer_load_dwordx4 v247, s[32:35], s40 offen lds
    v_mfma_f32_16x16x32_bf16 v[68:71], v[112:115], v[188:191], v[68:71]
    ds_read_b64_tr_b16 v[130:131], v228 offset:35328
    s_waitcnt lgkmcnt(6)
    v_mfma_f32_16x16x32_bf16 v[72:75], v[116:119], v[184:187], v[72:75]
    ds_read_b64_tr_b16 v[132:133], v229 offset:33280
    v_mfma_f32_16x16x32_bf16 v[76:79], v[116:119], v[188:191], v[76:79]
    ds_read_b64_tr_b16 v[134:135], v229 offset:35328
    s_waitcnt lgkmcnt(6)
    v_mfma_f32_16x16x32_bf16 v[80:83], v[120:123], v[184:187], v[80:83]
    ds_read_b64_tr_b16 v[112:113], v224 offset:0
    s_add_u32 m0, s38, 114688
    s_nop 0
    buffer_load_dwordx4 v248, s[32:35], s39 offen lds
    v_readlane_b32 s36, v251, s41
    s_add_u32 s41, s41, 1
    v_readlane_b32 s39, v251, s41
    s_add_u32 s41, s41, 1
    s_cmp_lt_u32 s90, 4
    s_cselect_b32 s40, s36, s39
    v_mfma_f32_16x16x32_bf16 v[84:87], v[120:123], v[188:191], v[84:87]
    ds_read_b64_tr_b16 v[114:115], v224 offset:2048
    s_waitcnt lgkmcnt(6)
    v_mfma_f32_16x16x32_bf16 v[88:91], v[124:127], v[184:187], v[88:91]
    ds_read_b64_tr_b16 v[116:117], v225 offset:0
    v_mfma_f32_16x16x32_bf16 v[92:95], v[124:127], v[188:191], v[92:95]
    ds_read_b64_tr_b16 v[118:119], v225 offset:2048
    s_waitcnt lgkmcnt(6)
    v_mfma_f32_16x16x32_bf16 v[96:99], v[128:131], v[184:187], v[96:99]
    ds_read_b64_tr_b16 v[120:121], v224 offset:512
    v_mfma_f32_16x16x32_bf16 v[100:103], v[128:131], v[188:191], v[100:103]
    ds_read_b64_tr_b16 v[122:123], v224 offset:2560
    s_waitcnt lgkmcnt(6)
    v_mfma_f32_16x16x32_bf16 v[104:107], v[132:135], v[184:187], v[104:107]
    ds_read_b64_tr_b16 v[124:125], v225 offset:512
    v_mfma_f32_16x16x32_bf16 v[108:111], v[132:135], v[188:191], v[108:111]
    ds_read_b64_tr_b16 v[126:127], v225 offset:2560
    s_waitcnt vmcnt(15)
    s_barrier
    s_waitcnt lgkmcnt(6)
    v_mfma_f32_16x16x32_bf16 v[16:19], v[112:115], v[192:195], v[16:19]
    ds_read_b64_tr_b16 v[128:129], v224 offset:4096
    buffer_load_dwordx4 v[184:187], v9, s[4:7], s42 offen sc1
    v_mfma_f32_16x16x32_bf16 v[20:23], v[112:115], v[196:199], v[20:23]
    ds_read_b64_tr_b16 v[130:131], v224 offset:6144
    s_waitcnt lgkmcnt(6)
    v_mfma_f32_16x16x32_bf16 v[24:27], v[116:119], v[192:195], v[24:27]
    ds_read_b64_tr_b16 v[132:133], v225 offset:4096
    v_mfma_f32_16x16x32_bf16 v[28:31], v[116:119], v[196:199], v[28:31]
    ds_read_b64_tr_b16 v[134:135], v225 offset:6144
    s_waitcnt lgkmcnt(6)
    v_mfma_f32_16x16x32_bf16 v[32:35], v[120:123], v[192:195], v[32:35]
    ds_read_b64_tr_b16 v[112:113], v224 offset:4608
    buffer_load_dwordx4 v[188:191], v9, s[8:11], s42 offen sc1
    s_add_u32 s45, s45, 2
    v_readlane_b32 s42, v252, s45
    v_mfma_f32_16x16x32_bf16 v[36:39], v[120:123], v[196:199], v[36:39]
    ds_read_b64_tr_b16 v[114:115], v224 offset:6656
    s_waitcnt lgkmcnt(6)
    v_mfma_f32_16x16x32_bf16 v[40:43], v[124:127], v[192:195], v[40:43]
    ds_read_b64_tr_b16 v[116:117], v225 offset:4608
    v_mfma_f32_16x16x32_bf16 v[44:47], v[124:127], v[196:199], v[44:47]
    ds_read_b64_tr_b16 v[118:119], v225 offset:6656
    s_waitcnt lgkmcnt(6)
    v_mfma_f32_16x16x32_bf16 v[48:51], v[128:131], v[192:195], v[48:51]
    ds_read_b64_tr_b16 v[120:121], v224 offset:8192
    s_add_u32 m0, s38, 122880
    s_nop 0
    buffer_load_dwordx4 v246, s[32:35], s36 offen lds
    v_mfma_f32_16x16x32_bf16 v[52:55], v[128:131], v[196:199], v[52:55]
    ds_read_b64_tr_b16 v[122:123], v224 offset:10240
    s_waitcnt lgkmcnt(6)
    v_mfma_f32_16x16x32_bf16 v[56:59], v[132:135], v[192:195], v[56:59]
    ds_read_b64_tr_b16 v[124:125], v225 offset:8192
    v_mfma_f32_16x16x32_bf16 v[60:63], v[132:135], v[196:199], v[60:63]
    ds_read_b64_tr_b16 v[126:127], v225 offset:10240
    s_waitcnt lgkmcnt(6)
    v_mfma_f32_16x16x32_bf16 v[64:67], v[112:115], v[192:195], v[64:67]
    ds_read_b64_tr_b16 v[128:129], v224 offset:8704
    s_add_u32 m0, s38, 131072
    s_nop 0
    buffer_load_dwordx4 v247, s[32:35], s40 offen lds
    v_mfma_f32_16x16x32_bf16 v[68:71], v[112:115], v[196:199], v[68:71]
    ds_read_b64_tr_b16 v[130:131], v224 offset:10752
    s_waitcnt lgkmcnt(6)
    v_mfma_f32_16x16x32_bf16 v[72:75], v[116:119], v[192:195], v[72:75]
    ds_read_b64_tr_b16 v[132:133], v225 offset:8704
    v_mfma_f32_16x16x32_bf16 v[76:79], v[116:119], v[196:199], v[76:79]
    ds_read_b64_tr_b16 v[134:135], v225 offset:10752
    s_waitcnt lgkmcnt(6)
    v_mfma_f32_16x16x32_bf16 v[80:83], v[120:123], v[192:195], v[80:83]
    ds_read_b64_tr_b16 v[112:113], v224 offset:24576
    s_add_u32 m0, s38, 139264
    s_nop 0
    buffer_load_dwordx4 v248, s[32:35], s39 offen lds
    v_readlane_b32 s36, v251, s41
    s_add_u32 s41, s41, 1
    v_readlane_b32 s39, v251, s41
    s_add_u32 s41, s41, 1
    s_cmp_lt_u32 s90, 4
    s_cselect_b32 s40, s36, s39
    v_mfma_f32_16x16x32_bf16 v[84:87], v[120:123], v[196:199], v[84:87]
    ds_read_b64_tr_b16 v[114:115], v224 offset:26624
    s_waitcnt lgkmcnt(6)
    v_mfma_f32_16x16x32_bf16 v[88:91], v[124:127], v[192:195], v[88:91]
    ds_read_b64_tr_b16 v[116:117], v225 offset:24576
    v_mfma_f32_16x16x32_bf16 v[92:95], v[124:127], v[196:199], v[92:95]
    ds_read_b64_tr_b16 v[118:119], v225 offset:26624
    s_waitcnt lgkmcnt(6)
    v_mfma_f32_16x16x32_bf16 v[96:99], v[128:131], v[192:195], v[96:99]
    ds_read_b64_tr_b16 v[120:121], v224 offset:25088
    v_mfma_f32_16x16x32_bf16 v[100:103], v[128:131], v[196:199], v[100:103]
    ds_read_b64_tr_b16 v[122:123], v224 offset:27136
    s_waitcnt lgkmcnt(6)
    v_mfma_f32_16x16x32_bf16 v[104:107], v[132:135], v[192:195], v[104:107]
    ds_read_b64_tr_b16 v[124:125], v225 offset:25088
    v_mfma_f32_16x16x32_bf16 v[108:111], v[132:135], v[196:199], v[108:111]
    ds_read_b64_tr_b16 v[126:127], v225 offset:27136
    s_waitcnt vmcnt(15)
    s_barrier
    s_waitcnt lgkmcnt(6)
    v_mfma_f32_16x16x32_bf16 v[16:19], v[112:115], v[200:203], v[16:19]
    ds_read_b64_tr_b16 v[128:129], v224 offset:28672
    buffer_load_dwordx4 v[192:195], v9, s[4:7], s42 offen sc1
    v_mfma_f32_16x16x32_bf16 v[20:23], v[112:115], v[204:207], v[20:23]
    ds_read_b64_tr_b16 v[130:131], v224 offset:30720
    s_waitcnt lgkmcnt(6)
    v_mfma_f32_16x16x32_bf16 v[24:27], v[116:119], v[200:203], v[24:27]
    ds_read_b64_tr_b16 v[132:133], v225 offset:28672
    v_mfma_f32_16x16x32_bf16 v[28:31], v[116:119], v[204:207], v[28:31]
    ds_read_b64_tr_b16 v[134:135], v225 offset:30720
    s_waitcnt lgkmcnt(6)
    v_mfma_f32_16x16x32_bf16 v[32:35], v[120:123], v[200:203], v[32:35]
    ds_read_b64_tr_b16 v[112:113], v224 offset:29184
    buffer_load_dwordx4 v[196:199], v9, s[8:11], s42 offen sc1
    s_add_u32 s45, s45, 2
    v_readlane_b32 s42, v252, s45
    v_mfma_f32_16x16x32_bf16 v[36:39], v[120:123], v[204:207], v[36:39]
    ds_read_b64_tr_b16 v[114:115], v224 offset:31232
    s_waitcnt lgkmcnt(6)
    v_mfma_f32_16x16x32_bf16 v[40:43], v[124:127], v[200:203], v[40:43]
    ds_read_b64_tr_b16 v[116:117], v225 offset:29184
    v_mfma_f32_16x16x32_bf16 v[44:47], v[124:127], v[204:207], v[44:47]
    ds_read_b64_tr_b16 v[118:119], v225 offset:31232
    s_waitcnt lgkmcnt(6)
    v_mfma_f32_16x16x32_bf16 v[48:51], v[128:131], v[200:203], v[48:51]
    ds_read_b64_tr_b16 v[120:121], v224 offset:32768
    s_add_u32 m0, s38, 0
    s_nop 0
    buffer_load_dwordx4 v246, s[32:35], s36 offen lds
    v_mfma_f32_16x16x32_bf16 v[52:55], v[128:131], v[204:207], v[52:55]
    ds_read_b64_tr_b16 v[122:123], v224 offset:34816
    s_waitcnt lgkmcnt(6)
    v_mfma_f32_16x16x32_bf16 v[56:59], v[132:135], v[200:203], v[56:59]
    ds_read_b64_tr_b16 v[124:125], v225 offset:32768
    v_mfma_f32_16x16x32_bf16 v[60:63], v[132:135], v[204:207], v[60:63]
    ds_read_b64_tr_b16 v[126:127], v225 offset:34816
    s_waitcnt lgkmcnt(6)
    v_mfma_f32_16x16x32_bf16 v[64:67], v[112:115], v[200:203], v[64:67]
    ds_read_b64_tr_b16 v[128:129], v224 offset:33280
    s_add_u32 m0, s38, 8192
    s_nop 0
    buffer_load_dwordx4 v247, s[32:35], s40 offen lds
    v_mfma_f32_16x16x32_bf16 v[68:71], v[112:115], v[204:207], v[68:71]
    ds_read_b64_tr_b16 v[130:131], v224 offset:35328
    s_waitcnt lgkmcnt(6)
    v_mfma_f32_16x16x32_bf16 v[72:75], v[116:119], v[200:203], v[72:75]
    ds_read_b64_tr_b16 v[132:133], v225 offset:33280
    v_mfma_f32_16x16x32_bf16 v[76:79], v[116:119], v[204:207], v[76:79]
    ds_read_b64_tr_b16 v[134:135], v225 offset:35328
    s_waitcnt lgkmcnt(6)
    v_mfma_f32_16x16x32_bf16 v[80:83], v[120:123], v[200:203], v[80:83]
    ds_read_b64_tr_b16 v[112:113], v226 offset:0
    s_add_u32 m0, s38, 16384
    s_nop 0
    buffer_load_dwordx4 v248, s[32:35], s39 offen lds
    v_readlane_b32 s36, v251, s41
    s_add_u32 s41, s41, 1
    v_readlane_b32 s39, v251, s41
    s_add_u32 s41, s41, 1
    s_cmp_lt_u32 s90, 4
    s_cselect_b32 s40, s36, s39
    v_mfma_f32_16x16x32_bf16 v[84:87], v[120:123], v[204:207], v[84:87]
    ds_read_b64_tr_b16 v[114:115], v226 offset:2048
    s_waitcnt lgkmcnt(6)
    v_mfma_f32_16x16x32_bf16 v[88:91], v[124:127], v[200:203], v[88:91]
    ds_read_b64_tr_b16 v[116:117], v227 offset:0
    v_mfma_f32_16x16x32_bf16 v[92:95], v[124:127], v[204:207], v[92:95]
    ds_read_b64_tr_b16 v[118:119], v227 offset:2048
    s_waitcnt lgkmcnt(6)
    v_mfma_f32_16x16x32_bf16 v[96:99], v[128:131], v[200:203], v[96:99]
    ds_read_b64_tr_b16 v[120:121], v226 offset:512
    v_mfma_f32_16x16x32_bf16 v[100:103], v[128:131], v[204:207], v[100:103]
    ds_read_b64_tr_b16 v[122:123], v226 offset:2560
    s_waitcnt lgkmcnt(6)
    v_mfma_f32_16x16x32_bf16 v[104:107], v[132:135], v[200:203], v[104:107]
    ds_read_b64_tr_b16 v[124:125], v227 offset:512
    v_mfma_f32_16x16x32_bf16 v[108:111], v[132:135], v[204:207], v[108:111]
    ds_read_b64_tr_b16 v[126:127], v227 offset:2560
    s_waitcnt vmcnt(15)
    s_barrier
    s_waitcnt lgkmcnt(6)
    v_mfma_f32_16x16x32_bf16 v[16:19], v[112:115], v[208:211], v[16:19]
    ds_read_b64_tr_b16 v[128:129], v226 offset:4096
    buffer_load_dwordx4 v[200:203], v9, s[4:7], s42 offen sc1
    v_mfma_f32_16x16x32_bf16 v[20:23], v[112:115], v[212:215], v[20:23]
    ds_read_b64_tr_b16 v[130:131], v226 offset:6144
    s_waitcnt lgkmcnt(6)
    v_mfma_f32_16x16x32_bf16 v[24:27], v[116:119], v[208:211], v[24:27]
    ds_read_b64_tr_b16 v[132:133], v227 offset:4096
    v_mfma_f32_16x16x32_bf16 v[28:31], v[116:119], v[212:215], v[28:31]
    ds_read_b64_tr_b16 v[134:135], v227 offset:6144
    s_waitcnt lgkmcnt(6)
    v_mfma_f32_16x16x32_bf16 v[32:35], v[120:123], v[208:211], v[32:35]
    ds_read_b64_tr_b16 v[112:113], v226 offset:4608
    buffer_load_dwordx4 v[204:207], v9, s[8:11], s42 offen sc1
    s_add_u32 s45, s45, 2
    v_readlane_b32 s42, v252, s45
    v_mfma_f32_16x16x32_bf16 v[36:39], v[120:123], v[212:215], v[36:39]
    ds_read_b64_tr_b16 v[114:115], v226 offset:6656
    s_waitcnt lgkmcnt(6)
    v_mfma_f32_16x16x32_bf16 v[40:43], v[124:127], v[208:211], v[40:43]
    ds_read_b64_tr_b16 v[116:117], v227 offset:4608
    v_mfma_f32_16x16x32_bf16 v[44:47], v[124:127], v[212:215], v[44:47]
    ds_read_b64_tr_b16 v[118:119], v227 offset:6656
    s_waitcnt lgkmcnt(6)
    v_mfma_f32_16x16x32_bf16 v[48:51], v[128:131], v[208:211], v[48:51]
    ds_read_b64_tr_b16 v[120:121], v226 offset:8192
    s_add_u32 m0, s38, 24576
    s_nop 0
    buffer_load_dwordx4 v246, s[32:35], s36 offen lds
    v_mfma_f32_16x16x32_bf16 v[52:55], v[128:131], v[212:215], v[52:55]
    ds_read_b64_tr_b16 v[122:123], v226 offset:10240
    s_waitcnt lgkmcnt(6)
    v_mfma_f32_16x16x32_bf16 v[56:59], v[132:135], v[208:211], v[56:59]
    ds_read_b64_tr_b16 v[124:125], v227 offset:8192
    v_mfma_f32_16x16x32_bf16 v[60:63], v[132:135], v[212:215], v[60:63]
    ds_read_b64_tr_b16 v[126:127], v227 offset:10240
    s_waitcnt lgkmcnt(6)
    v_mfma_f32_16x16x32_bf16 v[64:67], v[112:115], v[208:211], v[64:67]
    ds_read_b64_tr_b16 v[128:129], v226 offset:8704
    s_add_u32 m0, s38, 32768
    s_nop 0
    buffer_load_dwordx4 v247, s[32:35], s40 offen lds
    v_mfma_f32_16x16x32_bf16 v[68:71], v[112:115], v[212:215], v[68:71]
    ds_read_b64_tr_b16 v[130:131], v226 offset:10752
    s_waitcnt lgkmcnt(6)
    v_mfma_f32_16x16x32_bf16 v[72:75], v[116:119], v[208:211], v[72:75]
    ds_read_b64_tr_b16 v[132:133], v227 offset:8704
    v_mfma_f32_16x16x32_bf16 v[76:79], v[116:119], v[212:215], v[76:79]
    ds_read_b64_tr_b16 v[134:135], v227 offset:10752
    s_waitcnt lgkmcnt(6)
    v_mfma_f32_16x16x32_bf16 v[80:83], v[120:123], v[208:211], v[80:83]
    ds_read_b64_tr_b16 v[112:113], v226 offset:24576
    s_add_u32 m0, s38, 40960
    s_nop 0
    buffer_load_dwordx4 v248, s[32:35], s39 offen lds
    v_readlane_b32 s36, v251, s41
    s_add_u32 s41, s41, 1
    v_readlane_b32 s39, v251, s41
    s_add_u32 s41, s41, 1
    s_cmp_lt_u32 s90, 4
    s_cselect_b32 s40, s36, s39
    v_mfma_f32_16x16x32_bf16 v[84:87], v[120:123], v[212:215], v[84:87]
    ds_read_b64_tr_b16 v[114:115], v226 offset:26624
    s_waitcnt lgkmcnt(6)
    v_mfma_f32_16x16x32_bf16 v[88:91], v[124:127], v[208:211], v[88:91]
    ds_read_b64_tr_b16 v[116:117], v227 offset:24576
    v_mfma_f32_16x16x32_bf16 v[92:95], v[124:127], v[212:215], v[92:95]
    ds_read_b64_tr_b16 v[118:119], v227 offset:26624
    s_waitcnt lgkmcnt(6)
    v_mfma_f32_16x16x32_bf16 v[96:99], v[128:131], v[208:211], v[96:99]
    ds_read_b64_tr_b16 v[120:121], v226 offset:25088
    v_mfma_f32_16x16x32_bf16 v[100:103], v[128:131], v[212:215], v[100:103]
    ds_read_b64_tr_b16 v[122:123], v226 offset:27136
    s_waitcnt lgkmcnt(6)
    v_mfma_f32_16x16x32_bf16 v[104:107], v[132:135], v[208:211], v[104:107]
    ds_read_b64_tr_b16 v[124:125], v227 offset:25088
    v_mfma_f32_16x16x32_bf16 v[108:111], v[132:135], v[212:215], v[108:111]
    ds_read_b64_tr_b16 v[126:127], v227 offset:27136
    s_waitcnt vmcnt(15)
    s_barrier
    s_waitcnt lgkmcnt(6)
    v_mfma_f32_16x16x32_bf16 v[16:19], v[112:115], v[216:219], v[16:19]
    ds_read_b64_tr_b16 v[128:129], v226 offset:28672
    buffer_load_dwordx4 v[208:211], v9, s[4:7], s42 offen sc1
    v_mfma_f32_16x16x32_bf16 v[20:23], v[112:115], v[220:223], v[20:23]
    ds_read_b64_tr_b16 v[130:131], v226 offset:30720
    s_waitcnt lgkmcnt(6)
    v_mfma_f32_16x16x32_bf16 v[24:27], v[116:119], v[216:219], v[24:27]
    ds_read_b64_tr_b16 v[132:133], v227 offset:28672
    v_mfma_f32_16x16x32_bf16 v[28:31], v[116:119], v[220:223], v[28:31]
    ds_read_b64_tr_b16 v[134:135], v227 offset:30720
    s_waitcnt lgkmcnt(6)
    v_mfma_f32_16x16x32_bf16 v[32:35], v[120:123], v[216:219], v[32:35]
    ds_read_b64_tr_b16 v[112:113], v226 offset:29184
    buffer_load_dwordx4 v[212:215], v9, s[8:11], s42 offen sc1
    s_add_u32 s45, s45, 2
    v_readlane_b32 s42, v252, s45
    v_mfma_f32_16x16x32_bf16 v[36:39], v[120:123], v[220:223], v[36:39]
    ds_read_b64_tr_b16 v[114:115], v226 offset:31232
    s_waitcnt lgkmcnt(6)
    v_mfma_f32_16x16x32_bf16 v[40:43], v[124:127], v[216:219], v[40:43]
    ds_read_b64_tr_b16 v[116:117], v227 offset:29184
    v_mfma_f32_16x16x32_bf16 v[44:47], v[124:127], v[220:223], v[44:47]
    ds_read_b64_tr_b16 v[118:119], v227 offset:31232
    s_waitcnt lgkmcnt(6)
    v_mfma_f32_16x16x32_bf16 v[48:51], v[128:131], v[216:219], v[48:51]
    ds_read_b64_tr_b16 v[120:121], v226 offset:32768
    s_add_u32 m0, s38, 49152
    s_nop 0
    buffer_load_dwordx4 v246, s[32:35], s36 offen lds
    v_mfma_f32_16x16x32_bf16 v[52:55], v[128:131], v[220:223], v[52:55]
    ds_read_b64_tr_b16 v[122:123], v226 offset:34816
    s_waitcnt lgkmcnt(6)
    v_mfma_f32_16x16x32_bf16 v[56:59], v[132:135], v[216:219], v[56:59]
    ds_read_b64_tr_b16 v[124:125], v227 offset:32768
    v_mfma_f32_16x16x32_bf16 v[60:63], v[132:135], v[220:223], v[60:63]
    ds_read_b64_tr_b16 v[126:127], v227 offset:34816
    s_waitcnt lgkmcnt(6)
    v_mfma_f32_16x16x32_bf16 v[64:67], v[112:115], v[216:219], v[64:67]
    ds_read_b64_tr_b16 v[128:129], v226 offset:33280
    s_add_u32 m0, s38, 57344
    s_nop 0
    buffer_load_dwordx4 v247, s[32:35], s40 offen lds
    v_mfma_f32_16x16x32_bf16 v[68:71], v[112:115], v[220:223], v[68:71]
    ds_read_b64_tr_b16 v[130:131], v226 offset:35328
    s_waitcnt lgkmcnt(6)
    v_mfma_f32_16x16x32_bf16 v[72:75], v[116:119], v[216:219], v[72:75]
    ds_read_b64_tr_b16 v[132:133], v227 offset:33280
    v_mfma_f32_16x16x32_bf16 v[76:79], v[116:119], v[220:223], v[76:79]
    ds_read_b64_tr_b16 v[134:135], v227 offset:35328
    s_waitcnt lgkmcnt(6)
    v_mfma_f32_16x16x32_bf16 v[80:83], v[120:123], v[216:219], v[80:83]
    ds_read_b64_tr_b16 v[112:113], v228 offset:0
    s_add_u32 m0, s38, 65536
    s_nop 0
    buffer_load_dwordx4 v248, s[32:35], s39 offen lds
    v_readlane_b32 s36, v251, s41
    s_add_u32 s41, s41, 1
    v_readlane_b32 s39, v251, s41
    s_add_u32 s41, s41, 1
    s_cmp_lt_u32 s90, 4
    s_cselect_b32 s40, s36, s39
    v_mfma_f32_16x16x32_bf16 v[84:87], v[120:123], v[220:223], v[84:87]
    ds_read_b64_tr_b16 v[114:115], v228 offset:2048
    s_waitcnt lgkmcnt(6)
    v_mfma_f32_16x16x32_bf16 v[88:91], v[124:127], v[216:219], v[88:91]
    ds_read_b64_tr_b16 v[116:117], v229 offset:0
    v_mfma_f32_16x16x32_bf16 v[92:95], v[124:127], v[220:223], v[92:95]
    ds_read_b64_tr_b16 v[118:119], v229 offset:2048
    s_waitcnt lgkmcnt(6)
    v_mfma_f32_16x16x32_bf16 v[96:99], v[128:131], v[216:219], v[96:99]
    ds_read_b64_tr_b16 v[120:121], v228 offset:512
    v_mfma_f32_16x16x32_bf16 v[100:103], v[128:131], v[220:223], v[100:103]
    ds_read_b64_tr_b16 v[122:123], v228 offset:2560
    s_waitcnt lgkmcnt(6)
    v_mfma_f32_16x16x32_bf16 v[104:107], v[132:135], v[216:219], v[104:107]
    ds_read_b64_tr_b16 v[124:125], v229 offset:512
    v_mfma_f32_16x16x32_bf16 v[108:111], v[132:135], v[220:223], v[108:111]
    ds_read_b64_tr_b16 v[126:127], v229 offset:2560
    s_waitcnt vmcnt(15)
    s_barrier
    s_waitcnt lgkmcnt(6)
    v_mfma_f32_16x16x32_bf16 v[16:19], v[112:115], v[184:187], v[16:19]
    ds_read_b64_tr_b16 v[128:129], v228 offset:4096
    buffer_load_dwordx4 v[216:219], v9, s[4:7], s42 offen sc1
    v_mfma_f32_16x16x32_bf16 v[20:23], v[112:115], v[188:191], v[20:23]
    ds_read_b64_tr_b16 v[130:131], v228 offset:6144
    s_waitcnt lgkmcnt(6)
    v_mfma_f32_16x16x32_bf16 v[24:27], v[116:119], v[184:187], v[24:27]
    ds_read_b64_tr_b16 v[132:133], v229 offset:4096
    v_mfma_f32_16x16x32_bf16 v[28:31], v[116:119], v[188:191], v[28:31]
    ds_read_b64_tr_b16 v[134:135], v229 offset:6144
    s_waitcnt lgkmcnt(6)
    v_mfma_f32_16x16x32_bf16 v[32:35], v[120:123], v[184:187], v[32:35]
    ds_read_b64_tr_b16 v[112:113], v228 offset:4608
    v_mfma_f32_16x16x32_bf16 v[36:39], v[120:123], v[188:191], v[36:39]
    ds_read_b64_tr_b16 v[114:115], v228 offset:6656
    s_waitcnt lgkmcnt(6)
    v_mfma_f32_16x16x32_bf16 v[40:43], v[124:127], v[184:187], v[40:43]
    ds_read_b64_tr_b16 v[116:117], v229 offset:4608
    v_mfma_f32_16x16x32_bf16 v[44:47], v[124:127], v[188:191], v[44:47]
    ds_read_b64_tr_b16 v[118:119], v229 offset:6656
    s_waitcnt lgkmcnt(6)
    v_mfma_f32_16x16x32_bf16 v[48:51], v[128:131], v[184:187], v[48:51]
    ds_read_b64_tr_b16 v[120:121], v228 offset:8192
    buffer_load_dwordx4 v[220:223], v9, s[8:11], s42 offen sc1
    s_add_u32 s45, s45, 2
    v_readlane_b32 s42, v252, s45
    v_mfma_f32_16x16x32_bf16 v[52:55], v[128:131], v[188:191], v[52:55]
    ds_read_b64_tr_b16 v[122:123], v228 offset:10240
    s_waitcnt lgkmcnt(6)
    v_mfma_f32_16x16x32_bf16 v[56:59], v[132:135], v[184:187], v[56:59]
    ds_read_b64_tr_b16 v[124:125], v229 offset:8192
    v_mfma_f32_16x16x32_bf16 v[60:63], v[132:135], v[188:191], v[60:63]
    ds_read_b64_tr_b16 v[126:127], v229 offset:10240
    s_waitcnt lgkmcnt(6)
    v_mfma_f32_16x16x32_bf16 v[64:67], v[112:115], v[184:187], v[64:67]
    ds_read_b64_tr_b16 v[128:129], v228 offset:8704
    v_mfma_f32_16x16x32_bf16 v[68:71], v[112:115], v[188:191], v[68:71]
    ds_read_b64_tr_b16 v[130:131], v228 offset:10752
    s_waitcnt lgkmcnt(6)
    v_mfma_f32_16x16x32_bf16 v[72:75], v[116:119], v[184:187], v[72:75]
    ds_read_b64_tr_b16 v[132:133], v229 offset:8704
    v_mfma_f32_16x16x32_bf16 v[76:79], v[116:119], v[188:191], v[76:79]
    ds_read_b64_tr_b16 v[134:135], v229 offset:10752
    s_waitcnt lgkmcnt(6)
    v_mfma_f32_16x16x32_bf16 v[80:83], v[120:123], v[184:187], v[80:83]
    ds_read_b64_tr_b16 v[112:113], v228 offset:24576
    v_mfma_f32_16x16x32_bf16 v[84:87], v[120:123], v[188:191], v[84:87]
    ds_read_b64_tr_b16 v[114:115], v228 offset:26624
    s_waitcnt lgkmcnt(6)
    v_mfma_f32_16x16x32_bf16 v[88:91], v[124:127], v[184:187], v[88:91]
    ds_read_b64_tr_b16 v[116:117], v229 offset:24576
    v_mfma_f32_16x16x32_bf16 v[92:95], v[124:127], v[188:191], v[92:95]
    ds_read_b64_tr_b16 v[118:119], v229 offset:26624
    s_waitcnt lgkmcnt(6)
    v_mfma_f32_16x16x32_bf16 v[96:99], v[128:131], v[184:187], v[96:99]
    ds_read_b64_tr_b16 v[120:121], v228 offset:25088
    v_mfma_f32_16x16x32_bf16 v[100:103], v[128:131], v[188:191], v[100:103]
    ds_read_b64_tr_b16 v[122:123], v228 offset:27136
    s_waitcnt lgkmcnt(6)
    v_mfma_f32_16x16x32_bf16 v[104:107], v[132:135], v[184:187], v[104:107]
    ds_read_b64_tr_b16 v[124:125], v229 offset:25088
    v_mfma_f32_16x16x32_bf16 v[108:111], v[132:135], v[188:191], v[108:111]
    ds_read_b64_tr_b16 v[126:127], v229 offset:27136
    s_waitcnt vmcnt(12)
    s_barrier
    s_waitcnt lgkmcnt(6)
    v_mfma_f32_16x16x32_bf16 v[16:19], v[112:115], v[192:195], v[16:19]
    ds_read_b64_tr_b16 v[128:129], v228 offset:28672
    v_mfma_f32_16x16x32_bf16 v[20:23], v[112:115], v[196:199], v[20:23]
    ds_read_b64_tr_b16 v[130:131], v228 offset:30720
    s_waitcnt lgkmcnt(6)
    v_mfma_f32_16x16x32_bf16 v[24:27], v[116:119], v[192:195], v[24:27]
    ds_read_b64_tr_b16 v[132:133], v229 offset:28672
    v_mfma_f32_16x16x32_bf16 v[28:31], v[116:119], v[196:199], v[28:31]
    ds_read_b64_tr_b16 v[134:135], v229 offset:30720
    s_waitcnt lgkmcnt(6)
    v_mfma_f32_16x16x32_bf16 v[32:35], v[120:123], v[192:195], v[32:35]
    ds_read_b64_tr_b16 v[112:113], v228 offset:29184
    v_mfma_f32_16x16x32_bf16 v[36:39], v[120:123], v[196:199], v[36:39]
    ds_read_b64_tr_b16 v[114:115], v228 offset:31232
    s_waitcnt lgkmcnt(6)
    v_mfma_f32_16x16x32_bf16 v[40:43], v[124:127], v[192:195], v[40:43]
    ds_read_b64_tr_b16 v[116:117], v229 offset:29184
    v_mfma_f32_16x16x32_bf16 v[44:47], v[124:127], v[196:199], v[44:47]
    ds_read_b64_tr_b16 v[118:119], v229 offset:31232
    s_waitcnt lgkmcnt(6)
    v_mfma_f32_16x16x32_bf16 v[48:51], v[128:131], v[192:195], v[48:51]
    ds_read_b64_tr_b16 v[120:121], v228 offset:32768
    v_mfma_f32_16x16x32_bf16 v[52:55], v[128:131], v[196:199], v[52:55]
    ds_read_b64_tr_b16 v[122:123], v228 offset:34816
    s_waitcnt lgkmcnt(6)
    v_mfma_f32_16x16x32_bf16 v[56:59], v[132:135], v[192:195], v[56:59]
    ds_read_b64_tr_b16 v[124:125], v229 offset:32768
    v_mfma_f32_16x16x32_bf16 v[60:63], v[132:135], v[196:199], v[60:63]
    ds_read_b64_tr_b16 v[126:127], v229 offset:34816
    s_waitcnt lgkmcnt(6)
    v_mfma_f32_16x16x32_bf16 v[64:67], v[112:115], v[192:195], v[64:67]
    ds_read_b64_tr_b16 v[128:129], v228 offset:33280
    v_mfma_f32_16x16x32_bf16 v[68:71], v[112:115], v[196:199], v[68:71]
    ds_read_b64_tr_b16 v[130:131], v228 offset:35328
    s_waitcnt lgkmcnt(6)
    v_mfma_f32_16x16x32_bf16 v[72:75], v[116:119], v[192:195], v[72:75]
    ds_read_b64_tr_b16 v[132:133], v229 offset:33280
    v_mfma_f32_16x16x32_bf16 v[76:79], v[116:119], v[196:199], v[76:79]
    ds_read_b64_tr_b16 v[134:135], v229 offset:35328
    s_waitcnt lgkmcnt(6)
    v_mfma_f32_16x16x32_bf16 v[80:83], v[120:123], v[192:195], v[80:83]
    ds_read_b64_tr_b16 v[112:113], v224 offset:0
    v_mfma_f32_16x16x32_bf16 v[84:87], v[120:123], v[196:199], v[84:87]
    ds_read_b64_tr_b16 v[114:115], v224 offset:2048
    s_waitcnt lgkmcnt(6)
    v_mfma_f32_16x16x32_bf16 v[88:91], v[124:127], v[192:195], v[88:91]
    ds_read_b64_tr_b16 v[116:117], v225 offset:0
    v_mfma_f32_16x16x32_bf16 v[92:95], v[124:127], v[196:199], v[92:95]
    ds_read_b64_tr_b16 v[118:119], v225 offset:2048
    s_waitcnt lgkmcnt(6)
    v_mfma_f32_16x16x32_bf16 v[96:99], v[128:131], v[192:195], v[96:99]
    ds_read_b64_tr_b16 v[120:121], v224 offset:512
    v_mfma_f32_16x16x32_bf16 v[100:103], v[128:131], v[196:199], v[100:103]
    ds_read_b64_tr_b16 v[122:123], v224 offset:2560
    s_waitcnt lgkmcnt(6)
    v_mfma_f32_16x16x32_bf16 v[104:107], v[132:135], v[192:195], v[104:107]
    ds_read_b64_tr_b16 v[124:125], v225 offset:512
    v_mfma_f32_16x16x32_bf16 v[108:111], v[132:135], v[196:199], v[108:111]
    ds_read_b64_tr_b16 v[126:127], v225 offset:2560
    s_waitcnt vmcnt(7)
    s_barrier
    s_waitcnt lgkmcnt(6)
    v_mfma_f32_16x16x32_bf16 v[16:19], v[112:115], v[200:203], v[16:19]
    ds_read_b64_tr_b16 v[128:129], v224 offset:4096
    v_mfma_f32_16x16x32_bf16 v[20:23], v[112:115], v[204:207], v[20:23]
    ds_read_b64_tr_b16 v[130:131], v224 offset:6144
    s_waitcnt lgkmcnt(6)
    v_mfma_f32_16x16x32_bf16 v[24:27], v[116:119], v[200:203], v[24:27]
    ds_read_b64_tr_b16 v[132:133], v225 offset:4096
    v_mfma_f32_16x16x32_bf16 v[28:31], v[116:119], v[204:207], v[28:31]
    ds_read_b64_tr_b16 v[134:135], v225 offset:6144
    s_waitcnt lgkmcnt(6)
    v_mfma_f32_16x16x32_bf16 v[32:35], v[120:123], v[200:203], v[32:35]
    ds_read_b64_tr_b16 v[112:113], v224 offset:4608
    v_mfma_f32_16x16x32_bf16 v[36:39], v[120:123], v[204:207], v[36:39]
    ds_read_b64_tr_b16 v[114:115], v224 offset:6656
    s_waitcnt lgkmcnt(6)
    v_mfma_f32_16x16x32_bf16 v[40:43], v[124:127], v[200:203], v[40:43]
    ds_read_b64_tr_b16 v[116:117], v225 offset:4608
    v_mfma_f32_16x16x32_bf16 v[44:47], v[124:127], v[204:207], v[44:47]
    ds_read_b64_tr_b16 v[118:119], v225 offset:6656
    s_waitcnt lgkmcnt(6)
    v_mfma_f32_16x16x32_bf16 v[48:51], v[128:131], v[200:203], v[48:51]
    ds_read_b64_tr_b16 v[120:121], v224 offset:8192
    v_mfma_f32_16x16x32_bf16 v[52:55], v[128:131], v[204:207], v[52:55]
    ds_read_b64_tr_b16 v[122:123], v224 offset:10240
    s_waitcnt lgkmcnt(6)
    v_mfma_f32_16x16x32_bf16 v[56:59], v[132:135], v[200:203], v[56:59]
    ds_read_b64_tr_b16 v[124:125], v225 offset:8192
    v_mfma_f32_16x16x32_bf16 v[60:63], v[132:135], v[204:207], v[60:63]
    ds_read_b64_tr_b16 v[126:127], v225 offset:10240
    s_waitcnt lgkmcnt(6)
    v_mfma_f32_16x16x32_bf16 v[64:67], v[112:115], v[200:203], v[64:67]
    ds_read_b64_tr_b16 v[128:129], v224 offset:8704
    v_mfma_f32_16x16x32_bf16 v[68:71], v[112:115], v[204:207], v[68:71]
    ds_read_b64_tr_b16 v[130:131], v224 offset:10752
    s_waitcnt lgkmcnt(6)
    v_mfma_f32_16x16x32_bf16 v[72:75], v[116:119], v[200:203], v[72:75]
    ds_read_b64_tr_b16 v[132:133], v225 offset:8704
    v_mfma_f32_16x16x32_bf16 v[76:79], v[116:119], v[204:207], v[76:79]
    ds_read_b64_tr_b16 v[134:135], v225 offset:10752
    s_waitcnt lgkmcnt(6)
    v_mfma_f32_16x16x32_bf16 v[80:83], v[120:123], v[200:203], v[80:83]
    ds_read_b64_tr_b16 v[112:113], v224 offset:24576
    v_mfma_f32_16x16x32_bf16 v[84:87], v[120:123], v[204:207], v[84:87]
    ds_read_b64_tr_b16 v[114:115], v224 offset:26624
    s_waitcnt lgkmcnt(6)
    v_mfma_f32_16x16x32_bf16 v[88:91], v[124:127], v[200:203], v[88:91]
    ds_read_b64_tr_b16 v[116:117], v225 offset:24576
    v_mfma_f32_16x16x32_bf16 v[92:95], v[124:127], v[204:207], v[92:95]
    ds_read_b64_tr_b16 v[118:119], v225 offset:26624
    s_waitcnt lgkmcnt(6)
    v_mfma_f32_16x16x32_bf16 v[96:99], v[128:131], v[200:203], v[96:99]
    ds_read_b64_tr_b16 v[120:121], v224 offset:25088
    v_mfma_f32_16x16x32_bf16 v[100:103], v[128:131], v[204:207], v[100:103]
    ds_read_b64_tr_b16 v[122:123], v224 offset:27136
    s_waitcnt lgkmcnt(6)
    v_mfma_f32_16x16x32_bf16 v[104:107], v[132:135], v[200:203], v[104:107]
    ds_read_b64_tr_b16 v[124:125], v225 offset:25088
    v_mfma_f32_16x16x32_bf16 v[108:111], v[132:135], v[204:207], v[108:111]
    ds_read_b64_tr_b16 v[126:127], v225 offset:27136
    s_waitcnt vmcnt(2)
    s_barrier
    s_waitcnt lgkmcnt(6)
    v_mfma_f32_16x16x32_bf16 v[16:19], v[112:115], v[208:211], v[16:19]
    ds_read_b64_tr_b16 v[128:129], v224 offset:28672
    v_mfma_f32_16x16x32_bf16 v[20:23], v[112:115], v[212:215], v[20:23]
    ds_read_b64_tr_b16 v[130:131], v224 offset:30720
    s_waitcnt lgkmcnt(6)
    v_mfma_f32_16x16x32_bf16 v[24:27], v[116:119], v[208:211], v[24:27]
    ds_read_b64_tr_b16 v[132:133], v225 offset:28672
    v_mfma_f32_16x16x32_bf16 v[28:31], v[116:119], v[212:215], v[28:31]
    ds_read_b64_tr_b16 v[134:135], v225 offset:30720
    s_waitcnt lgkmcnt(6)
    v_mfma_f32_16x16x32_bf16 v[32:35], v[120:123], v[208:211], v[32:35]
    ds_read_b64_tr_b16 v[112:113], v224 offset:29184
    v_mfma_f32_16x16x32_bf16 v[36:39], v[120:123], v[212:215], v[36:39]
    ds_read_b64_tr_b16 v[114:115], v224 offset:31232
    s_waitcnt lgkmcnt(6)
    v_mfma_f32_16x16x32_bf16 v[40:43], v[124:127], v[208:211], v[40:43]
    ds_read_b64_tr_b16 v[116:117], v225 offset:29184
    v_mfma_f32_16x16x32_bf16 v[44:47], v[124:127], v[212:215], v[44:47]
    ds_read_b64_tr_b16 v[118:119], v225 offset:31232
    s_waitcnt lgkmcnt(6)
    v_mfma_f32_16x16x32_bf16 v[48:51], v[128:131], v[208:211], v[48:51]
    ds_read_b64_tr_b16 v[120:121], v224 offset:32768
    v_mfma_f32_16x16x32_bf16 v[52:55], v[128:131], v[212:215], v[52:55]
    ds_read_b64_tr_b16 v[122:123], v224 offset:34816
    s_waitcnt lgkmcnt(6)
    v_mfma_f32_16x16x32_bf16 v[56:59], v[132:135], v[208:211], v[56:59]
    ds_read_b64_tr_b16 v[124:125], v225 offset:32768
    v_mfma_f32_16x16x32_bf16 v[60:63], v[132:135], v[212:215], v[60:63]
    ds_read_b64_tr_b16 v[126:127], v225 offset:34816
    s_waitcnt lgkmcnt(6)
    v_mfma_f32_16x16x32_bf16 v[64:67], v[112:115], v[208:211], v[64:67]
    ds_read_b64_tr_b16 v[128:129], v224 offset:33280
    v_mfma_f32_16x16x32_bf16 v[68:71], v[112:115], v[212:215], v[68:71]
    ds_read_b64_tr_b16 v[130:131], v224 offset:35328
    s_waitcnt lgkmcnt(6)
    v_mfma_f32_16x16x32_bf16 v[72:75], v[116:119], v[208:211], v[72:75]
    ds_read_b64_tr_b16 v[132:133], v225 offset:33280
    v_mfma_f32_16x16x32_bf16 v[76:79], v[116:119], v[212:215], v[76:79]
    ds_read_b64_tr_b16 v[134:135], v225 offset:35328
    s_waitcnt lgkmcnt(6)
    v_mfma_f32_16x16x32_bf16 v[80:83], v[120:123], v[208:211], v[80:83]
    ds_read_b64_tr_b16 v[112:113], v226 offset:0
    v_mfma_f32_16x16x32_bf16 v[84:87], v[120:123], v[212:215], v[84:87]
    ds_read_b64_tr_b16 v[114:115], v226 offset:2048
    s_waitcnt lgkmcnt(6)
    v_mfma_f32_16x16x32_bf16 v[88:91], v[124:127], v[208:211], v[88:91]
    ds_read_b64_tr_b16 v[116:117], v227 offset:0
    v_mfma_f32_16x16x32_bf16 v[92:95], v[124:127], v[212:215], v[92:95]
    ds_read_b64_tr_b16 v[118:119], v227 offset:2048
    s_waitcnt lgkmcnt(6)
    v_mfma_f32_16x16x32_bf16 v[96:99], v[128:131], v[208:211], v[96:99]
    ds_read_b64_tr_b16 v[120:121], v226 offset:512
    v_mfma_f32_16x16x32_bf16 v[100:103], v[128:131], v[212:215], v[100:103]
    ds_read_b64_tr_b16 v[122:123], v226 offset:2560
    s_waitcnt lgkmcnt(6)
    v_mfma_f32_16x16x32_bf16 v[104:107], v[132:135], v[208:211], v[104:107]
    ds_read_b64_tr_b16 v[124:125], v227 offset:512
    v_mfma_f32_16x16x32_bf16 v[108:111], v[132:135], v[212:215], v[108:111]
    ds_read_b64_tr_b16 v[126:127], v227 offset:2560
    s_waitcnt vmcnt(0)
    s_barrier
    s_waitcnt lgkmcnt(6)
    v_mfma_f32_16x16x32_bf16 v[16:19], v[112:115], v[216:219], v[16:19]
    ds_read_b64_tr_b16 v[128:129], v226 offset:4096
    v_mfma_f32_16x16x32_bf16 v[20:23], v[112:115], v[220:223], v[20:23]
    ds_read_b64_tr_b16 v[130:131], v226 offset:6144
    s_waitcnt lgkmcnt(6)
    v_mfma_f32_16x16x32_bf16 v[24:27], v[116:119], v[216:219], v[24:27]
    ds_read_b64_tr_b16 v[132:133], v227 offset:4096
    v_mfma_f32_16x16x32_bf16 v[28:31], v[116:119], v[220:223], v[28:31]
    ds_read_b64_tr_b16 v[134:135], v227 offset:6144
    s_waitcnt lgkmcnt(6)
    v_mfma_f32_16x16x32_bf16 v[32:35], v[120:123], v[216:219], v[32:35]
    ds_read_b64_tr_b16 v[112:113], v226 offset:4608
    v_mfma_f32_16x16x32_bf16 v[36:39], v[120:123], v[220:223], v[36:39]
    ds_read_b64_tr_b16 v[114:115], v226 offset:6656
    s_waitcnt lgkmcnt(6)
    v_mfma_f32_16x16x32_bf16 v[40:43], v[124:127], v[216:219], v[40:43]
    ds_read_b64_tr_b16 v[116:117], v227 offset:4608
    v_mfma_f32_16x16x32_bf16 v[44:47], v[124:127], v[220:223], v[44:47]
    ds_read_b64_tr_b16 v[118:119], v227 offset:6656
    s_waitcnt lgkmcnt(6)
    v_mfma_f32_16x16x32_bf16 v[48:51], v[128:131], v[216:219], v[48:51]
    ds_read_b64_tr_b16 v[120:121], v226 offset:8192
    v_mfma_f32_16x16x32_bf16 v[52:55], v[128:131], v[220:223], v[52:55]
    ds_read_b64_tr_b16 v[122:123], v226 offset:10240
    s_waitcnt lgkmcnt(6)
    v_mfma_f32_16x16x32_bf16 v[56:59], v[132:135], v[216:219], v[56:59]
    ds_read_b64_tr_b16 v[124:125], v227 offset:8192
    v_mfma_f32_16x16x32_bf16 v[60:63], v[132:135], v[220:223], v[60:63]
    ds_read_b64_tr_b16 v[126:127], v227 offset:10240
    s_waitcnt lgkmcnt(6)
    v_mfma_f32_16x16x32_bf16 v[64:67], v[112:115], v[216:219], v[64:67]
    ds_read_b64_tr_b16 v[128:129], v226 offset:8704
    v_mfma_f32_16x16x32_bf16 v[68:71], v[112:115], v[220:223], v[68:71]
    ds_read_b64_tr_b16 v[130:131], v226 offset:10752
    s_waitcnt lgkmcnt(6)
    v_mfma_f32_16x16x32_bf16 v[72:75], v[116:119], v[216:219], v[72:75]
    ds_read_b64_tr_b16 v[132:133], v227 offset:8704
    v_mfma_f32_16x16x32_bf16 v[76:79], v[116:119], v[220:223], v[76:79]
    ds_read_b64_tr_b16 v[134:135], v227 offset:10752
    s_waitcnt lgkmcnt(6)
    v_mfma_f32_16x16x32_bf16 v[80:83], v[120:123], v[216:219], v[80:83]
    v_mfma_f32_16x16x32_bf16 v[84:87], v[120:123], v[220:223], v[84:87]
    s_waitcnt lgkmcnt(4)
    v_mfma_f32_16x16x32_bf16 v[88:91], v[124:127], v[216:219], v[88:91]
    v_mfma_f32_16x16x32_bf16 v[92:95], v[124:127], v[220:223], v[92:95]
    s_waitcnt lgkmcnt(2)
    v_mfma_f32_16x16x32_bf16 v[96:99], v[128:131], v[216:219], v[96:99]
    v_mfma_f32_16x16x32_bf16 v[100:103], v[128:131], v[220:223], v[100:103]
    s_waitcnt lgkmcnt(0)
    v_mfma_f32_16x16x32_bf16 v[104:107], v[132:135], v[216:219], v[104:107]
    v_mfma_f32_16x16x32_bf16 v[108:111], v[132:135], v[220:223], v[108:111]
    s_waitcnt vmcnt(0) lgkmcnt(0)
    s_barrier
    v_lshlrev_b32 v4, 4, v1
    s_mul_i32 s52, s90, 12288
    v_add_u32 v5, s52, v4
    s_xor_b32 s53, s90, 4
    s_mul_i32 s53, s53, 12288
    v_add_u32 v6, s53, v4
    s_cmp_lt_u32 s90, 4
    s_cbranch_scc0 Lhi_65
    ds_write_b128 v5, v[64:67] offset:0
    ds_write_b128 v5, v[68:71] offset:1024
    ds_write_b128 v5, v[72:75] offset:2048
    ds_write_b128 v5, v[76:79] offset:3072
    ds_write_b128 v5, v[80:83] offset:4096
    ds_write_b128 v5, v[84:87] offset:5120
    ds_write_b128 v5, v[88:91] offset:6144
    ds_write_b128 v5, v[92:95] offset:7168
    ds_write_b128 v5, v[96:99] offset:8192
    ds_write_b128 v5, v[100:103] offset:9216
    ds_write_b128 v5, v[104:107] offset:10240
    ds_write_b128 v5, v[108:111] offset:11264
    s_branch Lx_66
Lhi_65:
    ds_write_b128 v5, v[16:19] offset:0
    ds_write_b128 v5, v[20:23] offset:1024
    ds_write_b128 v5, v[24:27] offset:2048
    ds_write_b128 v5, v[28:31] offset:3072
    ds_write_b128 v5, v[32:35] offset:4096
    ds_write_b128 v5, v[36:39] offset:5120
    ds_write_b128 v5, v[40:43] offset:6144
    ds_write_b128 v5, v[44:47] offset:7168
    ds_write_b128 v5, v[48:51] offset:8192
    ds_write_b128 v5, v[52:55] offset:9216
    ds_write_b128 v5, v[56:59] offset:10240
    ds_write_b128 v5, v[60:63] offset:11264
    v_mov_b32 v16, v64
    v_mov_b32 v17, v65
    v_mov_b32 v18, v66
    v_mov_b32 v19, v67
    v_mov_b32 v20, v68
    v_mov_b32 v21, v69
    v_mov_b32 v22, v70
    v_mov_b32 v23, v71
    v_mov_b32 v24, v72
    v_mov_b32 v25, v73
    v_mov_b32 v26, v74
    v_mov_b32 v27, v75
    v_mov_b32 v28, v76
    v_mov_b32 v29, v77
    v_mov_b32 v30, v78
    v_mov_b32 v31, v79
    v_mov_b32 v32, v80
    v_mov_b32 v33, v81
    v_mov_b32 v34, v82
    v_mov_b32 v35, v83
    v_mov_b32 v36, v84
    v_mov_b32 v37, v85
    v_mov_b32 v38, v86
    v_mov_b32 v39, v87
    v_mov_b32 v40, v88
    v_mov_b32 v41, v89
    v_mov_b32 v42, v90
    v_mov_b32 v43, v91
    v_mov_b32 v44, v92
    v_mov_b32 v45, v93
    v_mov_b32 v46, v94
    v_mov_b32 v47, v95
    v_mov_b32 v48, v96
    v_mov_b32 v49, v97
    v_mov_b32 v50, v98
    v_mov_b32 v51, v99
    v_mov_b32 v52, v100
    v_mov_b32 v53, v101
    v_mov_b32 v54, v102
    v_mov_b32 v55, v103
    v_mov_b32 v56, v104
    v_mov_b32 v57, v105
    v_mov_b32 v58, v106
    v_mov_b32 v59, v107
    v_mov_b32 v60, v108
    v_mov_b32 v61, v109
    v_mov_b32 v62, v110
    v_mov_b32 v63, v111
Lx_66:
    s_waitcnt lgkmcnt(0)
    s_barrier
    ds_read_b128 v[64:67], v6 offset:0
    ds_read_b128 v[68:71], v6 offset:1024
    ds_read_b128 v[72:75], v6 offset:2048
    ds_read_b128 v[76:79], v6 offset:3072
    ds_read_b128 v[80:83], v6 offset:4096
    ds_read_b128 v[84:87], v6 offset:5120
    ds_read_b128 v[88:91], v6 offset:6144
    ds_read_b128 v[92:95], v6 offset:7168
    ds_read_b128 v[96:99], v6 offset:8192
    ds_read_b128 v[100:103], v6 offset:9216
    ds_read_b128 v[104:107], v6 offset:10240
    ds_read_b128 v[108:111], v6 offset:11264
    s_add_u32 s4, s30, 35651584
    s_addc_u32 s5, s31, 0
    s_mov_b32 s6, 11796480
    s_mov_b32 s7, 0x20000
    s_mul_i32 s52, s69, 18
    s_mul_i32 s53, s64, 6
    s_add_u32 s52, s52, s53
    s_mul_i32 s53, s43, 3
    s_add_u32 s52, s52, s53
    s_lshl_b32 s52, s52, 10
    s_mul_i32 s53, s66, 2359296
    s_add_u32 s52, s52, s53
    s_waitcnt lgkmcnt(0)
    v_pk_add_f32 v[16:17], v[16:17], v[64:65]
    v_pk_add_f32 v[18:19], v[18:19], v[66:67]
    v_pk_add_f32 v[20:21], v[20:21], v[68:69]
    v_pk_add_f32 v[22:23], v[22:23], v[70:71]
    v_pk_add_f32 v[24:25], v[24:25], v[72:73]
    v_pk_add_f32 v[26:27], v[26:27], v[74:75]
    v_pk_add_f32 v[28:29], v[28:29], v[76:77]
    v_pk_add_f32 v[30:31], v[30:31], v[78:79]
    v_pk_add_f32 v[32:33], v[32:33], v[80:81]
    v_pk_add_f32 v[34:35], v[34:35], v[82:83]
    v_pk_add_f32 v[36:37], v[36:37], v[84:85]
    v_pk_add_f32 v[38:39], v[38:39], v[86:87]
    v_pk_add_f32 v[40:41], v[40:41], v[88:89]
    v_pk_add_f32 v[42:43], v[42:43], v[90:91]
    v_pk_add_f32 v[44:45], v[44:45], v[92:93]
    v_pk_add_f32 v[46:47], v[46:47], v[94:95]
    v_pk_add_f32 v[48:49], v[48:49], v[96:97]
    v_pk_add_f32 v[50:51], v[50:51], v[98:99]
    v_pk_add_f32 v[52:53], v[52:53], v[100:101]
    v_pk_add_f32 v[54:55], v[54:55], v[102:103]
    v_pk_add_f32 v[56:57], v[56:57], v[104:105]
    v_pk_add_f32 v[58:59], v[58:59], v[106:107]
    v_pk_add_f32 v[60:61], v[60:61], v[108:109]
    v_pk_add_f32 v[62:63], v[62:63], v[110:111]
    s_mul_i32 s40, s66, 10
    s_cmp_eq_u32 s66, 4
    s_cselect_b32 s41, 1, 0
    s_sub_u32 s40, s40, s41
    s_cmp_lt_u32 s66, 3
    s_cselect_b32 s41, 10, 9
    s_add_u32 s41, s41, s40
    s_and_b32 s54, s90, 3
    s_mul_i32 s54, s54, 12
    s_mul_i32 s55, s43, 3
    s_add_u32 s54, s54, s55
    v_add_u32 v5, 102400, v4
    v_cvt_pk_bf16_f32 v112, v16, v17
    v_cvt_pk_bf16_f32 v113, v18, v19
    v_cvt_pk_bf16_f32 v114, v24, v25
    v_cvt_pk_bf16_f32 v115, v26, v27
    s_add_u32 s55, s54, 0
    s_sub_u32 s56, s55, s40
    s_sub_u32 s57, s41, s40
    s_cmp_lt_u32 s56, s57
    s_cbranch_scc1 Lown_67
    s_add_u32 s53, s52, 0
    buffer_store_dwordx4 v[112:115], v4, s[4:7], s53 offen sc1
    s_branch Lowe_68
Lown_67:
    s_lshl_b32 s56, s56, 10
    v_add_u32 v6, s56, v5
    ds_write_b128 v6, v[112:115]
Lowe_68:
    v_cvt_pk_bf16_f32 v116, v32, v33
    v_cvt_pk_bf16_f32 v117, v34, v35
    v_cvt_pk_bf16_f32 v118, v40, v41
    v_cvt_pk_bf16_f32 v119, v42, v43
    s_add_u32 s55, s54, 1
    s_sub_u32 s56, s55, s40
    s_sub_u32 s57, s41, s40
    s_cmp_lt_u32 s56, s57
    s_cbranch_scc1 Lown_69
    s_add_u32 s53, s52, 1024
    buffer_store_dwordx4 v[116:119], v4, s[4:7], s53 offen sc1
    s_branch Lowe_70
Lown_69:
    s_lshl_b32 s56, s56, 10
    v_add_u32 v6, s56, v5
    ds_write_b128 v6, v[116:119]
Lowe_70:
    v_cvt_pk_bf16_f32 v120, v48, v49
    v_cvt_pk_bf16_f32 v121, v50, v51
    v_cvt_pk_bf16_f32 v122, v56, v57
    v_cvt_pk_bf16_f32 v123, v58, v59
    s_add_u32 s55, s54, 2
    s_sub_u32 s56, s55, s40
    s_sub_u32 s57, s41, s40
    s_cmp_lt_u32 s56, s57
    s_cbranch_scc1 Lown_71
    s_add_u32 s53, s52, 2048
    buffer_store_dwordx4 v[120:123], v4, s[4:7], s53 offen sc1
    s_branch Lowe_72
Lown_71:
    s_lshl_b32 s56, s56, 10
    v_add_u32 v6, s56, v5
    ds_write_b128 v6, v[120:123]
Lowe_72:
    v_cvt_pk_bf16_f32 v124, v20, v21
    v_cvt_pk_bf16_f32 v125, v22, v23
    v_cvt_pk_bf16_f32 v126, v28, v29
    v_cvt_pk_bf16_f32 v127, v30, v31
    s_add_u32 s55, s54, 6
    s_sub_u32 s56, s55, s40
    s_sub_u32 s57, s41, s40
    s_cmp_lt_u32 s56, s57
    s_cbranch_scc1 Lown_73
    s_add_u32 s53, s52, 18432
    buffer_store_dwordx4 v[124:127], v4, s[4:7], s53 offen sc1
    s_branch Lowe_74
Lown_73:
    s_lshl_b32 s56, s56, 10
    v_add_u32 v6, s56, v5
    ds_write_b128 v6, v[124:127]
Lowe_74:
    v_cvt_pk_bf16_f32 v112, v36, v37
    v_cvt_pk_bf16_f32 v113, v38, v39
    v_cvt_pk_bf16_f32 v114, v44, v45
    v_cvt_pk_bf16_f32 v115, v46, v47
    s_add_u32 s55, s54, 7
    s_sub_u32 s56, s55, s40
    s_sub_u32 s57, s41, s40
    s_cmp_lt_u32 s56, s57
    s_cbranch_scc1 Lown_75
    s_add_u32 s53, s52, 19456
    buffer_store_dwordx4 v[112:115], v4, s[4:7], s53 offen sc1
    s_branch Lowe_76
Lown_75:
    s_lshl_b32 s56, s56, 10
    v_add_u32 v6, s56, v5
    ds_write_b128 v6, v[112:115]
Lowe_76:
    v_cvt_pk_bf16_f32 v116, v52, v53
    v_cvt_pk_bf16_f32 v117, v54, v55
    v_cvt_pk_bf16_f32 v118, v60, v61
    v_cvt_pk_bf16_f32 v119, v62, v63
    s_add_u32 s55, s54, 8
    s_sub_u32 s56, s55, s40
    s_sub_u32 s57, s41, s40
    s_cmp_lt_u32 s56, s57
    s_cbranch_scc1 Lown_77
    s_add_u32 s53, s52, 20480
    buffer_store_dwordx4 v[116:119], v4, s[4:7], s53 offen sc1
    s_branch Lowe_78
Lown_77:
    s_lshl_b32 s56, s56, 10
    v_add_u32 v6, s56, v5
    ds_write_b128 v6, v[116:119]
Lowe_78:
    s_lshl_b32 s58, s64, 4
    s_add_u32 s58, s58, s65
    s_mul_i32 s58, s58, 5
    s_add_u32 s58, s58, s66
    s_waitcnt vmcnt(0) lgkmcnt(0)
    s_barrier
    s_cmp_eq_u32 s90, 0
    s_cbranch_scc0 Lsig_79
    s_lshl_b32 s60, s58, 4
    s_add_u32 s60, s60, 168960
    v_mul_u32_u24 v2, 4224, v1
    v_add_u32 v2, s60, v2
    v_mov_b32 v3, s91
    s_mov_b64 exec, 0xff
    buffer_store_dword v3, v2, s[96:99], 0 offen sc1
    s_mov_b64 exec, -1
Lsig_79:
    s_add_u32 s8, s30, 7340032
    s_addc_u32 s9, s31, 0
    s_mov_b32 s10, 2359296
    s_mov_b32 s11, 0x20000
    s_add_u32 s12, s30, 9699328
    s_addc_u32 s13, s31, 0
    s_mov_b32 s14, 13824
    s_mov_b32 s15, 0x20000
    s_mov_b32 s16, s28
    s_mov_b32 s17, s29
    s_mov_b32 s18, 2359296
    s_mov_b32 s19, 0x20000
    v_lshlrev_b32 v2, 4, v1
    v_bfe_u32 v3, v1, 4, 1
    v_lshlrev_b32 v3, 5, v3
    v_lshrrev_b32 v6, 5, v1
    v_lshlrev_b32 v6, 4, v6
    v_add_u32 v3, v3, v6
    v_and_b32 v4, 15, v1
    v_mul_u32_u24 v4, 1152, v4
    v_add_u32 v4, v4, v3
    v_lshlrev_b32 v5, 1, v3
    v_add_u32 v7, 102400, v2
    s_add_u32 s42, s40, s90
    s_add_u32 s43, s42, 8
    s_mul_i32 s52, s42, 10923
    s_lshr_b32 s52, s52, 16
    s_mul_i32 s53, s52, 6
    s_sub_u32 s53, s42, s53
    s_lshl_b32 s54, s65, 3
    s_add_u32 s52, s52, s54
    s_mul_i32 s54, s64, 6
    s_add_u32 s53, s53, s54
    s_mul_i32 s54, s52, 18
    s_add_u32 s54, s54, s53
    s_lshl_b32 s72, s54, 10
    s_mul_i32 s55, s52, 18432
    s_lshl_b32 s56, s53, 6
    s_add_u32 s73, s55, s56
    s_lshl_b32 s56, s53, 7
    s_add_u32 s74, s56, 11520
    s_sub_u32 s75, s42, s40
    s_lshl_b32 s75, s75, 10
    buffer_load_dwordx4 v[36:39], v4, s[8:11], s73 offen sc1
    buffer_load_dwordx4 v[40:43], v5, s[12:15], s74 offen sc1
    buffer_load_dwordx4 v[44:47], v5, s[12:15], s74 offen offset:16 sc1
    s_cmp_ge_u32 s43, s41
    s_cbranch_scc1 Lnb_80
    s_mul_i32 s52, s43, 10923
    s_lshr_b32 s52, s52, 16
    s_mul_i32 s53, s52, 6
    s_sub_u32 s53, s43, s53
    s_lshl_b32 s54, s65, 3
    s_add_u32 s52, s52, s54
    s_mul_i32 s54, s64, 6
    s_add_u32 s53, s53, s54
    s_mul_i32 s54, s52, 18
    s_add_u32 s54, s54, s53
    s_lshl_b32 s76, s54, 10
    s_mul_i32 s55, s52, 18432
    s_lshl_b32 s56, s53, 6
    s_add_u32 s77, s55, s56
    s_lshl_b32 s56, s53, 7
    s_add_u32 s78, s56, 11520
    s_sub_u32 s79, s43, s40
    s_lshl_b32 s79, s79, 10
    buffer_load_dwordx4 v[84:87], v4, s[8:11], s77 offen sc1
    buffer_load_dwordx4 v[88:91], v5, s[12:15], s78 offen sc1
    buffer_load_dwordx4 v[92:95], v5, s[12:15], s78 offen offset:16 sc1
Lnb_80:
    s_cmp_eq_u32 s90, 7
    s_cbranch_scc0 Lw_81
    s_lshl_b32 s52, s64, 4
    s_add_u32 s52, s52, s65
    s_mul_i32 s52, s52, 5
    s_and_b32 s88, s2, 7
    s_mul_i32 s88, s88, 4224
    s_add_u32 s88, s88, 168960
    s_lshl_b32 s60, s52, 4
    s_add_u32 s60, s60, s88
    v_lshlrev_b32 v8, 4, v1
    v_add_u32 v8, s60, v8
    v_cmp_gt_u32 vcc, 5, v1
    s_mov_b64 exec, vcc
    s_mov_b32 s61, 0
Lpoll_82:
    buffer_load_dword v9, v8, s[96:99], 0 offen sc1
    s_waitcnt vmcnt(0)
    v_cmp_ne_u32 vcc, s91, v9
    s_cmp_eq_u64 vcc, 0
    s_cbranch_scc1 Lpd_83
    s_add_u32 s61, s61, 1
    s_cmp_lt_u32 s61, s93
    s_cbranch_scc1 Lpoll_82
Lpd_83:
    s_mov_b64 exec, -1
Lw_81:
    s_barrier
    v_add_u32 v6, s75, v7
    s_cmp_eq_u32 s66, 0
    s_cbranch_scc1 Lk_84
    s_add_u32 s52, s72, 0
    buffer_load_dwordx4 v[16:19], v2, s[4:7], s52 offen sc1
    s_branch Lk_85
Lk_84:
    ds_read_b128 v[16:19], v6
Lk_85:
    s_cmp_eq_u32 s66, 1
    s_cbranch_scc1 Lk_86
    s_add_u32 s52, s72, 2359296
    buffer_load_dwordx4 v[20:23], v2, s[4:7], s52 offen sc1
    s_branch Lk_87
Lk_86:
    ds_read_b128 v[20:23], v6
Lk_87:
    s_cmp_eq_u32 s66, 2
    s_cbranch_scc1 Lk_88
    s_add_u32 s52, s72, 4718592
    buffer_load_dwordx4 v[24:27], v2, s[4:7], s52 offen sc1
    s_branch Lk_89
Lk_88:
    ds_read_b128 v[24:27], v6
Lk_89:
    s_cmp_eq_u32 s66, 3
    s_cbranch_scc1 Lk_90
    s_add_u32 s52, s72, 7077888
    buffer_load_dwordx4 v[28:31], v2, s[4:7], s52 offen sc1
    s_branch Lk_91
Lk_90:
    ds_read_b128 v[28:31], v6
Lk_91:
    s_cmp_eq_u32 s66, 4
    s_cbranch_scc1 Lk_92
    s_add_u32 s52, s72, 9437184
    buffer_load_dwordx4 v[32:35], v2, s[4:7], s52 offen sc1
    s_branch Lk_93
Lk_92:
    ds_read_b128 v[32:35], v6
Lk_93:
    s_cmp_ge_u32 s43, s41
    s_cbranch_scc1 Lnb_94
    v_add_u32 v6, s79, v7
    s_cmp_eq_u32 s66, 0
    s_cbranch_scc1 Lk_96
    s_add_u32 s52, s76, 0
    buffer_load_dwordx4 v[64:67], v2, s[4:7], s52 offen sc1
    s_branch Lk_97
Lk_96:
    ds_read_b128 v[64:67], v6
Lk_97:
    s_cmp_eq_u32 s66, 1
    s_cbranch_scc1 Lk_98
    s_add_u32 s52, s76, 2359296
    buffer_load_dwordx4 v[68:71], v2, s[4:7], s52 offen sc1
    s_branch Lk_99
Lk_98:
    ds_read_b128 v[68:71], v6
Lk_99:
    s_cmp_eq_u32 s66, 2
    s_cbranch_scc1 Lk_100
    s_add_u32 s52, s76, 4718592
    buffer_load_dwordx4 v[72:75], v2, s[4:7], s52 offen sc1
    s_branch Lk_101
Lk_100:
    ds_read_b128 v[72:75], v6
Lk_101:
    s_cmp_eq_u32 s66, 3
    s_cbranch_scc1 Lk_102
    s_add_u32 s52, s76, 7077888
    buffer_load_dwordx4 v[76:79], v2, s[4:7], s52 offen sc1
    s_branch Lk_103
Lk_102:
    ds_read_b128 v[76:79], v6
Lk_103:
    s_cmp_eq_u32 s66, 4
    s_cbranch_scc1 Lk_104
    s_add_u32 s52, s76, 9437184
    buffer_load_dwordx4 v[80:83], v2, s[4:7], s52 offen sc1
    s_branch Lk_105
Lk_104:
    ds_read_b128 v[80:83], v6
Lk_105:
    s_waitcnt vmcnt(0) lgkmcnt(0)
    v_lshlrev_b32 v112, 16, v64
    v_and_b32 v113, s92, v64
    v_lshlrev_b32 v114, 16, v65
    v_and_b32 v115, s92, v65
    v_lshlrev_b32 v116, 16, v66
    v_and_b32 v117, s92, v66
    v_lshlrev_b32 v118, 16, v67
    v_and_b32 v119, s92, v67
    v_lshlrev_b32 v120, 16, v68
    v_and_b32 v121, s92, v68
    v_pk_add_f32 v[112:113], v[112:113], v[120:121]
    v_lshlrev_b32 v120, 16, v69
    v_and_b32 v121, s92, v69
    v_pk_add_f32 v[114:115], v[114:115], v[120:121]
    v_lshlrev_b32 v120, 16, v70
    v_and_b32 v121, s92, v70
    v_pk_add_f32 v[116:117], v[116:117], v[120:121]
    v_lshlrev_b32 v120, 16, v71
    v_and_b32 v121, s92, v71
    v_pk_add_f32 v[118:119], v[118:119], v[120:121]
    v_lshlrev_b32 v120, 16, v72
    v_and_b32 v121, s92, v72
    v_pk_add_f32 v[112:113], v[112:113], v[120:121]
    v_lshlrev_b32 v120, 16, v73
    v_and_b32 v121, s92, v73
    v_pk_add_f32 v[114:115], v[114:115], v[120:121]
    v_lshlrev_b32 v120, 16, v74
    v_and_b32 v121, s92, v74
    v_pk_add_f32 v[116:117], v[116:117], v[120:121]
    v_lshlrev_b32 v120, 16, v75
    v_and_b32 v121, s92, v75
    v_pk_add_f32 v[118:119], v[118:119], v[120:121]
    v_lshlrev_b32 v120, 16, v76
    v_and_b32 v121, s92, v76
    v_pk_add_f32 v[112:113], v[112:113], v[120:121]
    v_lshlrev_b32 v120, 16, v77
    v_and_b32 v121, s92, v77
    v_pk_add_f32 v[114:115], v[114:115], v[120:121]
    v_lshlrev_b32 v120, 16, v78
    v_and_b32 v121, s92, v78
    v_pk_add_f32 v[116:117], v[116:117], v[120:121]
    v_lshlrev_b32 v120, 16, v79
    v_and_b32 v121, s92, v79
    v_pk_add_f32 v[118:119], v[118:119], v[120:121]
    v_lshlrev_b32 v120, 16, v80
    v_and_b32 v121, s92, v80
    v_pk_add_f32 v[112:113], v[112:113], v[120:121]
    v_lshlrev_b32 v120, 16, v81
    v_and_b32 v121, s92, v81
    v_pk_add_f32 v[114:115], v[114:115], v[120:121]
    v_lshlrev_b32 v120, 16, v82
    v_and_b32 v121, s92, v82
    v_pk_add_f32 v[116:117], v[116:117], v[120:121]
    v_lshlrev_b32 v120, 16, v83
    v_and_b32 v121, s92, v83
    v_pk_add_f32 v[118:119], v[118:119], v[120:121]
    s_nop 1
    v_permlane16_swap_b32 v112, v116
    v_permlane16_swap_b32 v113, v117
    v_permlane16_swap_b32 v114, v118
    v_permlane16_swap_b32 v115, v119
    s_nop 0
    v_lshlrev_b32 v120, 16, v84
    v_and_b32 v121, s92, v84
    v_pk_fma_f32 v[112:113], v[112:113], v[88:89], v[120:121]
    v_cvt_pk_bf16_f32 v124, v112, v113
    v_lshlrev_b32 v120, 16, v85
    v_and_b32 v121, s92, v85
    v_pk_fma_f32 v[114:115], v[114:115], v[90:91], v[120:121]
    v_cvt_pk_bf16_f32 v125, v114, v115
    v_lshlrev_b32 v120, 16, v86
    v_and_b32 v121, s92, v86
    v_pk_fma_f32 v[116:117], v[116:117], v[92:93], v[120:121]
    v_cvt_pk_bf16_f32 v126, v116, v117
    v_lshlrev_b32 v120, 16, v87
    v_and_b32 v121, s92, v87
    v_pk_fma_f32 v[118:119], v[118:119], v[94:95], v[120:121]
    v_cvt_pk_bf16_f32 v127, v118, v119
    buffer_store_dwordx4 v[124:127], v4, s[16:19], s77 offen
Lnb_94:
    s_waitcnt vmcnt(0) lgkmcnt(0)
    v_lshlrev_b32 v112, 16, v16
    v_and_b32 v113, s92, v16
    v_lshlrev_b32 v114, 16, v17
    v_and_b32 v115, s92, v17
    v_lshlrev_b32 v116, 16, v18
    v_and_b32 v117, s92, v18
    v_lshlrev_b32 v118, 16, v19
    v_and_b32 v119, s92, v19
    v_lshlrev_b32 v120, 16, v20
    v_and_b32 v121, s92, v20
    v_pk_add_f32 v[112:113], v[112:113], v[120:121]
    v_lshlrev_b32 v120, 16, v21
    v_and_b32 v121, s92, v21
    v_pk_add_f32 v[114:115], v[114:115], v[120:121]
    v_lshlrev_b32 v120, 16, v22
    v_and_b32 v121, s92, v22
    v_pk_add_f32 v[116:117], v[116:117], v[120:121]
    v_lshlrev_b32 v120, 16, v23
    v_and_b32 v121, s92, v23
    v_pk_add_f32 v[118:119], v[118:119], v[120:121]
    v_lshlrev_b32 v120, 16, v24
    v_and_b32 v121, s92, v24
    v_pk_add_f32 v[112:113], v[112:113], v[120:121]
    v_lshlrev_b32 v120, 16, v25
    v_and_b32 v121, s92, v25
    v_pk_add_f32 v[114:115], v[114:115], v[120:121]
    v_lshlrev_b32 v120, 16, v26
    v_and_b32 v121, s92, v26
    v_pk_add_f32 v[116:117], v[116:117], v[120:121]
    v_lshlrev_b32 v120, 16, v27
    v_and_b32 v121, s92, v27
    v_pk_add_f32 v[118:119], v[118:119], v[120:121]
    v_lshlrev_b32 v120, 16, v28
    v_and_b32 v121, s92, v28
    v_pk_add_f32 v[112:113], v[112:113], v[120:121]
    v_lshlrev_b32 v120, 16, v29
    v_and_b32 v121, s92, v29
    v_pk_add_f32 v[114:115], v[114:115], v[120:121]
    v_lshlrev_b32 v120, 16, v30
    v_and_b32 v121, s92, v30
    v_pk_add_f32 v[116:117], v[116:117], v[120:121]
    v_lshlrev_b32 v120, 16, v31
    v_and_b32 v121, s92, v31
    v_pk_add_f32 v[118:119], v[118:119], v[120:121]
    v_lshlrev_b32 v120, 16, v32
    v_and_b32 v121, s92, v32
    v_pk_add_f32 v[112:113], v[112:113], v[120:121]
    v_lshlrev_b32 v120, 16, v33
    v_and_b32 v121, s92, v33
    v_pk_add_f32 v[114:115], v[114:115], v[120:121]
    v_lshlrev_b32 v120, 16, v34
    v_and_b32 v121, s92, v34
    v_pk_add_f32 v[116:117], v[116:117], v[120:121]
    v_lshlrev_b32 v120, 16, v35
    v_and_b32 v121, s92, v35
    v_pk_add_f32 v[118:119], v[118:119], v[120:121]
    s_nop 1
    v_permlane16_swap_b32 v112, v116
    v_permlane16_swap_b32 v113, v117
    v_permlane16_swap_b32 v114, v118
    v_permlane16_swap_b32 v115, v119
    s_nop 0
    v_lshlrev_b32 v120, 16, v36
    v_and_b32 v121, s92, v36
    v_pk_fma_f32 v[112:113], v[112:113], v[40:41], v[120:121]
    v_cvt_pk_bf16_f32 v124, v112, v113
    v_lshlrev_b32 v120, 16, v37
    v_and_b32 v121, s92, v37
    v_pk_fma_f32 v[114:115], v[114:115], v[42:43], v[120:121]
    v_cvt_pk_bf16_f32 v125, v114, v115
    v_lshlrev_b32 v120, 16, v38
    v_and_b32 v121, s92, v38
    v_pk_fma_f32 v[116:117], v[116:117], v[44:45], v[120:121]
    v_cvt_pk_bf16_f32 v126, v116, v117
    v_lshlrev_b32 v120, 16, v39
    v_and_b32 v121, s92, v39
    v_pk_fma_f32 v[118:119], v[118:119], v[46:47], v[120:121]
    v_cvt_pk_bf16_f32 v127, v118, v119
    buffer_store_dwordx4 v[124:127], v4, s[16:19], s73 offen
L_done:
    s_endpgm
.section .rodata,"a"
.p2align 6
.amdhsa_kernel adaLN_cond__ssm_conv_h3__geglu_ffn__prompt_kernel
.amdhsa_next_free_vgpr 256
.amdhsa_next_free_sgpr 102
.amdhsa_accum_offset 256
.amdhsa_group_segment_fixed_size 0
.amdhsa_kernarg_size 120
.amdhsa_user_sgpr_count 2
.amdhsa_user_sgpr_kernarg_segment_ptr 1
.amdhsa_system_sgpr_workgroup_id_x 1
.end_amdhsa_kernel
```
